```python
import torch

def _softmax(x, axis=-1):
    return torch.softmax(x, dim=axis)
def _gelu(x):
    return torch.nn.functional.gelu(x, approximate="tanh")
def _silu(x):
    return torch.nn.functional.silu(x)
def _sigmoid(x):
    return torch.sigmoid(x)
def _layernorm(x, axis=-1, eps=1e-5):
    m = x.mean(dim=axis, keepdim=True)
    v = x.var(dim=axis, keepdim=True, unbiased=False)
    return (x - m) / torch.sqrt(v + eps)
def _scatter_add(tgt, idx, src, axis=0):
    return tgt.clone().index_add_(axis, idx, src)
def _segment_sum(src, seg, n):
    out = torch.zeros((n,) + src.shape[1:], dtype=src.dtype)
    return out.index_add_(0, seg, src)
def _pad(x, pw):
    flat = tuple(v for pair in reversed(pw) for v in pair)
    return torch.nn.functional.pad(x, flat)

kernel_name = 'gated_mix__sliding_local_dilated__dense_activation_relu__prompt'

def setup_inputs():

    _w = (lambda a: (lambda t: t.to(torch.bfloat16) if t.is_floating_point() else t)(torch.as_tensor(a)))
    def _A_setup():
        B, S, D = 1, 2048, 512
        return {
            "x": _w((lambda *s: torch.randn(*s, dtype=torch.bfloat16) * 0.05)(B, S, D)),
            "wqkv": _w((lambda *s: torch.randn(*s, dtype=torch.bfloat16) * 1.6)(D, 3 * D)),
            "wo": _w((lambda *s: torch.randn(*s, dtype=torch.bfloat16) * 0.05)(D, D)),
        }
    _A_in = _A_setup()

    def _B_setup():
        B, S, D, Dff = 1, 2048, 512, 1792
        return {
            "x": _w((lambda *s: torch.randn(*s, dtype=torch.bfloat16) * 0.05)(B, S, D)),
            "w1": _w((lambda *s: torch.randn(*s, dtype=torch.bfloat16) * 0.2)(D, Dff)),
            "w2": _w((lambda *s: torch.randn(*s, dtype=torch.bfloat16) * 0.2)(Dff, D)),
        }
    _B_in = _B_setup()

    return {
        "A_x": _A_in["x"],
        "A_wqkv": _A_in["wqkv"],
        "A_wo": _A_in["wo"],
        "B_x": _B_in["x"],
        "B_w1": _B_in["w1"],
        "B_w2": _B_in["w2"],
        "gate_w": _w((lambda *s: torch.randn(*s, dtype=torch.bfloat16) * 0.05)(512) * 16.0),
    }

def reference(A_x, A_wqkv, A_wo, B_x, B_w1, B_w2, gate_w):
    def _A_ref(x, wqkv, wo):
        B, S, D = x.shape
        H = 32; Dh = D // H
        W, dil = 8, 2
        qkv = (lambda x, *d: x.permute(*d))((x @ wqkv).reshape(B, S, 3, H, Dh), 2, 0, 3, 1, 4)
        q, k, v = qkv[0], qkv[1], qkv[2]
        scale = Dh ** -0.5
        pos = torch.arange(S)
        off = torch.arange(W) * dil
        idx = pos[:, None] - off[None, :]
        mask = idx >= 0
        idx_c = torch.where(mask, idx, 0).reshape(-1)
        kg = k[:, :, idx_c, :].reshape(B, H, S, W, Dh)
        vg = v[:, :, idx_c, :].reshape(B, H, S, W, Dh)
        logits = torch.einsum("bhsd,bhswd->bhsw", q, kg) * scale
        logits = torch.where(mask[None, None, :, :], logits, -1e9)
        attn = _softmax(logits, axis=-1)
        o = torch.einsum("bhsw,bhswd->bhsd", attn, vg)
        return (lambda x, *d: x.permute(*d))(o, 0, 2, 1, 3).reshape(B, S, D) @ wo

    def _B_ref(x, w1, w2):
        h = torch.einsum("bsd,df->bsf", x, w1)
        zero = torch.zeros_like(h)
        h = torch.maximum(h, zero)
        return torch.einsum("bsf,fd->bsd", h, w2)

    x = A_x
    g = _sigmoid((x * gate_w).sum(-1, keepdims=True))
    a = _A_ref(x, A_wqkv, A_wo)
    b = _B_ref(x, B_w1, B_w2)
    return g * a + (1 - g) * b
```

```asm
; @launch grid=(256,1,1) block=(512,1,1) lds=163840
.amdgcn_target "amdgcn-amd-amdhsa--gfx950"
.text
.globl gated_mix__sliding_local_dilated__dense_activation_relu__prompt_kernel
.p2align 8
.type gated_mix__sliding_local_dilated__dense_activation_relu__prompt_kernel,@function
gated_mix__sliding_local_dilated__dense_activation_relu__prompt_kernel:
    s_load_dwordx16 s[4:19], s[0:1], 0
    s_load_dwordx4 s[20:23], s[0:1], 64
    s_getpc_b64 s[56:57]
L_pc:
    v_lshrrev_b32 v1, 5, v0
    v_and_b32 v2, 1, v0
    v_add_u32 v2, v2, v1
    s_bfe_u32 s3, s2, 0x50003
    s_lshl_b32 s3, s3, 4
    v_add_lshl_u32 v2, v2, s3, 7
    v_min_u32 v2, L_end-L_pc, v2
    s_mov_b64 exec, 3
    global_load_dword v127, v2, s[56:57]
    s_mov_b64 exec, -1
    v_lshrrev_b32 v1, 6, v0
    s_cmp_ge_u32 s2, 256
    s_cbranch_scc1 L_end
    v_readfirstlane_b32 s68, v1
    v_and_b32 v0, 63, v0
    s_bfe_u32 s64, s2, 0x20001
    s_and_b32 s3, s2, 1
    s_lshl_b32 s3, s3, 3
    s_bfe_u32 s61, s2, 0x30003
    s_or_b32 s61, s61, s3
    s_lshr_b32 s62, s2, 6
    s_lshr_b32 s63, s3, 2
    s_add_u32 s63, s63, s64
    s_and_b32 s3, s61, 1
    s_add_u32 s63, s63, s3
    s_and_b32 s60, s68, 3
    s_lshl_b32 s65, s60, 12
    s_cmp_lt_u32 s68, 4
    s_cbranch_scc1 L_C
    s_setprio 3
    v_lshrrev_b32 v32, 4, v0
    v_lshrrev_b32 v36, 3, v0
    v_and_b32 v37, 7, v0
    v_xor_b32 v39, v37, v32
    v_lshlrev_b32 v39, 4, v39
    v_lshl_add_u32 v4, v36, 11, v39
    v_xor_b32 v5, 64, v4
    v_add_u32 v6, 14336, v5
    v_add_u32 v7, 14336, v4
    s_lshl_b32 s3, s61, 17
    s_lshl_b32 s67, s60, 15
    s_add_u32 s3, s3, s67
    s_add_u32 s84, s63, 0
    s_and_b32 s84, s84, 3
    s_lshl_b32 s80, s84, 8
    s_add_u32 s80, s80, s3
    s_add_u32 s85, s63, 1
    s_and_b32 s85, s85, 3
    s_lshl_b32 s81, s85, 8
    s_add_u32 s81, s81, s3
    s_add_u32 s86, s63, 2
    s_and_b32 s86, s86, 3
    s_lshl_b32 s82, s86, 8
    s_add_u32 s82, s82, s3
    s_add_u32 s87, s63, 3
    s_and_b32 s87, s87, 3
    s_lshl_b32 s83, s87, 8
    s_add_u32 s83, s83, s3
    s_mov_b32 s26, 2097152
    s_mov_b32 s27, 0x20000
    s_cmp_ge_u32 s62, 2
    s_cselect_b32 s68, 5, 4
    s_cselect_b32 s70, 0, 6
    s_mov_b32 s30, 1835008
    s_cmov_b32 s30, 1572864
    s_mov_b32 s95, 3584
    s_cmov_b32 s95, 3072
    s_lshl_b32 s68, s68, 14
    s_add_u32 s68, s68, s65
    s_mov_b32 m0, s68
    s_add_u32 s71, s80, 128
    s_waitcnt lgkmcnt(0)
    s_mov_b32 s24, s4
    s_and_b32 s25, s5, 0xffff
    buffer_load_dwordx4 v4, s[24:27], s80 offen offset:0 lds
    buffer_load_dwordx4 v5, s[24:27], s80 offen offset:1024 lds
    buffer_load_dwordx4 v6, s[24:27], s80 offen offset:2048 lds
    buffer_load_dwordx4 v7, s[24:27], s80 offen offset:3072 lds
    s_add_u32 m0, s68, 16384
    s_mov_b32 s31, 0x20000
    buffer_load_dwordx4 v4, s[24:27], s71 offen offset:0 lds
    buffer_load_dwordx4 v5, s[24:27], s71 offen offset:1024 lds
    buffer_load_dwordx4 v6, s[24:27], s71 offen offset:2048 lds
    buffer_load_dwordx4 v7, s[24:27], s71 offen offset:3072 lds
    s_lshl_b32 s3, s60, 5
    v_add_u32 v38, s3, v36
    v_mul_lo_u32 v38, v38, s95
    s_mul_i32 s88, s64, 896
    s_lshl_b32 s3, s64, 8
    s_add_u32 s3, s3, 768
    s_cmp_ge_u32 s62, 2
    s_cselect_b32 s28, s6, s12
    s_cselect_b32 s29, s7, s13
    s_cselect_b32 s88, s3, s88
    s_cselect_b32 s3, 1, 1
    s_cselect_b32 s67, 64, 64
    s_and_b32 s29, s29, 0xffff
    v_and_b32 v39, 1, v32
    v_lshlrev_b32 v39, s3, v39
    v_xor_b32 v39, v39, v37
    v_lshlrev_b32 v39, 4, v39
    v_add_u32 v8, v38, v39
    v_xor_b32 v39, s67, v39
    s_lshl_b32 s3, s95, 3
    s_sub_u32 s3, s3, 1024
    v_add3_u32 v9, v38, v39, s3
    s_lshl_b32 s3, s3, 1
    v_add_u32 v10, s3, v8
    v_add_u32 v11, s3, v9
    s_lshl_b32 s3, s62, 7
    s_add_u32 s88, s88, s3
    s_lshl_b32 s67, s95, 7
    s_mul_i32 s84, s84, s67
    s_mul_i32 s85, s85, s67
    s_mul_i32 s86, s86, s67
    s_mul_i32 s87, s87, s67
    s_lshl_b32 s70, s70, 14
    s_add_u32 m0, s70, s65
    s_add_u32 s71, s84, s88
    buffer_load_dwordx4 v8, s[28:31], s71 offen offset:0 lds
    buffer_load_dwordx4 v9, s[28:31], s71 offen offset:1024 lds
    buffer_load_dwordx4 v10, s[28:31], s71 offen offset:2048 lds
    buffer_load_dwordx4 v11, s[28:31], s71 offen offset:3072 lds
    s_add_u32 s52, s22, 33554432
    s_addc_u32 s53, s23, 0
    s_lshl_b32 s3, s61, 4
    s_add_u32 s54, s20, s3
    s_addc_u32 s55, s21, 0
    s_mov_b32 s32, s22
    s_and_b32 s33, s23, 0xffff
    s_mov_b32 s34, 37748736
    s_mov_b32 s35, 0x20000
    s_mov_b32 s40, s14
    s_and_b32 s41, s15, 0xffff
    s_mov_b32 s42, 1835008
    s_mov_b32 s43, 0x20000
    s_mov_b32 s44, s8
    s_and_b32 s45, s9, 0xffff
    s_mov_b32 s46, 524288
    s_mov_b32 s47, 0x20000
    s_mov_b32 s36, s18
    s_and_b32 s37, s19, 0xffff
    s_mov_b32 s38, 2097152
    s_mov_b32 s39, 0x20000
    s_mov_b32 s48, s16
    s_and_b32 s49, s17, 0xffff
    s_mov_b32 s50, 1024
    s_mov_b32 s51, 0x20000
    s_cmp_ge_u32 s62, 2
    s_cbranch_scc1 L_h_att
    s_lshl_b32 s3, s60, 8
    s_add_u32 m0, s3, 152576
    v_lshlrev_b32 v1, 2, v0
    buffer_load_dword v1, s[48:51], s3 offen lds
    s_add_u32 m0, s65, 114688
    s_add_u32 s71, s84, s88
    s_add_i32 s71, s71, 256
    buffer_load_dwordx4 v8, s[28:31], s71 offen offset:0 lds
    buffer_load_dwordx4 v9, s[28:31], s71 offen offset:1024 lds
    buffer_load_dwordx4 v10, s[28:31], s71 offen offset:2048 lds
    buffer_load_dwordx4 v11, s[28:31], s71 offen offset:3072 lds
    s_add_u32 m0, s65, 131072
    s_add_u32 s71, s81, 0
    buffer_load_dwordx4 v4, s[24:27], s71 offen offset:0 lds
    buffer_load_dwordx4 v5, s[24:27], s71 offen offset:1024 lds
    buffer_load_dwordx4 v6, s[24:27], s71 offen offset:2048 lds
    buffer_load_dwordx4 v7, s[24:27], s71 offen offset:3072 lds
    s_add_u32 m0, s65, 0
    s_add_u32 s71, s81, 128
    buffer_load_dwordx4 v4, s[24:27], s71 offen offset:0 lds
    buffer_load_dwordx4 v5, s[24:27], s71 offen offset:1024 lds
    buffer_load_dwordx4 v6, s[24:27], s71 offen offset:2048 lds
    buffer_load_dwordx4 v7, s[24:27], s71 offen offset:3072 lds
    s_waitcnt vmcnt(12)
    s_barrier
    s_add_u32 m0, s65, 16384
    s_add_u32 s71, s85, s88
    buffer_load_dwordx4 v8, s[28:31], s71 offen offset:0 lds
    buffer_load_dwordx4 v9, s[28:31], s71 offen offset:1024 lds
    buffer_load_dwordx4 v10, s[28:31], s71 offen offset:2048 lds
    buffer_load_dwordx4 v11, s[28:31], s71 offen offset:3072 lds
    s_add_u32 m0, s65, 32768
    s_add_u32 s71, s85, s88
    s_add_i32 s71, s71, 256
    buffer_load_dwordx4 v8, s[28:31], s71 offen offset:0 lds
    buffer_load_dwordx4 v9, s[28:31], s71 offen offset:1024 lds
    buffer_load_dwordx4 v10, s[28:31], s71 offen offset:2048 lds
    buffer_load_dwordx4 v11, s[28:31], s71 offen offset:3072 lds
    s_waitcnt vmcnt(16)
    s_barrier
    s_add_u32 m0, s65, 49152
    s_add_u32 s71, s82, 0
    buffer_load_dwordx4 v4, s[24:27], s71 offen offset:0 lds
    buffer_load_dwordx4 v5, s[24:27], s71 offen offset:1024 lds
    buffer_load_dwordx4 v6, s[24:27], s71 offen offset:2048 lds
    buffer_load_dwordx4 v7, s[24:27], s71 offen offset:3072 lds
    s_add_u32 m0, s65, 65536
    s_add_u32 s71, s82, 128
    buffer_load_dwordx4 v4, s[24:27], s71 offen offset:0 lds
    buffer_load_dwordx4 v5, s[24:27], s71 offen offset:1024 lds
    buffer_load_dwordx4 v6, s[24:27], s71 offen offset:2048 lds
    buffer_load_dwordx4 v7, s[24:27], s71 offen offset:3072 lds
    s_lshl_b32 s79, s60, 2
    s_mov_b32 s69, 400000
    s_and_b32 s66, s62, 1
    s_lshl_b32 s3, s62, 8
    s_lshr_b32 s67, s60, 1
    s_lshl_b32 s67, s67, 7
    s_add_u32 s3, s3, s67
    s_and_b32 s67, s60, 1
    s_lshl_b32 s67, s67, 15
    s_add_u32 s3, s3, s67
    s_mul_i32 s90, s64, 458752
    s_add_u32 s90, s90, s3
    s_lshl_b32 s91, s64, 17
    s_add_u32 s91, s91, s3
    s_lshl_b32 s93, s66, 16
    s_lshl_b32 s3, s61, 2
    s_add_u32 s3, s3, s64
    s_mul_i32 s89, s3, 147456
    s_lshl_b32 s67, s60, 11
    s_add_u32 s89, s89, s67
    s_lshl_b32 s75, s3, 2
    s_add_u32 s75, s75, s62
    s_lshl_b32 s75, s75, 2
    s_add_u32 s75, s75, s60
    s_lshl_b32 s75, s75, 7
    v_lshlrev_b32 v16, 4, v0
    v_and_b32 v17, 3, v0
    v_lshlrev_b32 v17, 2, v17
    v_add_u32 v17, 151552, v17
    v_lshrrev_b32 v1, 3, v0
    v_lshrrev_b32 v2, 4, v0
    v_lshlrev_b32 v2, 1, v2
    v_and_b32 v12, 7, v0
    v_xor_b32 v12, v12, v2
    v_lshlrev_b32 v12, 4, v12
    v_lshl_add_u32 v12, v1, 10, v12
    v_add_u32 v13, 7168, v12
    v_add_u32 v14, 14336, v12
    v_add_u32 v15, 21504, v12
    s_waitcnt vmcnt(12)
    s_barrier
    s_add_u32 m0, s65, 81920
    s_add_u32 s71, s86, s88
    buffer_load_dwordx4 v8, s[28:31], s71 offen offset:0 lds
    buffer_load_dwordx4 v9, s[28:31], s71 offen offset:1024 lds
    buffer_load_dwordx4 v10, s[28:31], s71 offen offset:2048 lds
    buffer_load_dwordx4 v11, s[28:31], s71 offen offset:3072 lds
    s_add_u32 m0, s65, 98304
    s_add_u32 s71, s86, s88
    s_add_i32 s71, s71, 256
    buffer_load_dwordx4 v8, s[28:31], s71 offen offset:0 lds
    buffer_load_dwordx4 v9, s[28:31], s71 offen offset:1024 lds
    buffer_load_dwordx4 v10, s[28:31], s71 offen offset:2048 lds
    buffer_load_dwordx4 v11, s[28:31], s71 offen offset:3072 lds
    s_waitcnt vmcnt(16)
    s_barrier
    s_add_u32 m0, s65, 114688
    s_add_u32 s71, s83, 0
    buffer_load_dwordx4 v4, s[24:27], s71 offen offset:0 lds
    buffer_load_dwordx4 v5, s[24:27], s71 offen offset:1024 lds
    buffer_load_dwordx4 v6, s[24:27], s71 offen offset:2048 lds
    buffer_load_dwordx4 v7, s[24:27], s71 offen offset:3072 lds
    s_add_u32 m0, s65, 131072
    s_add_u32 s71, s83, 128
    buffer_load_dwordx4 v4, s[24:27], s71 offen offset:0 lds
    buffer_load_dwordx4 v5, s[24:27], s71 offen offset:1024 lds
    buffer_load_dwordx4 v6, s[24:27], s71 offen offset:2048 lds
    buffer_load_dwordx4 v7, s[24:27], s71 offen offset:3072 lds
    s_waitcnt vmcnt(12)
    s_barrier
    s_add_u32 m0, s65, 0
    s_add_u32 s71, s87, s88
    buffer_load_dwordx4 v8, s[28:31], s71 offen offset:0 lds
    buffer_load_dwordx4 v9, s[28:31], s71 offen offset:1024 lds
    buffer_load_dwordx4 v10, s[28:31], s71 offen offset:2048 lds
    buffer_load_dwordx4 v11, s[28:31], s71 offen offset:3072 lds
    s_add_u32 m0, s65, 16384
    s_add_u32 s71, s87, s88
    s_add_i32 s71, s71, 256
    buffer_load_dwordx4 v8, s[28:31], s71 offen offset:0 lds
    buffer_load_dwordx4 v9, s[28:31], s71 offen offset:1024 lds
    buffer_load_dwordx4 v10, s[28:31], s71 offen offset:2048 lds
    buffer_load_dwordx4 v11, s[28:31], s71 offen offset:3072 lds
    s_waitcnt vmcnt(16)
    s_barrier
    s_add_u32 m0, s65, 32768
    s_add_u32 s71, s84, s88
    s_add_i32 s71, s71, 512
    buffer_load_dwordx4 v8, s[28:31], s71 offen offset:0 lds
    buffer_load_dwordx4 v9, s[28:31], s71 offen offset:1024 lds
    buffer_load_dwordx4 v10, s[28:31], s71 offen offset:2048 lds
    buffer_load_dwordx4 v11, s[28:31], s71 offen offset:3072 lds
    s_add_u32 m0, s65, 49152
    s_add_u32 s71, s85, s88
    s_add_i32 s71, s71, 512
    buffer_load_dwordx4 v8, s[28:31], s71 offen offset:0 lds
    buffer_load_dwordx4 v9, s[28:31], s71 offen offset:1024 lds
    buffer_load_dwordx4 v10, s[28:31], s71 offen offset:2048 lds
    buffer_load_dwordx4 v11, s[28:31], s71 offen offset:3072 lds
    s_waitcnt vmcnt(12)
    s_barrier
    s_add_u32 m0, s65, 65536
    s_add_u32 s71, s86, s88
    s_add_i32 s71, s71, 512
    buffer_load_dwordx4 v8, s[28:31], s71 offen offset:0 lds
    buffer_load_dwordx4 v9, s[28:31], s71 offen offset:1024 lds
    buffer_load_dwordx4 v10, s[28:31], s71 offen offset:2048 lds
    buffer_load_dwordx4 v11, s[28:31], s71 offen offset:3072 lds
    s_add_u32 m0, s65, 81920
    s_add_u32 s71, s87, s88
    s_add_i32 s71, s71, 512
    buffer_load_dwordx4 v8, s[28:31], s71 offen offset:0 lds
    buffer_load_dwordx4 v9, s[28:31], s71 offen offset:1024 lds
    buffer_load_dwordx4 v10, s[28:31], s71 offen offset:2048 lds
    buffer_load_dwordx4 v11, s[28:31], s71 offen offset:3072 lds
    s_lshl_b32 s3, s61, 2
    s_add_u32 s3, s3, s60
    s_mul_i32 s67, s3, 28672
    s_mul_i32 s68, s64, 896
    s_add_u32 s67, s67, s68
    v_and_b32 v1, 7, v0
    v_mul_u32_u24 v1, 3584, v1
    s_lshl_b32 s68, s66, 7
    s_add_u32 s68, s68, s67
    v_lshlrev_b32 v2, 7, v0
    s_mov_b64 exec, 0xff
    buffer_load_dword v18, v1, s[28:31], s68 offen offset:512
    s_mul_i32 s68, s66, 14336
    s_add_u32 s68, s68, s67
    s_mov_b64 exec, 0xf
    buffer_load_dword v18, v1, s[28:31], s68 offen offset:768
    s_lshl_b32 s3, s3, 2
    s_add_u32 s3, s3, s62
    s_mul_i32 s67, s3, 1792
    s_mul_i32 s68, s64, 458752
    s_add_u32 s67, s67, s68
    s_mov_b64 exec, 16383
    buffer_load_dword v18, v2, s[40:43], s67 offen
    s_lshl_b32 s67, s3, 9
    s_lshl_b32 s68, s64, 17
    s_add_u32 s67, s67, s68
    s_mov_b64 exec, 15
    buffer_load_dword v18, v2, s[44:47], s67 offen
    s_mov_b64 exec, -1
    s_waitcnt vmcnt(20)
    s_barrier
    s_cmp_eq_u32 s60, 0
    s_cbranch_scc0 L_w01
    s_load_dword s74, s[54:55], 0 glc
L_w01:
    v_lshrrev_b32 v1, 2, v0
    v_bfe_u32 v2, v0, 3, 2
    v_lshlrev_b32 v1, 7, v1
    v_lshl_add_u32 v1, v2, 5, v1
    v_and_b32 v2, 3, v0
    v_lshl_add_u32 v1, v2, 3, v1
    s_lshr_b32 s3, s64, 1
    s_lshl_b32 s3, s3, 13
    s_and_b32 s67, s64, 1
    s_lshl_b32 s67, s67, 6
    s_or_b32 s3, s3, s67
    v_xor_b32 v1, s3, v1
    v_xor_b32 v24, 8256, v1
    v_xor_b32 v25, 8288, v1
    v_xor_b32 v26, 8192, v1
    v_xor_b32 v27, 8224, v1
    v_xor_b32 v28, 64, v1
    v_xor_b32 v29, 96, v1
    v_xor_b32 v30, 0, v1
    v_xor_b32 v31, 32, v1
    s_lshl_b32 s92, s61, 2
    s_add_u32 s92, s92, s62
    s_mul_i32 s92, s92, 98304
    s_lshl_b32 s3, s60, 11
    s_add_u32 s92, s92, s3
    s_add_u32 s92, s92, 10485760
    s_waitcnt vmcnt(16)
    s_barrier
    s_waitcnt vmcnt(12)
    s_cmp_eq_u32 s60, 0
    s_cbranch_scc0 L_w02
    s_waitcnt lgkmcnt(0)
    s_cmp_ge_u32 s74, 16
    s_cbranch_scc0 L_pp3
L_po4:
L_w02:
    s_mov_b32 s74, 0
    s_barrier
    s_add_u32 m0, s65, 98304
    v_lshrrev_b32 v2, 2, v0
    v_and_b32 v2, 1, v2
    v_mul_u32_u24 v1, 917440, v2
    v_add_u32 v8, v8, v1
    v_add_u32 v10, v10, v1
    v_sub_u32 v1, 917440, v1
    v_add_u32 v9, v9, v1
    v_add_u32 v11, v11, v1
    v_mul_u32_u24 v2, 1835008, v2
    v_sub_u32 v4, 917504, v2
    s_cmp_ge_u32 s84, 917504
    s_cselect_b32 s3, 1, 0
    s_sub_u32 s67, 0, s3
    v_mad_i32_i24 v8, v4, s3, v8
    v_mad_i32_i24 v9, v4, s67, v9
    v_mad_i32_i24 v10, v4, s3, v10
    v_mad_i32_i24 v11, v4, s67, v11
    s_min_u32 s71, s84, s86
    s_add_u32 s71, s71, s88
    s_lshl_b32 s3, s62, 6
    s_sub_u32 s71, s71, s3
    s_add_u32 s71, s71, 768
    buffer_load_dwordx4 v8, s[28:31], s71 offen offset:0 lds
    buffer_load_dwordx4 v9, s[28:31], s71 offen offset:1024 lds
    buffer_load_dwordx4 v10, s[28:31], s71 offen offset:2048 lds
    buffer_load_dwordx4 v11, s[28:31], s71 offen offset:3072 lds
    s_waitcnt vmcnt(12)
    s_barrier
    s_lshl_b32 s68, s62, 2
    s_lshl_b32 s68, 1, s68
    s_xor_b32 s3, s75, 0
    s_atomic_or s68, s[52:53], s3
    s_xor_b32 s3, s75, 512
    s_atomic_or s68, s[52:53], s3
    s_xor_b32 s3, s75, 1024
    s_atomic_or s68, s[52:53], s3
    s_xor_b32 s3, s75, 1536
    s_atomic_or s68, s[52:53], s3
    s_add_u32 m0, s65, 114688
    s_cmp_ge_u32 s84, 917504
    s_cselect_b32 s67, 1, 0
    s_cmp_ge_u32 s85, 917504
    s_cselect_b32 s3, 1, 0
    s_sub_u32 s3, s3, s67
    s_sub_u32 s67, 0, s3
    v_mad_i32_i24 v8, v4, s3, v8
    v_mad_i32_i24 v9, v4, s67, v9
    v_mad_i32_i24 v10, v4, s3, v10
    v_mad_i32_i24 v11, v4, s67, v11
    s_min_u32 s71, s85, s87
    s_add_u32 s71, s71, s88
    s_lshl_b32 s3, s62, 6
    s_sub_u32 s71, s71, s3
    s_add_u32 s71, s71, 768
    buffer_load_dwordx4 v8, s[28:31], s71 offen offset:0 lds
    buffer_load_dwordx4 v9, s[28:31], s71 offen offset:1024 lds
    buffer_load_dwordx4 v10, s[28:31], s71 offen offset:2048 lds
    buffer_load_dwordx4 v11, s[28:31], s71 offen offset:3072 lds
    s_waitcnt vmcnt(12)
    s_barrier
    s_lshl_b32 s68, s62, 2
    s_lshl_b32 s68, 2, s68
    s_xor_b32 s3, s75, 0
    s_atomic_or s68, s[52:53], s3
    s_xor_b32 s3, s75, 512
    s_atomic_or s68, s[52:53], s3
    s_xor_b32 s3, s75, 1024
    s_atomic_or s68, s[52:53], s3
    s_xor_b32 s3, s75, 1536
    s_atomic_or s68, s[52:53], s3
    s_add_u32 m0, s65, 0
    s_add_u32 s71, s90, 0
    buffer_load_dwordx4 v12, s[40:43], s71 offen offset:0 lds
    buffer_load_dwordx4 v13, s[40:43], s71 offen offset:1024 lds
    buffer_load_dwordx4 v14, s[40:43], s71 offen offset:2048 lds
    buffer_load_dwordx4 v15, s[40:43], s71 offen offset:3072 lds
    s_add_u32 m0, s65, 16384
    s_add_u32 s71, s90, 65536
    buffer_load_dwordx4 v12, s[40:43], s71 offen offset:0 lds
    buffer_load_dwordx4 v13, s[40:43], s71 offen offset:1024 lds
    buffer_load_dwordx4 v14, s[40:43], s71 offen offset:2048 lds
    buffer_load_dwordx4 v15, s[40:43], s71 offen offset:3072 lds
    s_load_dword s74, s[52:53], s75 glc
    s_waitcnt vmcnt(12)
    s_barrier
    s_andn2_b32 s70, 17, s74
    s_cbranch_scc1 L_pl6
L_pk5:
    s_add_u32 s67, s89, 0
    buffer_load_dwordx4 a[0:3], v16, s[32:35], s67 offen offset:0 sc1
    buffer_load_dwordx4 a[4:7], v16, s[32:35], s67 offen offset:1024 sc1
    s_add_u32 s67, s89, 8192
    buffer_load_dwordx4 a[8:11], v16, s[32:35], s67 offen offset:0 sc1
    buffer_load_dwordx4 a[12:15], v16, s[32:35], s67 offen offset:1024 sc1
    s_load_dword s74, s[52:53], s75 glc
    s_waitcnt vmcnt(12)
    s_barrier
    s_add_u32 s67, s89, 16384
    buffer_load_dwordx4 a[16:19], v16, s[32:35], s67 offen offset:0 sc1
    buffer_load_dwordx4 a[20:23], v16, s[32:35], s67 offen offset:1024 sc1
    s_add_u32 s67, s89, 24576
    buffer_load_dwordx4 a[24:27], v16, s[32:35], s67 offen offset:0 sc1
    buffer_load_dwordx4 a[28:31], v16, s[32:35], s67 offen offset:1024 sc1
    s_add_u32 m0, s65, 32768
    s_add_u32 s71, s90, 131072
    buffer_load_dwordx4 v12, s[40:43], s71 offen offset:0 lds
    buffer_load_dwordx4 v13, s[40:43], s71 offen offset:1024 lds
    buffer_load_dwordx4 v14, s[40:43], s71 offen offset:2048 lds
    buffer_load_dwordx4 v15, s[40:43], s71 offen offset:3072 lds
    s_add_u32 m0, s79, 151552
    s_mov_b64 exec, 1
    buffer_load_dword v16, s[44:47], s46 offen lds
    s_mov_b64 exec, -1
    s_waitcnt vmcnt(13)
    s_barrier
    s_andn2_b32 s70, 34, s74
    s_cbranch_scc1 L_pl8
L_pk7:
    s_setprio 1
    ds_read_b64_tr_b16 v[32:33], v24 offset:0
    ds_read_b64_tr_b16 v[34:35], v24 offset:2048
    ds_read_b64_tr_b16 v[36:37], v25 offset:0
    ds_read_b64_tr_b16 v[38:39], v25 offset:2048
    ds_read_b64_tr_b16 v[40:41], v26 offset:0
    ds_read_b64_tr_b16 v[42:43], v26 offset:2048
    ds_read_b64_tr_b16 v[44:45], v27 offset:0
    ds_read_b64_tr_b16 v[46:47], v27 offset:2048
    ds_read_b64_tr_b16 v[48:49], v28 offset:0
    ds_read_b64_tr_b16 v[50:51], v28 offset:2048
    s_waitcnt vmcnt(11)
    s_waitcnt lgkmcnt(6)
    v_mfma_f32_16x16x32_bf16 v[64:67], v[32:35], a[0:3], 0
    ds_read_b64_tr_b16 v[52:53], v29 offset:0
    v_mfma_f32_16x16x32_bf16 v[72:75], v[32:35], a[4:7], 0
    ds_read_b64_tr_b16 v[54:55], v29 offset:2048
    v_mfma_f32_16x16x32_bf16 v[68:71], v[36:39], a[0:3], 0
    ds_read_b64_tr_b16 v[12:13], v30 offset:0
    s_add_u32 s88, s89, 32768
    buffer_load_dwordx4 a[32:35], v16, s[32:35], s88 offen sc1
    v_mfma_f32_16x16x32_bf16 v[76:79], v[36:39], a[4:7], 0
    ds_read_b64_tr_b16 v[14:15], v30 offset:2048
    buffer_load_dwordx4 a[36:39], v16, s[32:35], s88 offen offset:1024 sc1
    s_waitcnt lgkmcnt(6)
    v_mfma_f32_16x16x32_bf16 v[80:83], v[40:43], a[0:3], 0
    ds_read_b64_tr_b16 v[32:33], v31 offset:0
    s_add_u32 s88, s89, 40960
    buffer_load_dwordx4 a[40:43], v16, s[32:35], s88 offen sc1
    v_mfma_f32_16x16x32_bf16 v[88:91], v[40:43], a[4:7], 0
    ds_read_b64_tr_b16 v[34:35], v31 offset:2048
    buffer_load_dwordx4 a[44:47], v16, s[32:35], s88 offen offset:1024 sc1
    v_mfma_f32_16x16x32_bf16 v[84:87], v[44:47], a[0:3], 0
    ds_read_b64_tr_b16 v[36:37], v24 offset:4096
    s_add_u32 s88, s89, 49152
    buffer_load_dwordx4 a[48:51], v16, s[32:35], s88 offen sc1
    v_mfma_f32_16x16x32_bf16 v[92:95], v[44:47], a[4:7], 0
    ds_read_b64_tr_b16 v[38:39], v24 offset:6144
    buffer_load_dwordx4 a[52:55], v16, s[32:35], s88 offen offset:1024 sc1
    s_waitcnt lgkmcnt(6)
    v_mfma_f32_16x16x32_bf16 v[96:99], v[48:51], a[0:3], 0
    ds_read_b64_tr_b16 v[40:41], v25 offset:4096
    s_add_u32 s88, s89, 57344
    buffer_load_dwordx4 a[56:59], v16, s[32:35], s88 offen sc1
    v_mfma_f32_16x16x32_bf16 v[104:107], v[48:51], a[4:7], 0
    ds_read_b64_tr_b16 v[42:43], v25 offset:6144
    buffer_load_dwordx4 a[60:63], v16, s[32:35], s88 offen offset:1024 sc1
    v_mfma_f32_16x16x32_bf16 v[100:103], v[52:55], a[0:3], 0
    ds_read_b64_tr_b16 v[44:45], v26 offset:4096
    v_mfma_f32_16x16x32_bf16 v[108:111], v[52:55], a[4:7], 0
    ds_read_b64_tr_b16 v[46:47], v26 offset:6144
    s_waitcnt lgkmcnt(6)
    v_mfma_f32_16x16x32_bf16 v[112:115], v[12:15], a[0:3], 0
    ds_read_b64_tr_b16 v[48:49], v27 offset:4096
    v_mfma_f32_16x16x32_bf16 v[120:123], v[12:15], a[4:7], 0
    ds_read_b64_tr_b16 v[50:51], v27 offset:6144
    v_mfma_f32_16x16x32_bf16 v[116:119], v[32:35], a[0:3], 0
    ds_read_b64_tr_b16 v[52:53], v28 offset:4096
    v_mfma_f32_16x16x32_bf16 v[124:127], v[32:35], a[4:7], 0
    ds_read_b64_tr_b16 v[54:55], v28 offset:6144
    s_waitcnt vmcnt(17)
    s_waitcnt lgkmcnt(6)
    v_mfma_f32_16x16x32_bf16 v[64:67], v[36:39], a[8:11], v[64:67]
    ds_read_b64_tr_b16 v[12:13], v29 offset:4096
    v_mfma_f32_16x16x32_bf16 v[72:75], v[36:39], a[12:15], v[72:75]
    ds_read_b64_tr_b16 v[14:15], v29 offset:6144
    v_mfma_f32_16x16x32_bf16 v[68:71], v[40:43], a[8:11], v[68:71]
    ds_read_b64_tr_b16 v[32:33], v30 offset:4096
    v_mfma_f32_16x16x32_bf16 v[76:79], v[40:43], a[12:15], v[76:79]
    ds_read_b64_tr_b16 v[34:35], v30 offset:6144
    s_waitcnt lgkmcnt(6)
    v_mfma_f32_16x16x32_bf16 v[80:83], v[44:47], a[8:11], v[80:83]
    ds_read_b64_tr_b16 v[36:37], v31 offset:4096
    v_mfma_f32_16x16x32_bf16 v[88:91], v[44:47], a[12:15], v[88:91]
    ds_read_b64_tr_b16 v[38:39], v31 offset:6144
    v_mfma_f32_16x16x32_bf16 v[84:87], v[48:51], a[8:11], v[84:87]
    ds_read_b64_tr_b16 v[40:41], v24 offset:16384
    v_mfma_f32_16x16x32_bf16 v[92:95], v[48:51], a[12:15], v[92:95]
    ds_read_b64_tr_b16 v[42:43], v24 offset:18432
    s_waitcnt lgkmcnt(6)
    v_mfma_f32_16x16x32_bf16 v[96:99], v[52:55], a[8:11], v[96:99]
    ds_read_b64_tr_b16 v[44:45], v25 offset:16384
    v_mfma_f32_16x16x32_bf16 v[104:107], v[52:55], a[12:15], v[104:107]
    ds_read_b64_tr_b16 v[46:47], v25 offset:18432
    v_mfma_f32_16x16x32_bf16 v[100:103], v[12:15], a[8:11], v[100:103]
    ds_read_b64_tr_b16 v[48:49], v26 offset:16384
    v_mfma_f32_16x16x32_bf16 v[108:111], v[12:15], a[12:15], v[108:111]
    ds_read_b64_tr_b16 v[50:51], v26 offset:18432
    s_waitcnt lgkmcnt(6)
    v_mfma_f32_16x16x32_bf16 v[112:115], v[32:35], a[8:11], v[112:115]
    ds_read_b64_tr_b16 v[52:53], v27 offset:16384
    v_mfma_f32_16x16x32_bf16 v[120:123], v[32:35], a[12:15], v[120:123]
    ds_read_b64_tr_b16 v[54:55], v27 offset:18432
    v_mfma_f32_16x16x32_bf16 v[116:119], v[36:39], a[8:11], v[116:119]
    ds_read_b64_tr_b16 v[12:13], v28 offset:16384
    v_mfma_f32_16x16x32_bf16 v[124:127], v[36:39], a[12:15], v[124:127]
    ds_read_b64_tr_b16 v[14:15], v28 offset:18432
    s_load_dword s74, s[52:53], s75 glc
    s_waitcnt vmcnt(15)
    s_waitcnt lgkmcnt(6)
    v_mfma_f32_16x16x32_bf16 v[64:67], v[40:43], a[16:19], v[64:67]
    ds_read_b64_tr_b16 v[32:33], v29 offset:16384
    v_mfma_f32_16x16x32_bf16 v[72:75], v[40:43], a[20:23], v[72:75]
    ds_read_b64_tr_b16 v[34:35], v29 offset:18432
    v_mfma_f32_16x16x32_bf16 v[68:71], v[44:47], a[16:19], v[68:71]
    ds_read_b64_tr_b16 v[36:37], v24 offset:20480
    v_mfma_f32_16x16x32_bf16 v[76:79], v[44:47], a[20:23], v[76:79]
    ds_read_b64_tr_b16 v[38:39], v24 offset:22528
    s_waitcnt lgkmcnt(6)
    v_mfma_f32_16x16x32_bf16 v[80:83], v[48:51], a[16:19], v[80:83]
    ds_read_b64_tr_b16 v[40:41], v25 offset:20480
    v_mfma_f32_16x16x32_bf16 v[88:91], v[48:51], a[20:23], v[88:91]
    ds_read_b64_tr_b16 v[42:43], v25 offset:22528
    v_mfma_f32_16x16x32_bf16 v[84:87], v[52:55], a[16:19], v[84:87]
    ds_read_b64_tr_b16 v[44:45], v26 offset:20480
    v_mfma_f32_16x16x32_bf16 v[92:95], v[52:55], a[20:23], v[92:95]
    ds_read_b64_tr_b16 v[46:47], v26 offset:22528
    s_waitcnt lgkmcnt(6)
    v_mfma_f32_16x16x32_bf16 v[96:99], v[12:15], a[16:19], v[96:99]
    ds_read_b64_tr_b16 v[48:49], v27 offset:20480
    v_mfma_f32_16x16x32_bf16 v[104:107], v[12:15], a[20:23], v[104:107]
    ds_read_b64_tr_b16 v[50:51], v27 offset:22528
    ds_read_b32 v3, v17 offset:0
    v_mfma_f32_16x16x32_bf16 v[100:103], v[32:35], a[16:19], v[100:103]
    ds_read_b64_tr_b16 v[52:53], v28 offset:20480
    v_mfma_f32_16x16x32_bf16 v[108:111], v[32:35], a[20:23], v[108:111]
    ds_read_b64_tr_b16 v[54:55], v28 offset:22528
    s_waitcnt vmcnt(13)
    s_waitcnt lgkmcnt(7)
    v_mfma_f32_16x16x32_bf16 v[64:67], v[36:39], a[24:27], v[64:67]
    ds_read_b64_tr_b16 v[12:13], v29 offset:20480
    v_mfma_f32_16x16x32_bf16 v[72:75], v[36:39], a[28:31], v[72:75]
    ds_read_b64_tr_b16 v[14:15], v29 offset:22528
    v_mfma_f32_16x16x32_bf16 v[68:71], v[40:43], a[24:27], v[68:71]
    s_waitcnt lgkmcnt(4)
    v_cmp_ne_u32 vcc, 0, v3
    s_cbranch_vccnz L_sp15
L_ok14:
    ds_read_b64_tr_b16 v[32:33], v24 offset:32768
    v_mfma_f32_16x16x32_bf16 v[76:79], v[40:43], a[28:31], v[76:79]
    ds_read_b64_tr_b16 v[34:35], v24 offset:34816
    v_mfma_f32_16x16x32_bf16 v[80:83], v[44:47], a[24:27], v[80:83]
    ds_read_b64_tr_b16 v[36:37], v25 offset:32768
    v_mfma_f32_16x16x32_bf16 v[88:91], v[44:47], a[28:31], v[88:91]
    ds_read_b64_tr_b16 v[38:39], v25 offset:34816
    s_lshl_b32 s3, s61, 2
    s_add_u32 s3, s3, s64
    s_lshl_b32 s3, s3, 12
    s_lshr_b32 s67, s65, 2
    s_add_u32 s3, s3, s67
    s_add_u32 s3, s3, 9961472
    buffer_load_dwordx4 v[20:23], v16, s[32:35], s3 offen sc1
    v_mfma_f32_16x16x32_bf16 v[84:87], v[48:51], a[24:27], v[84:87]
    ds_read_b64_tr_b16 v[40:41], v26 offset:32768
    v_mfma_f32_16x16x32_bf16 v[92:95], v[48:51], a[28:31], v[92:95]
    ds_read_b64_tr_b16 v[42:43], v26 offset:34816
    s_waitcnt lgkmcnt(6)
    v_mfma_f32_16x16x32_bf16 v[96:99], v[52:55], a[24:27], v[96:99]
    ds_read_b64_tr_b16 v[44:45], v27 offset:32768
    v_mfma_f32_16x16x32_bf16 v[104:107], v[52:55], a[28:31], v[104:107]
    ds_read_b64_tr_b16 v[46:47], v27 offset:34816
    v_mfma_f32_16x16x32_bf16 v[100:103], v[12:15], a[24:27], v[100:103]
    ds_read_b64_tr_b16 v[48:49], v28 offset:32768
    v_mfma_f32_16x16x32_bf16 v[108:111], v[12:15], a[28:31], v[108:111]
    ds_read_b64_tr_b16 v[50:51], v28 offset:34816
    s_waitcnt vmcnt(7)
    s_waitcnt lgkmcnt(6)
    v_mfma_f32_16x16x32_bf16 v[64:67], v[32:35], a[32:35], v[64:67]
    ds_read_b64_tr_b16 v[52:53], v29 offset:32768
    v_mfma_f32_16x16x32_bf16 v[72:75], v[32:35], a[36:39], v[72:75]
    ds_read_b64_tr_b16 v[54:55], v29 offset:34816
    v_mfma_f32_16x16x32_bf16 v[68:71], v[36:39], a[32:35], v[68:71]
    ds_read_b64_tr_b16 v[12:13], v24 offset:36864
    v_mfma_f32_16x16x32_bf16 v[76:79], v[36:39], a[36:39], v[76:79]
    ds_read_b64_tr_b16 v[14:15], v24 offset:38912
    s_waitcnt lgkmcnt(6)
    v_mfma_f32_16x16x32_bf16 v[80:83], v[40:43], a[32:35], v[80:83]
    ds_read_b64_tr_b16 v[32:33], v25 offset:36864
    v_mfma_f32_16x16x32_bf16 v[88:91], v[40:43], a[36:39], v[88:91]
    ds_read_b64_tr_b16 v[34:35], v25 offset:38912
    s_andn2_b32 s70, 68, s74
    s_cbranch_scc1 L_pl17
L_pk16:
    v_mfma_f32_16x16x32_bf16 v[84:87], v[44:47], a[32:35], v[84:87]
    ds_read_b64_tr_b16 v[36:37], v26 offset:36864
    s_add_u32 s88, s89, 65536
    buffer_load_dwordx4 a[64:67], v16, s[32:35], s88 offen sc1
    v_mfma_f32_16x16x32_bf16 v[92:95], v[44:47], a[36:39], v[92:95]
    ds_read_b64_tr_b16 v[38:39], v26 offset:38912
    buffer_load_dwordx4 a[68:71], v16, s[32:35], s88 offen offset:1024 sc1
    s_waitcnt lgkmcnt(6)
    v_mfma_f32_16x16x32_bf16 v[96:99], v[48:51], a[32:35], v[96:99]
    ds_read_b64_tr_b16 v[40:41], v27 offset:36864
    s_add_u32 s88, s89, 73728
    buffer_load_dwordx4 a[72:75], v16, s[32:35], s88 offen sc1
    v_mfma_f32_16x16x32_bf16 v[104:107], v[48:51], a[36:39], v[104:107]
    ds_read_b64_tr_b16 v[42:43], v27 offset:38912
    ds_read_b32 v3, v17 offset:16
    buffer_load_dwordx4 a[76:79], v16, s[32:35], s88 offen offset:1024 sc1
    v_mfma_f32_16x16x32_bf16 v[100:103], v[52:55], a[32:35], v[100:103]
    ds_read_b64_tr_b16 v[44:45], v28 offset:36864
    s_add_u32 s88, s89, 81920
    buffer_load_dwordx4 a[80:83], v16, s[32:35], s88 offen sc1
    v_mfma_f32_16x16x32_bf16 v[108:111], v[52:55], a[36:39], v[108:111]
    ds_read_b64_tr_b16 v[46:47], v28 offset:38912
    buffer_load_dwordx4 a[84:87], v16, s[32:35], s88 offen offset:1024 sc1
    s_waitcnt vmcnt(11)
    s_waitcnt lgkmcnt(7)
    v_mfma_f32_16x16x32_bf16 v[64:67], v[12:15], a[40:43], v[64:67]
    ds_read_b64_tr_b16 v[48:49], v29 offset:36864
    s_add_u32 s88, s89, 90112
    buffer_load_dwordx4 a[88:91], v16, s[32:35], s88 offen sc1
    v_mfma_f32_16x16x32_bf16 v[72:75], v[12:15], a[44:47], v[72:75]
    ds_read_b64_tr_b16 v[50:51], v29 offset:38912
    buffer_load_dwordx4 a[92:95], v16, s[32:35], s88 offen offset:1024 sc1
    v_mfma_f32_16x16x32_bf16 v[68:71], v[32:35], a[40:43], v[68:71]
    s_waitcnt lgkmcnt(4)
    v_cmp_ne_u32 vcc, 0, v3
    s_cbranch_vccnz L_sp19
L_ok18:
    ds_read_b64_tr_b16 v[52:53], v24 offset:49152
    v_mfma_f32_16x16x32_bf16 v[76:79], v[32:35], a[44:47], v[76:79]
    ds_read_b64_tr_b16 v[54:55], v24 offset:51200
    v_mfma_f32_16x16x32_bf16 v[80:83], v[36:39], a[40:43], v[80:83]
    ds_read_b64_tr_b16 v[12:13], v25 offset:49152
    v_mfma_f32_16x16x32_bf16 v[88:91], v[36:39], a[44:47], v[88:91]
    ds_read_b64_tr_b16 v[14:15], v25 offset:51200
    v_mfma_f32_16x16x32_bf16 v[84:87], v[40:43], a[40:43], v[84:87]
    ds_read_b64_tr_b16 v[32:33], v26 offset:49152
    v_mfma_f32_16x16x32_bf16 v[92:95], v[40:43], a[44:47], v[92:95]
    ds_read_b64_tr_b16 v[34:35], v26 offset:51200
    s_load_dword s74, s[52:53], s75 glc
    s_waitcnt lgkmcnt(6)
    v_mfma_f32_16x16x32_bf16 v[96:99], v[44:47], a[40:43], v[96:99]
    ds_read_b64_tr_b16 v[36:37], v27 offset:49152
    v_mfma_f32_16x16x32_bf16 v[104:107], v[44:47], a[44:47], v[104:107]
    ds_read_b64_tr_b16 v[38:39], v27 offset:51200
    v_mfma_f32_16x16x32_bf16 v[100:103], v[48:51], a[40:43], v[100:103]
    ds_read_b64_tr_b16 v[40:41], v28 offset:49152
    v_mfma_f32_16x16x32_bf16 v[108:111], v[48:51], a[44:47], v[108:111]
    ds_read_b64_tr_b16 v[42:43], v28 offset:51200
    s_waitcnt vmcnt(11)
    s_waitcnt lgkmcnt(6)
    v_mfma_f32_16x16x32_bf16 v[64:67], v[52:55], a[48:51], v[64:67]
    ds_read_b64_tr_b16 v[44:45], v29 offset:49152
    v_mfma_f32_16x16x32_bf16 v[72:75], v[52:55], a[52:55], v[72:75]
    ds_read_b64_tr_b16 v[46:47], v29 offset:51200
    v_mfma_f32_16x16x32_bf16 v[68:71], v[12:15], a[48:51], v[68:71]
    ds_read_b64_tr_b16 v[48:49], v24 offset:53248
    v_mfma_f32_16x16x32_bf16 v[76:79], v[12:15], a[52:55], v[76:79]
    ds_read_b64_tr_b16 v[50:51], v24 offset:55296
    s_waitcnt lgkmcnt(6)
    v_mfma_f32_16x16x32_bf16 v[80:83], v[32:35], a[48:51], v[80:83]
    ds_read_b64_tr_b16 v[52:53], v25 offset:53248
    v_mfma_f32_16x16x32_bf16 v[88:91], v[32:35], a[52:55], v[88:91]
    ds_read_b64_tr_b16 v[54:55], v25 offset:55296
    v_mfma_f32_16x16x32_bf16 v[84:87], v[36:39], a[48:51], v[84:87]
    ds_read_b64_tr_b16 v[12:13], v26 offset:53248
    v_mfma_f32_16x16x32_bf16 v[92:95], v[36:39], a[52:55], v[92:95]
    ds_read_b64_tr_b16 v[14:15], v26 offset:55296
    s_waitcnt lgkmcnt(6)
    v_mfma_f32_16x16x32_bf16 v[96:99], v[40:43], a[48:51], v[96:99]
    ds_read_b64_tr_b16 v[32:33], v27 offset:53248
    v_mfma_f32_16x16x32_bf16 v[104:107], v[40:43], a[52:55], v[104:107]
    ds_read_b64_tr_b16 v[34:35], v27 offset:55296
    ds_read_b32 v3, v17 offset:32
    v_mfma_f32_16x16x32_bf16 v[100:103], v[44:47], a[48:51], v[100:103]
    ds_read_b64_tr_b16 v[36:37], v28 offset:53248
    v_mfma_f32_16x16x32_bf16 v[108:111], v[44:47], a[52:55], v[108:111]
    ds_read_b64_tr_b16 v[38:39], v28 offset:55296
    s_waitcnt vmcnt(9)
    s_waitcnt lgkmcnt(7)
    v_mfma_f32_16x16x32_bf16 v[64:67], v[48:51], a[56:59], v[64:67]
    ds_read_b64_tr_b16 v[40:41], v29 offset:53248
    v_mfma_f32_16x16x32_bf16 v[72:75], v[48:51], a[60:63], v[72:75]
    ds_read_b64_tr_b16 v[42:43], v29 offset:55296
    v_mfma_f32_16x16x32_bf16 v[68:71], v[52:55], a[56:59], v[68:71]
    s_waitcnt lgkmcnt(4)
    v_cmp_ne_u32 vcc, 0, v3
    s_cbranch_vccnz L_sp21
L_ok20:
    v_add_u32 v24, 65536, v24
    ds_read_b64_tr_b16 v[44:45], v24 offset:0
    v_mfma_f32_16x16x32_bf16 v[76:79], v[52:55], a[60:63], v[76:79]
    ds_read_b64_tr_b16 v[46:47], v24 offset:2048
    v_mfma_f32_16x16x32_bf16 v[80:83], v[12:15], a[56:59], v[80:83]
    v_add_u32 v25, 65536, v25
    ds_read_b64_tr_b16 v[48:49], v25 offset:0
    v_mfma_f32_16x16x32_bf16 v[88:91], v[12:15], a[60:63], v[88:91]
    ds_read_b64_tr_b16 v[50:51], v25 offset:2048
    v_mfma_f32_16x16x32_bf16 v[84:87], v[32:35], a[56:59], v[84:87]
    v_add_u32 v26, 65536, v26
    ds_read_b64_tr_b16 v[52:53], v26 offset:0
    v_mfma_f32_16x16x32_bf16 v[92:95], v[32:35], a[60:63], v[92:95]
    ds_read_b64_tr_b16 v[54:55], v26 offset:2048
    s_waitcnt lgkmcnt(6)
    v_mfma_f32_16x16x32_bf16 v[96:99], v[36:39], a[56:59], v[96:99]
    v_add_u32 v27, 65536, v27
    ds_read_b64_tr_b16 v[12:13], v27 offset:0
    v_mfma_f32_16x16x32_bf16 v[104:107], v[36:39], a[60:63], v[104:107]
    ds_read_b64_tr_b16 v[14:15], v27 offset:2048
    v_mfma_f32_16x16x32_bf16 v[100:103], v[40:43], a[56:59], v[100:103]
    v_add_u32 v28, 65536, v28
    ds_read_b64_tr_b16 v[32:33], v28 offset:0
    v_mfma_f32_16x16x32_bf16 v[108:111], v[40:43], a[60:63], v[108:111]
    ds_read_b64_tr_b16 v[34:35], v28 offset:2048
    s_waitcnt vmcnt(6)
    s_waitcnt lgkmcnt(6)
    v_mfma_f32_16x16x32_bf16 v[64:67], v[44:47], a[64:67], v[64:67]
    v_add_u32 v29, 65536, v29
    ds_read_b64_tr_b16 v[36:37], v29 offset:0
    v_mfma_f32_16x16x32_bf16 v[72:75], v[44:47], a[68:71], v[72:75]
    ds_read_b64_tr_b16 v[38:39], v29 offset:2048
    s_andn2_b32 s70, 136, s74
    s_cbranch_scc1 L_pl23
L_pk22:
    v_mfma_f32_16x16x32_bf16 v[68:71], v[48:51], a[64:67], v[68:71]
    ds_read_b64_tr_b16 v[40:41], v24 offset:4096
    s_add_u32 s88, s89, 98304
    buffer_load_dwordx4 a[96:99], v16, s[32:35], s88 offen sc1
    v_mfma_f32_16x16x32_bf16 v[76:79], v[48:51], a[68:71], v[76:79]
    ds_read_b64_tr_b16 v[42:43], v24 offset:6144
    buffer_load_dwordx4 a[100:103], v16, s[32:35], s88 offen offset:1024 sc1
    s_load_dword s74, s[52:53], s75 glc
    s_waitcnt lgkmcnt(6)
    v_mfma_f32_16x16x32_bf16 v[80:83], v[52:55], a[64:67], v[80:83]
    ds_read_b64_tr_b16 v[44:45], v25 offset:4096
    s_add_u32 s88, s89, 106496
    buffer_load_dwordx4 a[104:107], v16, s[32:35], s88 offen sc1
    v_mfma_f32_16x16x32_bf16 v[88:91], v[52:55], a[68:71], v[88:91]
    ds_read_b64_tr_b16 v[46:47], v25 offset:6144
    buffer_load_dwordx4 a[108:111], v16, s[32:35], s88 offen offset:1024 sc1
    v_mfma_f32_16x16x32_bf16 v[84:87], v[12:15], a[64:67], v[84:87]
    ds_read_b64_tr_b16 v[48:49], v26 offset:4096
    v_mfma_f32_16x16x32_bf16 v[92:95], v[12:15], a[68:71], v[92:95]
    ds_read_b64_tr_b16 v[50:51], v26 offset:6144
    s_waitcnt lgkmcnt(6)
    v_mfma_f32_16x16x32_bf16 v[96:99], v[32:35], a[64:67], v[96:99]
    ds_read_b64_tr_b16 v[52:53], v27 offset:4096
    v_mfma_f32_16x16x32_bf16 v[104:107], v[32:35], a[68:71], v[104:107]
    ds_read_b64_tr_b16 v[54:55], v27 offset:6144
    ds_read_b32 v3, v17 offset:48
    v_mfma_f32_16x16x32_bf16 v[100:103], v[36:39], a[64:67], v[100:103]
    ds_read_b64_tr_b16 v[12:13], v28 offset:4096
    v_mfma_f32_16x16x32_bf16 v[108:111], v[36:39], a[68:71], v[108:111]
    ds_read_b64_tr_b16 v[14:15], v28 offset:6144
    s_waitcnt vmcnt(8)
    s_waitcnt lgkmcnt(7)
    v_mfma_f32_16x16x32_bf16 v[64:67], v[40:43], a[72:75], v[64:67]
    ds_read_b64_tr_b16 v[32:33], v29 offset:4096
    v_mfma_f32_16x16x32_bf16 v[72:75], v[40:43], a[76:79], v[72:75]
    ds_read_b64_tr_b16 v[34:35], v29 offset:6144
    v_mfma_f32_16x16x32_bf16 v[68:71], v[44:47], a[72:75], v[68:71]
    s_waitcnt lgkmcnt(4)
    v_cmp_ne_u32 vcc, 0, v3
    s_cbranch_vccnz L_sp25
L_ok24:
    ds_read_b64_tr_b16 v[36:37], v24 offset:16384
    v_mfma_f32_16x16x32_bf16 v[76:79], v[44:47], a[76:79], v[76:79]
    ds_read_b64_tr_b16 v[38:39], v24 offset:18432
    v_mfma_f32_16x16x32_bf16 v[80:83], v[48:51], a[72:75], v[80:83]
    ds_read_b64_tr_b16 v[40:41], v25 offset:16384
    v_mfma_f32_16x16x32_bf16 v[88:91], v[48:51], a[76:79], v[88:91]
    ds_read_b64_tr_b16 v[42:43], v25 offset:18432
    v_mfma_f32_16x16x32_bf16 v[84:87], v[52:55], a[72:75], v[84:87]
    ds_read_b64_tr_b16 v[44:45], v26 offset:16384
    v_mfma_f32_16x16x32_bf16 v[92:95], v[52:55], a[76:79], v[92:95]
    ds_read_b64_tr_b16 v[46:47], v26 offset:18432
    s_waitcnt lgkmcnt(6)
    v_mfma_f32_16x16x32_bf16 v[96:99], v[12:15], a[72:75], v[96:99]
    ds_read_b64_tr_b16 v[48:49], v27 offset:16384
    v_mfma_f32_16x16x32_bf16 v[104:107], v[12:15], a[76:79], v[104:107]
    ds_read_b64_tr_b16 v[50:51], v27 offset:18432
    v_mfma_f32_16x16x32_bf16 v[100:103], v[32:35], a[72:75], v[100:103]
    ds_read_b64_tr_b16 v[52:53], v28 offset:16384
    v_mfma_f32_16x16x32_bf16 v[108:111], v[32:35], a[76:79], v[108:111]
    ds_read_b64_tr_b16 v[54:55], v28 offset:18432
    s_waitcnt vmcnt(6)
    s_waitcnt lgkmcnt(6)
    v_mfma_f32_16x16x32_bf16 v[64:67], v[36:39], a[80:83], v[64:67]
    ds_read_b64_tr_b16 v[12:13], v29 offset:16384
    v_mfma_f32_16x16x32_bf16 v[72:75], v[36:39], a[84:87], v[72:75]
    ds_read_b64_tr_b16 v[14:15], v29 offset:18432
    s_andn2_b32 s70, 768, s74
    s_cbranch_scc1 L_pl27
L_pk26:
    v_mfma_f32_16x16x32_bf16 v[68:71], v[40:43], a[80:83], v[68:71]
    ds_read_b64_tr_b16 v[32:33], v24 offset:20480
    s_lshr_b32 s88, s93, 2
    s_xor_b32 s88, s88, 0
    s_add_u32 s88, s88, s89
    s_add_u32 s88, s88, 114688
    buffer_load_dwordx4 v[56:59], v16, s[32:35], s88 offen sc1
    v_mfma_f32_16x16x32_bf16 v[76:79], v[40:43], a[84:87], v[76:79]
    ds_read_b64_tr_b16 v[34:35], v24 offset:22528
    buffer_load_dwordx4 v[60:63], v16, s[32:35], s88 offen offset:1024 sc1
    s_waitcnt lgkmcnt(6)
    v_mfma_f32_16x16x32_bf16 v[80:83], v[44:47], a[80:83], v[80:83]
    ds_read_b64_tr_b16 v[36:37], v25 offset:20480
    s_lshr_b32 s88, s93, 2
    s_xor_b32 s88, s88, 8192
    s_add_u32 s88, s88, s89
    s_add_u32 s88, s88, 114688
    buffer_load_dwordx4 v[4:7], v16, s[32:35], s88 offen sc1
    v_mfma_f32_16x16x32_bf16 v[88:91], v[44:47], a[84:87], v[88:91]
    ds_read_b64_tr_b16 v[38:39], v25 offset:22528
    buffer_load_dwordx4 v[8:11], v16, s[32:35], s88 offen offset:1024 sc1
    v_mfma_f32_16x16x32_bf16 v[84:87], v[48:51], a[80:83], v[84:87]
    ds_read_b64_tr_b16 v[40:41], v26 offset:20480
    s_lshr_b32 s88, s93, 2
    s_xor_b32 s88, s88, 16384
    s_add_u32 s88, s88, s89
    s_add_u32 s88, s88, 114688
    buffer_load_dwordx4 a[112:115], v16, s[32:35], s88 offen sc1
    v_mfma_f32_16x16x32_bf16 v[92:95], v[48:51], a[84:87], v[92:95]
    ds_read_b64_tr_b16 v[42:43], v26 offset:22528
    buffer_load_dwordx4 a[116:119], v16, s[32:35], s88 offen offset:1024 sc1
    s_waitcnt lgkmcnt(6)
    v_mfma_f32_16x16x32_bf16 v[96:99], v[52:55], a[80:83], v[96:99]
    ds_read_b64_tr_b16 v[44:45], v27 offset:20480
    s_lshr_b32 s88, s93, 2
    s_xor_b32 s88, s88, 24576
    s_add_u32 s88, s88, s89
    s_add_u32 s88, s88, 114688
    buffer_load_dwordx4 a[120:123], v16, s[32:35], s88 offen sc1
    v_mfma_f32_16x16x32_bf16 v[104:107], v[52:55], a[84:87], v[104:107]
    ds_read_b64_tr_b16 v[46:47], v27 offset:22528
    buffer_load_dwordx4 a[124:127], v16, s[32:35], s88 offen offset:1024 sc1
    v_mfma_f32_16x16x32_bf16 v[100:103], v[12:15], a[80:83], v[100:103]
    ds_read_b64_tr_b16 v[48:49], v28 offset:20480
    v_mfma_f32_16x16x32_bf16 v[108:111], v[12:15], a[84:87], v[108:111]
    ds_read_b64_tr_b16 v[50:51], v28 offset:22528
    s_waitcnt vmcnt(12)
    s_waitcnt lgkmcnt(6)
    v_mfma_f32_16x16x32_bf16 v[64:67], v[32:35], a[88:91], v[64:67]
    ds_read_b64_tr_b16 v[52:53], v29 offset:20480
    v_mfma_f32_16x16x32_bf16 v[72:75], v[32:35], a[92:95], v[72:75]
    ds_read_b64_tr_b16 v[54:55], v29 offset:22528
    v_mfma_f32_16x16x32_bf16 v[68:71], v[36:39], a[88:91], v[68:71]
    ds_read_b64_tr_b16 v[12:13], v24 offset:32768
    v_mfma_f32_16x16x32_bf16 v[76:79], v[36:39], a[92:95], v[76:79]
    ds_read_b64_tr_b16 v[14:15], v24 offset:34816
    s_waitcnt lgkmcnt(6)
    v_mfma_f32_16x16x32_bf16 v[80:83], v[40:43], a[88:91], v[80:83]
    ds_read_b64_tr_b16 v[32:33], v25 offset:32768
    v_mfma_f32_16x16x32_bf16 v[88:91], v[40:43], a[92:95], v[88:91]
    ds_read_b64_tr_b16 v[34:35], v25 offset:34816
    v_mfma_f32_16x16x32_bf16 v[84:87], v[44:47], a[88:91], v[84:87]
    ds_read_b64_tr_b16 v[36:37], v26 offset:32768
    v_mfma_f32_16x16x32_bf16 v[92:95], v[44:47], a[92:95], v[92:95]
    ds_read_b64_tr_b16 v[38:39], v26 offset:34816
    s_waitcnt lgkmcnt(6)
    v_mfma_f32_16x16x32_bf16 v[96:99], v[48:51], a[88:91], v[96:99]
    ds_read_b64_tr_b16 v[40:41], v27 offset:32768
    v_mfma_f32_16x16x32_bf16 v[104:107], v[48:51], a[92:95], v[104:107]
    ds_read_b64_tr_b16 v[42:43], v27 offset:34816
    v_mfma_f32_16x16x32_bf16 v[100:103], v[52:55], a[88:91], v[100:103]
    ds_read_b64_tr_b16 v[44:45], v28 offset:32768
    v_mfma_f32_16x16x32_bf16 v[108:111], v[52:55], a[92:95], v[108:111]
    ds_read_b64_tr_b16 v[46:47], v28 offset:34816
    s_waitcnt vmcnt(10)
    s_waitcnt lgkmcnt(6)
    v_mfma_f32_16x16x32_bf16 v[64:67], v[12:15], a[96:99], v[64:67]
    ds_read_b64_tr_b16 v[48:49], v29 offset:32768
    v_mfma_f32_16x16x32_bf16 v[72:75], v[12:15], a[100:103], v[72:75]
    ds_read_b64_tr_b16 v[50:51], v29 offset:34816
    v_mfma_f32_16x16x32_bf16 v[68:71], v[32:35], a[96:99], v[68:71]
    ds_read_b64_tr_b16 v[52:53], v24 offset:36864
    v_mfma_f32_16x16x32_bf16 v[76:79], v[32:35], a[100:103], v[76:79]
    ds_read_b64_tr_b16 v[54:55], v24 offset:38912
    s_waitcnt lgkmcnt(6)
    v_mfma_f32_16x16x32_bf16 v[80:83], v[36:39], a[96:99], v[80:83]
    ds_read_b64_tr_b16 v[12:13], v25 offset:36864
    v_mfma_f32_16x16x32_bf16 v[88:91], v[36:39], a[100:103], v[88:91]
    ds_read_b64_tr_b16 v[14:15], v25 offset:38912
    v_mfma_f32_16x16x32_bf16 v[84:87], v[40:43], a[96:99], v[84:87]
    ds_read_b64_tr_b16 v[32:33], v26 offset:36864
    v_mfma_f32_16x16x32_bf16 v[92:95], v[40:43], a[100:103], v[92:95]
    ds_read_b64_tr_b16 v[34:35], v26 offset:38912
    s_waitcnt lgkmcnt(6)
    v_mfma_f32_16x16x32_bf16 v[96:99], v[44:47], a[96:99], v[96:99]
    ds_read_b64_tr_b16 v[36:37], v27 offset:36864
    v_mfma_f32_16x16x32_bf16 v[104:107], v[44:47], a[100:103], v[104:107]
    ds_read_b64_tr_b16 v[38:39], v27 offset:38912
    ds_read_b32 v3, v17 offset:64
    v_mfma_f32_16x16x32_bf16 v[100:103], v[48:51], a[96:99], v[100:103]
    ds_read_b64_tr_b16 v[40:41], v28 offset:36864
    v_mfma_f32_16x16x32_bf16 v[108:111], v[48:51], a[100:103], v[108:111]
    ds_read_b64_tr_b16 v[42:43], v28 offset:38912
    s_waitcnt vmcnt(8)
    s_waitcnt lgkmcnt(7)
    v_mfma_f32_16x16x32_bf16 v[64:67], v[52:55], a[104:107], v[64:67]
    ds_read_b64_tr_b16 v[44:45], v29 offset:36864
    v_mfma_f32_16x16x32_bf16 v[72:75], v[52:55], a[108:111], v[72:75]
    ds_read_b64_tr_b16 v[46:47], v29 offset:38912
    v_mfma_f32_16x16x32_bf16 v[68:71], v[12:15], a[104:107], v[68:71]
    s_waitcnt lgkmcnt(4)
    v_cmp_ne_u32 vcc, 0, v3
    s_cbranch_vccnz L_sp29
L_ok28:
    v_add_u32 v24, 65536, v24
    ds_read_b64_tr_b16 v[48:49], v24 offset:0
    v_mfma_f32_16x16x32_bf16 v[76:79], v[12:15], a[108:111], v[76:79]
    ds_read_b64_tr_b16 v[50:51], v24 offset:2048
    v_mfma_f32_16x16x32_bf16 v[80:83], v[32:35], a[104:107], v[80:83]
    v_add_u32 v25, 65536, v25
    ds_read_b64_tr_b16 v[52:53], v25 offset:0
    v_mfma_f32_16x16x32_bf16 v[88:91], v[32:35], a[108:111], v[88:91]
    ds_read_b64_tr_b16 v[54:55], v25 offset:2048
    v_mfma_f32_16x16x32_bf16 v[84:87], v[36:39], a[104:107], v[84:87]
    ds_read_b64_tr_b16 v[12:13], v24 offset:4096
    v_mfma_f32_16x16x32_bf16 v[92:95], v[36:39], a[108:111], v[92:95]
    ds_read_b64_tr_b16 v[14:15], v24 offset:6144
    s_waitcnt lgkmcnt(6)
    v_mfma_f32_16x16x32_bf16 v[96:99], v[40:43], a[104:107], v[96:99]
    ds_read_b64_tr_b16 v[32:33], v25 offset:4096
    v_mul_f32 v64, v21, v64
    v_mul_f32 v65, v21, v65
    v_mfma_f32_16x16x32_bf16 v[104:107], v[40:43], a[108:111], v[104:107]
    ds_read_b64_tr_b16 v[34:35], v25 offset:6144
    v_mul_f32 v66, v21, v66
    v_mfma_f32_16x16x32_bf16 v[100:103], v[44:47], a[104:107], v[100:103]
    v_add_u32 v24, 4294901760, v24
    ds_read_b64_tr_b16 v[36:37], v24 offset:49152
    v_mul_f32 v67, v21, v67
    v_mul_f32 v68, v21, v68
    v_mfma_f32_16x16x32_bf16 v[108:111], v[44:47], a[108:111], v[108:111]
    ds_read_b64_tr_b16 v[38:39], v24 offset:51200
    v_mul_f32 v69, v21, v69
    v_mul_f32 v70, v21, v70
    v_mul_f32 v71, v21, v71
    v_mul_f32 v72, v23, v72
    v_mul_f32 v73, v23, v73
    v_mul_f32 v74, v23, v74
    v_mul_f32 v75, v23, v75
    v_mul_f32 v76, v23, v76
    v_mul_f32 v77, v23, v77
    v_mul_f32 v78, v23, v78
    v_mul_f32 v79, v23, v79
    s_waitcnt vmcnt(6)
    s_waitcnt lgkmcnt(6)
    v_mfma_f32_16x16x32_bf16 v[64:67], v[48:51], v[56:59], v[64:67]
    v_add_u32 v25, 4294901760, v25
    ds_read_b64_tr_b16 v[40:41], v25 offset:49152
    v_mul_f32 v80, v21, v80
    v_mul_f32 v81, v21, v81
    v_mfma_f32_16x16x32_bf16 v[72:75], v[48:51], v[60:63], v[72:75]
    ds_read_b64_tr_b16 v[42:43], v25 offset:51200
    v_mul_f32 v82, v21, v82
    v_mfma_f32_16x16x32_bf16 v[68:71], v[52:55], v[56:59], v[68:71]
    ds_read_b64_tr_b16 v[44:45], v24 offset:53248
    v_mul_f32 v83, v21, v83
    v_mul_f32 v84, v21, v84
    v_mfma_f32_16x16x32_bf16 v[76:79], v[52:55], v[60:63], v[76:79]
    ds_read_b64_tr_b16 v[46:47], v24 offset:55296
    v_mul_f32 v85, v21, v85
    s_waitcnt vmcnt(4)
    s_waitcnt lgkmcnt(6)
    v_mfma_f32_16x16x32_bf16 v[64:67], v[12:15], v[4:7], v[64:67]
    ds_read_b64_tr_b16 v[48:49], v25 offset:53248
    v_mul_f32 v86, v21, v86
    v_mul_f32 v87, v21, v87
    v_mfma_f32_16x16x32_bf16 v[72:75], v[12:15], v[8:11], v[72:75]
    ds_read_b64_tr_b16 v[50:51], v25 offset:55296
    v_mul_f32 v88, v23, v88
    v_mfma_f32_16x16x32_bf16 v[68:71], v[32:35], v[4:7], v[68:71]
    v_add_u32 v26, 65536, v26
    ds_read_b64_tr_b16 v[52:53], v26 offset:0
    v_mul_f32 v89, v23, v89
    v_mul_f32 v90, v23, v90
    v_mfma_f32_16x16x32_bf16 v[76:79], v[32:35], v[8:11], v[76:79]
    ds_read_b64_tr_b16 v[54:55], v26 offset:2048
    v_mul_f32 v91, v23, v91
    s_waitcnt vmcnt(2)
    s_waitcnt lgkmcnt(6)
    v_mfma_f32_16x16x32_bf16 v[64:67], v[36:39], a[112:115], v[64:67]
    v_add_u32 v27, 65536, v27
    ds_read_b64_tr_b16 v[12:13], v27 offset:0
    v_mul_f32 v92, v23, v92
    v_mul_f32 v93, v23, v93
    v_mfma_f32_16x16x32_bf16 v[72:75], v[36:39], a[116:119], v[72:75]
    ds_read_b64_tr_b16 v[14:15], v27 offset:2048
    v_mul_f32 v94, v23, v94
    v_mfma_f32_16x16x32_bf16 v[68:71], v[40:43], a[112:115], v[68:71]
    ds_read_b64_tr_b16 v[32:33], v26 offset:4096
    v_mul_f32 v95, v23, v95
    v_mul_f32 v96, v21, v96
    v_mfma_f32_16x16x32_bf16 v[76:79], v[40:43], a[116:119], v[76:79]
    ds_read_b64_tr_b16 v[34:35], v26 offset:6144
    v_mul_f32 v97, v21, v97
    s_waitcnt vmcnt(0)
    s_waitcnt lgkmcnt(6)
    v_mfma_f32_16x16x32_bf16 v[64:67], v[44:47], a[120:123], v[64:67]
    ds_read_b64_tr_b16 v[36:37], v27 offset:4096
    v_mul_f32 v98, v21, v98
    v_mul_f32 v99, v21, v99
    v_mfma_f32_16x16x32_bf16 v[72:75], v[44:47], a[124:127], v[72:75]
    ds_read_b64_tr_b16 v[38:39], v27 offset:6144
    v_mul_f32 v100, v21, v100
    v_mfma_f32_16x16x32_bf16 v[68:71], v[48:51], a[120:123], v[68:71]
    v_add_u32 v26, 4294901760, v26
    ds_read_b64_tr_b16 v[40:41], v26 offset:49152
    v_mul_f32 v101, v21, v101
    v_mul_f32 v102, v21, v102
    v_mfma_f32_16x16x32_bf16 v[76:79], v[48:51], a[124:127], v[76:79]
    ds_read_b64_tr_b16 v[42:43], v26 offset:51200
    v_mul_f32 v103, v21, v103
    s_waitcnt lgkmcnt(6)
    v_mfma_f32_16x16x32_bf16 v[80:83], v[52:55], v[56:59], v[80:83]
    v_add_u32 v27, 4294901760, v27
    ds_read_b64_tr_b16 v[44:45], v27 offset:49152
    v_mul_f32 v104, v23, v104
    v_mul_f32 v105, v23, v105
    v_mfma_f32_16x16x32_bf16 v[88:91], v[52:55], v[60:63], v[88:91]
    ds_read_b64_tr_b16 v[46:47], v27 offset:51200
    v_mul_f32 v106, v23, v106
    v_mfma_f32_16x16x32_bf16 v[84:87], v[12:15], v[56:59], v[84:87]
    ds_read_b64_tr_b16 v[48:49], v26 offset:53248
    v_mul_f32 v107, v23, v107
    v_mul_f32 v108, v23, v108
    v_mfma_f32_16x16x32_bf16 v[92:95], v[12:15], v[60:63], v[92:95]
    ds_read_b64_tr_b16 v[50:51], v26 offset:55296
    v_mul_f32 v109, v23, v109
    s_waitcnt lgkmcnt(6)
    v_mfma_f32_16x16x32_bf16 v[80:83], v[32:35], v[4:7], v[80:83]
    ds_read_b64_tr_b16 v[52:53], v27 offset:53248
    v_mul_f32 v110, v23, v110
    v_mul_f32 v111, v23, v111
    v_mfma_f32_16x16x32_bf16 v[88:91], v[32:35], v[8:11], v[88:91]
    ds_read_b64_tr_b16 v[54:55], v27 offset:55296
    s_xor_b32 s94, s64, 3
    s_mul_i32 s94, s94, 24576
    s_add_u32 s94, s94, s92
    s_add_u32 s94, s94, 0
    v_mfma_f32_16x16x32_bf16 v[84:87], v[36:39], v[4:7], v[84:87]
    v_add_u32 v28, 65536, v28
    ds_read_b64_tr_b16 v[12:13], v28 offset:0
    v_cvt_pk_bf16_f32 v64, v64, v65
    v_cvt_pk_bf16_f32 v65, v66, v67
    v_mfma_f32_16x16x32_bf16 v[92:95], v[36:39], v[8:11], v[92:95]
    ds_read_b64_tr_b16 v[14:15], v28 offset:2048
    v_cvt_pk_bf16_f32 v66, v68, v69
    s_waitcnt lgkmcnt(6)
    v_mfma_f32_16x16x32_bf16 v[80:83], v[40:43], a[112:115], v[80:83]
    v_add_u32 v29, 65536, v29
    ds_read_b64_tr_b16 v[32:33], v29 offset:0
    v_cvt_pk_bf16_f32 v67, v70, v71
    v_cvt_pk_bf16_f32 v68, v72, v73
    v_mfma_f32_16x16x32_bf16 v[88:91], v[40:43], a[116:119], v[88:91]
    ds_read_b64_tr_b16 v[34:35], v29 offset:2048
    v_cvt_pk_bf16_f32 v69, v74, v75
    v_mfma_f32_16x16x32_bf16 v[84:87], v[44:47], a[112:115], v[84:87]
    ds_read_b64_tr_b16 v[36:37], v28 offset:4096
    v_cvt_pk_bf16_f32 v70, v76, v77
    v_cvt_pk_bf16_f32 v71, v78, v79
    v_mfma_f32_16x16x32_bf16 v[92:95], v[44:47], a[116:119], v[92:95]
    ds_read_b64_tr_b16 v[38:39], v28 offset:6144
    buffer_store_dwordx4 v[64:67], v16, s[32:35], s94 offen offset:0 sc1
    s_waitcnt lgkmcnt(6)
    v_mfma_f32_16x16x32_bf16 v[80:83], v[48:51], a[120:123], v[80:83]
    ds_read_b64_tr_b16 v[40:41], v29 offset:4096
    buffer_store_dwordx4 v[68:71], v16, s[32:35], s94 offen offset:1024 sc1
    v_mfma_f32_16x16x32_bf16 v[88:91], v[48:51], a[124:127], v[88:91]
    ds_read_b64_tr_b16 v[42:43], v29 offset:6144
    v_mfma_f32_16x16x32_bf16 v[84:87], v[52:55], a[120:123], v[84:87]
    v_add_u32 v28, 4294901760, v28
    ds_read_b64_tr_b16 v[44:45], v28 offset:49152
    v_mfma_f32_16x16x32_bf16 v[92:95], v[52:55], a[124:127], v[92:95]
    ds_read_b64_tr_b16 v[46:47], v28 offset:51200
    s_waitcnt lgkmcnt(6)
    v_mfma_f32_16x16x32_bf16 v[96:99], v[12:15], v[56:59], v[96:99]
    v_add_u32 v29, 4294901760, v29
    ds_read_b64_tr_b16 v[48:49], v29 offset:49152
    v_mfma_f32_16x16x32_bf16 v[104:107], v[12:15], v[60:63], v[104:107]
    ds_read_b64_tr_b16 v[50:51], v29 offset:51200
    v_mfma_f32_16x16x32_bf16 v[100:103], v[32:35], v[56:59], v[100:103]
    ds_read_b64_tr_b16 v[52:53], v28 offset:53248
    v_mfma_f32_16x16x32_bf16 v[108:111], v[32:35], v[60:63], v[108:111]
    ds_read_b64_tr_b16 v[54:55], v28 offset:55296
    s_waitcnt lgkmcnt(6)
    v_mfma_f32_16x16x32_bf16 v[96:99], v[36:39], v[4:7], v[96:99]
    ds_read_b64_tr_b16 v[12:13], v29 offset:53248
    s_xor_b32 s94, s64, 2
    s_mul_i32 s94, s94, 24576
    s_add_u32 s94, s94, s92
    s_add_u32 s94, s94, 8192
    v_cvt_pk_bf16_f32 v80, v80, v81
    v_mfma_f32_16x16x32_bf16 v[104:107], v[36:39], v[8:11], v[104:107]
    ds_read_b64_tr_b16 v[14:15], v29 offset:55296
    v_cvt_pk_bf16_f32 v81, v82, v83
    v_mfma_f32_16x16x32_bf16 v[100:103], v[40:43], v[4:7], v[100:103]
    ds_read_b64_tr_b16 v[32:33], v30 offset:16384
    v_cvt_pk_bf16_f32 v82, v84, v85
    v_cvt_pk_bf16_f32 v83, v86, v87
    v_mfma_f32_16x16x32_bf16 v[108:111], v[40:43], v[8:11], v[108:111]
    ds_read_b64_tr_b16 v[34:35], v30 offset:18432
    v_cvt_pk_bf16_f32 v84, v88, v89
    s_waitcnt lgkmcnt(6)
    v_mfma_f32_16x16x32_bf16 v[96:99], v[44:47], a[112:115], v[96:99]
    ds_read_b64_tr_b16 v[36:37], v31 offset:16384
    v_cvt_pk_bf16_f32 v85, v90, v91
    v_cvt_pk_bf16_f32 v86, v92, v93
    v_mfma_f32_16x16x32_bf16 v[104:107], v[44:47], a[116:119], v[104:107]
    ds_read_b64_tr_b16 v[38:39], v31 offset:18432
    v_cvt_pk_bf16_f32 v87, v94, v95
    v_mfma_f32_16x16x32_bf16 v[100:103], v[48:51], a[112:115], v[100:103]
    ds_read_b64_tr_b16 v[40:41], v30 offset:20480
    buffer_store_dwordx4 v[80:83], v16, s[32:35], s94 offen offset:0 sc1
    v_mfma_f32_16x16x32_bf16 v[108:111], v[48:51], a[116:119], v[108:111]
    ds_read_b64_tr_b16 v[42:43], v30 offset:22528
    buffer_store_dwordx4 v[84:87], v16, s[32:35], s94 offen offset:1024 sc1
    s_waitcnt lgkmcnt(6)
    v_mfma_f32_16x16x32_bf16 v[96:99], v[52:55], a[120:123], v[96:99]
    ds_read_b64_tr_b16 v[44:45], v31 offset:20480
    v_mfma_f32_16x16x32_bf16 v[104:107], v[52:55], a[124:127], v[104:107]
    ds_read_b64_tr_b16 v[46:47], v31 offset:22528
    v_mfma_f32_16x16x32_bf16 v[100:103], v[12:15], a[120:123], v[100:103]
    ds_read_b64_tr_b16 v[48:49], v30 offset:32768
    v_mfma_f32_16x16x32_bf16 v[108:111], v[12:15], a[124:127], v[108:111]
    ds_read_b64_tr_b16 v[50:51], v30 offset:34816
    s_waitcnt lgkmcnt(6)
    v_mfma_f32_16x16x32_bf16 v[112:115], v[32:35], a[16:19], v[112:115]
    ds_read_b64_tr_b16 v[52:53], v31 offset:32768
    v_mfma_f32_16x16x32_bf16 v[120:123], v[32:35], a[20:23], v[120:123]
    ds_read_b64_tr_b16 v[54:55], v31 offset:34816
    v_mfma_f32_16x16x32_bf16 v[116:119], v[36:39], a[16:19], v[116:119]
    ds_read_b64_tr_b16 v[12:13], v30 offset:36864
    v_mfma_f32_16x16x32_bf16 v[124:127], v[36:39], a[20:23], v[124:127]
    ds_read_b64_tr_b16 v[14:15], v30 offset:38912
    s_waitcnt lgkmcnt(6)
    v_mfma_f32_16x16x32_bf16 v[112:115], v[40:43], a[24:27], v[112:115]
    ds_read_b64_tr_b16 v[32:33], v31 offset:36864
    s_xor_b32 s94, s64, 1
    s_mul_i32 s94, s94, 24576
    s_add_u32 s94, s94, s92
    s_add_u32 s94, s94, 16384
    v_cvt_pk_bf16_f32 v96, v96, v97
    v_mfma_f32_16x16x32_bf16 v[120:123], v[40:43], a[28:31], v[120:123]
    ds_read_b64_tr_b16 v[34:35], v31 offset:38912
    v_cvt_pk_bf16_f32 v97, v98, v99
    v_mfma_f32_16x16x32_bf16 v[116:119], v[44:47], a[24:27], v[116:119]
    ds_read_b64_tr_b16 v[36:37], v30 offset:49152
    v_cvt_pk_bf16_f32 v98, v100, v101
    v_cvt_pk_bf16_f32 v99, v102, v103
    v_mfma_f32_16x16x32_bf16 v[124:127], v[44:47], a[28:31], v[124:127]
    ds_read_b64_tr_b16 v[38:39], v30 offset:51200
    v_cvt_pk_bf16_f32 v100, v104, v105
    s_waitcnt lgkmcnt(6)
    v_mfma_f32_16x16x32_bf16 v[112:115], v[48:51], a[32:35], v[112:115]
    ds_read_b64_tr_b16 v[40:41], v31 offset:49152
    v_cvt_pk_bf16_f32 v101, v106, v107
    v_cvt_pk_bf16_f32 v102, v108, v109
    v_mfma_f32_16x16x32_bf16 v[120:123], v[48:51], a[36:39], v[120:123]
    ds_read_b64_tr_b16 v[42:43], v31 offset:51200
    v_cvt_pk_bf16_f32 v103, v110, v111
    v_mfma_f32_16x16x32_bf16 v[116:119], v[52:55], a[32:35], v[116:119]
    ds_read_b64_tr_b16 v[44:45], v30 offset:53248
    buffer_store_dwordx4 v[96:99], v16, s[32:35], s94 offen offset:0 sc1
    v_mfma_f32_16x16x32_bf16 v[124:127], v[52:55], a[36:39], v[124:127]
    ds_read_b64_tr_b16 v[46:47], v30 offset:55296
    buffer_store_dwordx4 v[100:103], v16, s[32:35], s94 offen offset:1024 sc1
    s_waitcnt lgkmcnt(6)
    v_mfma_f32_16x16x32_bf16 v[112:115], v[12:15], a[40:43], v[112:115]
    ds_read_b64_tr_b16 v[48:49], v31 offset:53248
    v_mfma_f32_16x16x32_bf16 v[120:123], v[12:15], a[44:47], v[120:123]
    ds_read_b64_tr_b16 v[50:51], v31 offset:55296
    s_load_dword s74, s[52:53], s75 glc
    v_mfma_f32_16x16x32_bf16 v[116:119], v[32:35], a[40:43], v[116:119]
    v_add_u32 v30, 65536, v30
    ds_read_b64_tr_b16 v[52:53], v30 offset:0
    v_mfma_f32_16x16x32_bf16 v[124:127], v[32:35], a[44:47], v[124:127]
    ds_read_b64_tr_b16 v[54:55], v30 offset:2048
    s_waitcnt lgkmcnt(6)
    v_mfma_f32_16x16x32_bf16 v[112:115], v[36:39], a[48:51], v[112:115]
    v_add_u32 v31, 65536, v31
    ds_read_b64_tr_b16 v[12:13], v31 offset:0
    v_mfma_f32_16x16x32_bf16 v[120:123], v[36:39], a[52:55], v[120:123]
    ds_read_b64_tr_b16 v[14:15], v31 offset:2048
    s_waitcnt vmcnt(4)
    s_xor_b32 s3, s75, 6144
    s_mov_b32 s80, 1024
    s_atomic_or s80, s[52:53], s3
    v_mfma_f32_16x16x32_bf16 v[116:119], v[40:43], a[48:51], v[116:119]
    ds_read_b64_tr_b16 v[32:33], v30 offset:4096
    v_mfma_f32_16x16x32_bf16 v[124:127], v[40:43], a[52:55], v[124:127]
    ds_read_b64_tr_b16 v[34:35], v30 offset:6144
    s_waitcnt lgkmcnt(6)
    v_mfma_f32_16x16x32_bf16 v[112:115], v[44:47], a[56:59], v[112:115]
    ds_read_b64_tr_b16 v[36:37], v31 offset:4096
    v_mfma_f32_16x16x32_bf16 v[120:123], v[44:47], a[60:63], v[120:123]
    ds_read_b64_tr_b16 v[38:39], v31 offset:6144
    v_mfma_f32_16x16x32_bf16 v[116:119], v[48:51], a[56:59], v[116:119]
    ds_read_b64_tr_b16 v[40:41], v30 offset:16384
    v_mfma_f32_16x16x32_bf16 v[124:127], v[48:51], a[60:63], v[124:127]
    ds_read_b64_tr_b16 v[42:43], v30 offset:18432
    s_waitcnt lgkmcnt(6)
    v_mfma_f32_16x16x32_bf16 v[112:115], v[52:55], a[64:67], v[112:115]
    ds_read_b64_tr_b16 v[44:45], v31 offset:16384
    v_mfma_f32_16x16x32_bf16 v[120:123], v[52:55], a[68:71], v[120:123]
    ds_read_b64_tr_b16 v[46:47], v31 offset:18432
    v_mfma_f32_16x16x32_bf16 v[116:119], v[12:15], a[64:67], v[116:119]
    ds_read_b64_tr_b16 v[48:49], v30 offset:20480
    v_mfma_f32_16x16x32_bf16 v[124:127], v[12:15], a[68:71], v[124:127]
    ds_read_b64_tr_b16 v[50:51], v30 offset:22528
    s_waitcnt lgkmcnt(6)
    v_mfma_f32_16x16x32_bf16 v[112:115], v[32:35], a[72:75], v[112:115]
    ds_read_b64_tr_b16 v[52:53], v31 offset:20480
    v_mfma_f32_16x16x32_bf16 v[120:123], v[32:35], a[76:79], v[120:123]
    ds_read_b64_tr_b16 v[54:55], v31 offset:22528
    v_mfma_f32_16x16x32_bf16 v[116:119], v[36:39], a[72:75], v[116:119]
    ds_read_b64_tr_b16 v[12:13], v30 offset:32768
    v_mfma_f32_16x16x32_bf16 v[124:127], v[36:39], a[76:79], v[124:127]
    ds_read_b64_tr_b16 v[14:15], v30 offset:34816
    s_waitcnt lgkmcnt(6)
    v_mfma_f32_16x16x32_bf16 v[112:115], v[40:43], a[80:83], v[112:115]
    ds_read_b64_tr_b16 v[32:33], v31 offset:32768
    v_mfma_f32_16x16x32_bf16 v[120:123], v[40:43], a[84:87], v[120:123]
    ds_read_b64_tr_b16 v[34:35], v31 offset:34816
    v_mfma_f32_16x16x32_bf16 v[116:119], v[44:47], a[80:83], v[116:119]
    ds_read_b64_tr_b16 v[36:37], v30 offset:36864
    v_mfma_f32_16x16x32_bf16 v[124:127], v[44:47], a[84:87], v[124:127]
    ds_read_b64_tr_b16 v[38:39], v30 offset:38912
    s_waitcnt lgkmcnt(6)
    v_mfma_f32_16x16x32_bf16 v[112:115], v[48:51], a[88:91], v[112:115]
    ds_read_b64_tr_b16 v[40:41], v31 offset:36864
    v_mfma_f32_16x16x32_bf16 v[120:123], v[48:51], a[92:95], v[120:123]
    ds_read_b64_tr_b16 v[42:43], v31 offset:38912
    v_mfma_f32_16x16x32_bf16 v[116:119], v[52:55], a[88:91], v[116:119]
    v_add_u32 v30, 65536, v30
    ds_read_b64_tr_b16 v[44:45], v30 offset:0
    v_mfma_f32_16x16x32_bf16 v[124:127], v[52:55], a[92:95], v[124:127]
    ds_read_b64_tr_b16 v[46:47], v30 offset:2048
    s_waitcnt lgkmcnt(6)
    v_mfma_f32_16x16x32_bf16 v[112:115], v[12:15], a[96:99], v[112:115]
    v_add_u32 v31, 65536, v31
    ds_read_b64_tr_b16 v[48:49], v31 offset:0
    v_mfma_f32_16x16x32_bf16 v[120:123], v[12:15], a[100:103], v[120:123]
    ds_read_b64_tr_b16 v[50:51], v31 offset:2048
    v_mfma_f32_16x16x32_bf16 v[116:119], v[32:35], a[96:99], v[116:119]
    ds_read_b64_tr_b16 v[52:53], v30 offset:4096
    v_mfma_f32_16x16x32_bf16 v[124:127], v[32:35], a[100:103], v[124:127]
    ds_read_b64_tr_b16 v[54:55], v30 offset:6144
    s_waitcnt lgkmcnt(6)
    v_mfma_f32_16x16x32_bf16 v[112:115], v[36:39], a[104:107], v[112:115]
    ds_read_b64_tr_b16 v[12:13], v31 offset:4096
    v_mfma_f32_16x16x32_bf16 v[120:123], v[36:39], a[108:111], v[120:123]
    ds_read_b64_tr_b16 v[14:15], v31 offset:6144
    v_mfma_f32_16x16x32_bf16 v[116:119], v[40:43], a[104:107], v[116:119]
    v_add_u32 v30, 4294901760, v30
    ds_read_b64_tr_b16 v[32:33], v30 offset:49152
    v_mfma_f32_16x16x32_bf16 v[124:127], v[40:43], a[108:111], v[124:127]
    ds_read_b64_tr_b16 v[34:35], v30 offset:51200
    s_waitcnt lgkmcnt(6)
    v_mfma_f32_16x16x32_bf16 v[64:67], v[44:47], v[56:59], 0
    v_add_u32 v31, 4294901760, v31
    ds_read_b64_tr_b16 v[36:37], v31 offset:49152
    v_mfma_f32_16x16x32_bf16 v[72:75], v[44:47], v[60:63], 0
    ds_read_b64_tr_b16 v[38:39], v31 offset:51200
    v_mfma_f32_16x16x32_bf16 v[68:71], v[48:51], v[56:59], 0
    ds_read_b64_tr_b16 v[40:41], v30 offset:53248
    v_mfma_f32_16x16x32_bf16 v[76:79], v[48:51], v[60:63], 0
    ds_read_b64_tr_b16 v[42:43], v30 offset:55296
    s_waitcnt lgkmcnt(6)
    v_mfma_f32_16x16x32_bf16 v[64:67], v[52:55], v[4:7], v[64:67]
    ds_read_b64_tr_b16 v[44:45], v31 offset:53248
    v_mul_f32 v112, v21, v112
    v_mul_f32 v113, v21, v113
    v_mfma_f32_16x16x32_bf16 v[72:75], v[52:55], v[8:11], v[72:75]
    ds_read_b64_tr_b16 v[46:47], v31 offset:55296
    v_mul_f32 v114, v21, v114
    v_mfma_f32_16x16x32_bf16 v[68:71], v[12:15], v[4:7], v[68:71]
    v_mul_f32 v115, v21, v115
    v_mul_f32 v116, v21, v116
    v_mfma_f32_16x16x32_bf16 v[76:79], v[12:15], v[8:11], v[76:79]
    v_mul_f32 v117, v21, v117
    s_waitcnt lgkmcnt(0)
    s_waitcnt vmcnt(2)
    s_xor_b32 s3, s75, 4096
    s_mov_b32 s81, 2048
    s_atomic_or s81, s[52:53], s3
    s_waitcnt vmcnt(0)
    s_xor_b32 s3, s75, 2048
    s_mov_b32 s82, 4096
    s_atomic_or s82, s[52:53], s3
    s_load_dword s74, s[52:53], s75 glc
    v_mfma_f32_16x16x32_bf16 v[64:67], v[32:35], a[112:115], v[64:67]
    v_mul_f32 v118, v21, v118
    v_mul_f32 v119, v21, v119
    v_mfma_f32_16x16x32_bf16 v[72:75], v[32:35], a[116:119], v[72:75]
    v_mul_f32 v120, v23, v120
    v_mfma_f32_16x16x32_bf16 v[68:71], v[36:39], a[112:115], v[68:71]
    v_mul_f32 v121, v23, v121
    v_mul_f32 v122, v23, v122
    v_mfma_f32_16x16x32_bf16 v[76:79], v[36:39], a[116:119], v[76:79]
    v_mul_f32 v123, v23, v123
    v_mfma_f32_16x16x32_bf16 v[64:67], v[40:43], a[120:123], v[64:67]
    v_mul_f32 v124, v23, v124
    v_mul_f32 v125, v23, v125
    v_mfma_f32_16x16x32_bf16 v[72:75], v[40:43], a[124:127], v[72:75]
    v_mul_f32 v126, v23, v126
    v_mfma_f32_16x16x32_bf16 v[68:71], v[44:47], a[120:123], v[68:71]
    v_mul_f32 v127, v23, v127
    v_mfma_f32_16x16x32_bf16 v[76:79], v[44:47], a[124:127], v[76:79]
    s_mul_i32 s94, s64, 24576
    s_add_u32 s94, s94, s92
    v_and_b32 v4, 15, v0
    v_bfe_u32 v6, v0, 4, 1
    v_lshlrev_b32 v6, 5, v6
    v_lshrrev_b32 v7, 5, v0
    v_lshl_add_u32 v6, v7, 4, v6
    v_lshl_add_u32 v5, v4, 11, v6
    v_xor_b32 v4, 0x4000, v5
    s_lshl_b32 s88, s61, 17
    s_lshl_b32 s67, s60, 15
    s_add_u32 s88, s88, s67
    s_lshl_b32 s67, s62, 8
    s_add_u32 s88, s88, s67
    s_lshl_b32 s67, s64, 6
    s_add_u32 s88, s88, s67
    v_pk_add_f32 v[112:113], v[112:113], v[64:65]
    v_pk_add_f32 v[114:115], v[114:115], v[66:67]
    v_pk_add_f32 v[116:117], v[116:117], v[68:69]
    v_pk_add_f32 v[118:119], v[118:119], v[70:71]
    v_pk_add_f32 v[120:121], v[120:121], v[72:73]
    v_pk_add_f32 v[122:123], v[122:123], v[74:75]
    v_pk_add_f32 v[124:125], v[124:125], v[76:77]
    v_pk_add_f32 v[126:127], v[126:127], v[78:79]
    s_andn2_b32 s70, 1024, s74
    s_cbranch_scc1 L_pl31
L_pk30:
    buffer_load_dwordx4 v[24:27], v16, s[32:35], s94 offen offset:0 sc1
    buffer_load_dwordx4 v[28:31], v16, s[32:35], s94 offen offset:1024 sc1
    s_add_u32 s94, s94, 8192
    s_andn2_b32 s70, 2048, s74
    s_cbranch_scc1 L_pl33
L_pk32:
    buffer_load_dwordx4 v[32:35], v16, s[32:35], s94 offen offset:0 sc1
    buffer_load_dwordx4 v[36:39], v16, s[32:35], s94 offen offset:1024 sc1
    s_add_u32 s94, s94, 8192
    s_andn2_b32 s70, 4096, s74
    s_cbranch_scc1 L_pl35
L_pk34:
    buffer_load_dwordx4 v[40:43], v16, s[32:35], s94 offen offset:0 sc1
    buffer_load_dwordx4 v[44:47], v16, s[32:35], s94 offen offset:1024 sc1
    s_waitcnt vmcnt(4)
    v_lshlrev_b32 v80, 16, v24
    v_and_b32 v81, 0xffff0000, v24
    v_lshlrev_b32 v82, 16, v25
    v_and_b32 v83, 0xffff0000, v25
    v_lshlrev_b32 v84, 16, v26
    v_and_b32 v85, 0xffff0000, v26
    v_lshlrev_b32 v86, 16, v27
    v_and_b32 v87, 0xffff0000, v27
    v_lshlrev_b32 v88, 16, v28
    v_and_b32 v89, 0xffff0000, v28
    v_lshlrev_b32 v90, 16, v29
    v_and_b32 v91, 0xffff0000, v29
    v_lshlrev_b32 v92, 16, v30
    v_and_b32 v93, 0xffff0000, v30
    v_lshlrev_b32 v94, 16, v31
    v_and_b32 v95, 0xffff0000, v31
    v_pk_add_f32 v[112:113], v[112:113], v[80:81]
    v_pk_add_f32 v[114:115], v[114:115], v[82:83]
    v_pk_add_f32 v[116:117], v[116:117], v[84:85]
    v_pk_add_f32 v[118:119], v[118:119], v[86:87]
    v_pk_add_f32 v[120:121], v[120:121], v[88:89]
    v_pk_add_f32 v[122:123], v[122:123], v[90:91]
    v_pk_add_f32 v[124:125], v[124:125], v[92:93]
    v_pk_add_f32 v[126:127], v[126:127], v[94:95]
    s_waitcnt vmcnt(2)
    v_lshlrev_b32 v80, 16, v32
    v_and_b32 v81, 0xffff0000, v32
    v_lshlrev_b32 v82, 16, v33
    v_and_b32 v83, 0xffff0000, v33
    v_lshlrev_b32 v84, 16, v34
    v_and_b32 v85, 0xffff0000, v34
    v_lshlrev_b32 v86, 16, v35
    v_and_b32 v87, 0xffff0000, v35
    v_lshlrev_b32 v88, 16, v36
    v_and_b32 v89, 0xffff0000, v36
    v_lshlrev_b32 v90, 16, v37
    v_and_b32 v91, 0xffff0000, v37
    v_lshlrev_b32 v92, 16, v38
    v_and_b32 v93, 0xffff0000, v38
    v_lshlrev_b32 v94, 16, v39
    v_and_b32 v95, 0xffff0000, v39
    v_pk_add_f32 v[112:113], v[112:113], v[80:81]
    v_pk_add_f32 v[114:115], v[114:115], v[82:83]
    v_pk_add_f32 v[116:117], v[116:117], v[84:85]
    v_pk_add_f32 v[118:119], v[118:119], v[86:87]
    v_pk_add_f32 v[120:121], v[120:121], v[88:89]
    v_pk_add_f32 v[122:123], v[122:123], v[90:91]
    v_pk_add_f32 v[124:125], v[124:125], v[92:93]
    v_pk_add_f32 v[126:127], v[126:127], v[94:95]
    s_waitcnt vmcnt(0)
    v_lshlrev_b32 v80, 16, v40
    v_and_b32 v81, 0xffff0000, v40
    v_lshlrev_b32 v82, 16, v41
    v_and_b32 v83, 0xffff0000, v41
    v_lshlrev_b32 v84, 16, v42
    v_and_b32 v85, 0xffff0000, v42
    v_lshlrev_b32 v86, 16, v43
    v_and_b32 v87, 0xffff0000, v43
    v_lshlrev_b32 v88, 16, v44
    v_and_b32 v89, 0xffff0000, v44
    v_lshlrev_b32 v90, 16, v45
    v_and_b32 v91, 0xffff0000, v45
    v_lshlrev_b32 v92, 16, v46
    v_and_b32 v93, 0xffff0000, v46
    v_lshlrev_b32 v94, 16, v47
    v_and_b32 v95, 0xffff0000, v47
    v_pk_add_f32 v[112:113], v[112:113], v[80:81]
    v_pk_add_f32 v[114:115], v[114:115], v[82:83]
    v_pk_add_f32 v[116:117], v[116:117], v[84:85]
    v_pk_add_f32 v[118:119], v[118:119], v[86:87]
    v_pk_add_f32 v[120:121], v[120:121], v[88:89]
    v_pk_add_f32 v[122:123], v[122:123], v[90:91]
    v_pk_add_f32 v[124:125], v[124:125], v[92:93]
    v_pk_add_f32 v[126:127], v[126:127], v[94:95]
    v_pk_mul_f32 v[112:113], v[112:113], v[20:21] op_sel_hi:[1,0]
    v_pk_mul_f32 v[114:115], v[114:115], v[20:21] op_sel_hi:[1,0]
    v_pk_mul_f32 v[116:117], v[116:117], v[20:21] op_sel_hi:[1,0]
    v_pk_mul_f32 v[118:119], v[118:119], v[20:21] op_sel_hi:[1,0]
    v_pk_mul_f32 v[120:121], v[120:121], v[22:23] op_sel_hi:[1,0]
    v_pk_mul_f32 v[122:123], v[122:123], v[22:23] op_sel_hi:[1,0]
    v_pk_mul_f32 v[124:125], v[124:125], v[22:23] op_sel_hi:[1,0]
    v_pk_mul_f32 v[126:127], v[126:127], v[22:23] op_sel_hi:[1,0]
    v_cvt_pk_bf16_f32 v112, v112, v113
    v_cvt_pk_bf16_f32 v113, v114, v115
    v_cvt_pk_bf16_f32 v114, v116, v117
    v_cvt_pk_bf16_f32 v115, v118, v119
    v_cvt_pk_bf16_f32 v116, v120, v121
    v_cvt_pk_bf16_f32 v117, v122, v123
    v_cvt_pk_bf16_f32 v118, v124, v125
    v_cvt_pk_bf16_f32 v119, v126, v127
    v_permlane16_swap_b32 v112, v114
    v_permlane16_swap_b32 v113, v115
    buffer_store_dwordx4 v[112:115], v4, s[36:39], s88 offen offset:0
    v_permlane16_swap_b32 v116, v118
    v_permlane16_swap_b32 v117, v119
    buffer_store_dwordx4 v[116:119], v5, s[36:39], s88 offen offset:1024
    s_endpgm
L_pp3:
    s_sleep 8
    s_load_dword s74, s[54:55], 0 glc
    s_waitcnt lgkmcnt(0)
    s_cmp_ge_u32 s74, 16
    s_cbranch_scc1 L_po4
    s_sub_u32 s69, s69, 1
    s_cbranch_scc0 L_pp3
    s_mov_b32 s69, 0
    s_branch L_po4
L_pl6:
    s_waitcnt lgkmcnt(0)
    s_andn2_b32 s70, 17, s74
    s_cbranch_scc0 L_pk5
    s_load_dword s74, s[52:53], s75 glc
    s_sub_u32 s69, s69, 1
    s_cbranch_scc0 L_pl6
    s_mov_b32 s69, 0
    s_branch L_pk5
L_pl8:
    s_waitcnt lgkmcnt(0)
    s_andn2_b32 s70, 34, s74
    s_cbranch_scc0 L_pk7
    s_load_dword s74, s[52:53], s75 glc
    s_sub_u32 s69, s69, 1
    s_cbranch_scc0 L_pl8
    s_mov_b32 s69, 0
    s_branch L_pk7
L_sp15:
    ds_read_b32 v3, v17 offset:0
    s_waitcnt lgkmcnt(0)
    v_cmp_ne_u32 vcc, 0, v3
    s_cbranch_vccz L_ok14
    s_sleep 1
    s_sub_u32 s69, s69, 1
    s_cbranch_scc0 L_sp15
    s_mov_b32 s69, 0
    s_branch L_ok14
L_pl17:
    s_waitcnt lgkmcnt(0)
    s_andn2_b32 s70, 68, s74
    s_cbranch_scc0 L_pk16
    s_load_dword s74, s[52:53], s75 glc
    s_sub_u32 s69, s69, 1
    s_cbranch_scc0 L_pl17
    s_mov_b32 s69, 0
    s_branch L_pk16
L_sp19:
    ds_read_b32 v3, v17 offset:16
    s_waitcnt lgkmcnt(0)
    v_cmp_ne_u32 vcc, 0, v3
    s_cbranch_vccz L_ok18
    s_sleep 1
    s_sub_u32 s69, s69, 1
    s_cbranch_scc0 L_sp19
    s_mov_b32 s69, 0
    s_branch L_ok18
L_sp21:
    ds_read_b32 v3, v17 offset:32
    s_waitcnt lgkmcnt(0)
    v_cmp_ne_u32 vcc, 0, v3
    s_cbranch_vccz L_ok20
    s_sleep 1
    s_sub_u32 s69, s69, 1
    s_cbranch_scc0 L_sp21
    s_mov_b32 s69, 0
    s_branch L_ok20
L_pl23:
    s_waitcnt lgkmcnt(0)
    s_andn2_b32 s70, 136, s74
    s_cbranch_scc0 L_pk22
    s_load_dword s74, s[52:53], s75 glc
    s_sub_u32 s69, s69, 1
    s_cbranch_scc0 L_pl23
    s_mov_b32 s69, 0
    s_branch L_pk22
L_sp25:
    ds_read_b32 v3, v17 offset:48
    s_waitcnt lgkmcnt(0)
    v_cmp_ne_u32 vcc, 0, v3
    s_cbranch_vccz L_ok24
    s_sleep 1
    s_sub_u32 s69, s69, 1
    s_cbranch_scc0 L_sp25
    s_mov_b32 s69, 0
    s_branch L_ok24
L_pl27:
    s_waitcnt lgkmcnt(0)
    s_andn2_b32 s70, 768, s74
    s_cbranch_scc0 L_pk26
    s_load_dword s74, s[52:53], s75 glc
    s_sub_u32 s69, s69, 1
    s_cbranch_scc0 L_pl27
    s_mov_b32 s69, 0
    s_branch L_pk26
L_sp29:
    ds_read_b32 v3, v17 offset:64
    s_waitcnt lgkmcnt(0)
    v_cmp_ne_u32 vcc, 0, v3
    s_cbranch_vccz L_ok28
    s_sleep 1
    s_sub_u32 s69, s69, 1
    s_cbranch_scc0 L_sp29
    s_mov_b32 s69, 0
    s_branch L_ok28
L_pl31:
    s_waitcnt lgkmcnt(0)
    s_andn2_b32 s70, 1024, s74
    s_cbranch_scc0 L_pk30
    s_load_dword s74, s[52:53], s75 glc
    s_sub_u32 s69, s69, 1
    s_cbranch_scc0 L_pl31
    s_mov_b32 s69, 0
    s_branch L_pk30
L_pl33:
    s_waitcnt lgkmcnt(0)
    s_andn2_b32 s70, 2048, s74
    s_cbranch_scc0 L_pk32
    s_load_dword s74, s[52:53], s75 glc
    s_sub_u32 s69, s69, 1
    s_cbranch_scc0 L_pl33
    s_mov_b32 s69, 0
    s_branch L_pk32
L_pl35:
    s_waitcnt lgkmcnt(0)
    s_andn2_b32 s70, 4096, s74
    s_cbranch_scc0 L_pk34
    s_load_dword s74, s[52:53], s75 glc
    s_sub_u32 s69, s69, 1
    s_cbranch_scc0 L_pl35
    s_mov_b32 s69, 0
    s_branch L_pk34
L_h_att:
    s_and_b32 s67, s60, 1
    s_mul_i32 s67, s67, 1088
    v_xor_b32 v19, s67, v4
    s_lshl_b32 s3, s61, 17
    s_sub_u32 s3, s3, 16384
    s_lshr_b32 s67, s60, 1
    s_lshl_b32 s67, s67, 7
    s_add_u32 s3, s3, s67
    v_add_u32 v19, s3, v19
    v_max_i32 v19, 0, v19
    s_lshr_b32 s3, s65, 2
    s_add_u32 m0, s3, 114688
    s_and_b32 s3, s80, 0x300
    buffer_load_dwordx4 v19, s[24:27], s3 offen lds
    s_add_u32 m0, s65, 131072
    s_add_u32 s71, s84, s88
    s_add_i32 s71, s71, -1024
    buffer_load_dwordx4 v8, s[28:31], s71 offen offset:0 lds
    buffer_load_dwordx4 v9, s[28:31], s71 offen offset:1024 lds
    buffer_load_dwordx4 v10, s[28:31], s71 offen offset:2048 lds
    buffer_load_dwordx4 v11, s[28:31], s71 offen offset:3072 lds
    s_add_u32 m0, s65, 147456
    s_add_u32 s71, s81, 0
    buffer_load_dwordx4 v4, s[24:27], s71 offen offset:0 lds
    buffer_load_dwordx4 v5, s[24:27], s71 offen offset:1024 lds
    buffer_load_dwordx4 v6, s[24:27], s71 offen offset:2048 lds
    buffer_load_dwordx4 v7, s[24:27], s71 offen offset:3072 lds
    s_add_u32 m0, s65, 16384
    s_add_u32 s71, s81, 128
    buffer_load_dwordx4 v4, s[24:27], s71 offen offset:0 lds
    buffer_load_dwordx4 v5, s[24:27], s71 offen offset:1024 lds
    buffer_load_dwordx4 v6, s[24:27], s71 offen offset:2048 lds
    buffer_load_dwordx4 v7, s[24:27], s71 offen offset:3072 lds
    s_lshr_b32 s3, s65, 2
    s_add_u32 m0, s3, 118784
    s_and_b32 s3, s81, 0x300
    buffer_load_dwordx4 v19, s[24:27], s3 offen lds
    s_waitcnt vmcnt(13)
    s_barrier
    s_add_u32 m0, s65, 32768
    s_add_u32 s71, s85, s88
    buffer_load_dwordx4 v8, s[28:31], s71 offen offset:0 lds
    buffer_load_dwordx4 v9, s[28:31], s71 offen offset:1024 lds
    buffer_load_dwordx4 v10, s[28:31], s71 offen offset:2048 lds
    buffer_load_dwordx4 v11, s[28:31], s71 offen offset:3072 lds
    s_add_u32 m0, s65, 49152
    s_add_u32 s71, s85, s88
    s_add_i32 s71, s71, -1024
    buffer_load_dwordx4 v8, s[28:31], s71 offen offset:0 lds
    buffer_load_dwordx4 v9, s[28:31], s71 offen offset:1024 lds
    buffer_load_dwordx4 v10, s[28:31], s71 offen offset:2048 lds
    buffer_load_dwordx4 v11, s[28:31], s71 offen offset:3072 lds
    s_waitcnt vmcnt(17)
    s_barrier
    s_add_u32 m0, s65, 65536
    s_add_u32 s71, s82, 0
    buffer_load_dwordx4 v4, s[24:27], s71 offen offset:0 lds
    buffer_load_dwordx4 v5, s[24:27], s71 offen offset:1024 lds
    buffer_load_dwordx4 v6, s[24:27], s71 offen offset:2048 lds
    buffer_load_dwordx4 v7, s[24:27], s71 offen offset:3072 lds
    s_add_u32 m0, s65, 81920
    s_add_u32 s71, s82, 128
    buffer_load_dwordx4 v4, s[24:27], s71 offen offset:0 lds
    buffer_load_dwordx4 v5, s[24:27], s71 offen offset:1024 lds
    buffer_load_dwordx4 v6, s[24:27], s71 offen offset:2048 lds
    buffer_load_dwordx4 v7, s[24:27], s71 offen offset:3072 lds
    s_lshr_b32 s3, s65, 2
    s_add_u32 m0, s3, 122880
    s_and_b32 s3, s82, 0x300
    buffer_load_dwordx4 v19, s[24:27], s3 offen lds
    s_lshl_b32 s79, s60, 2
    s_mov_b32 s69, 400000
    s_and_b32 s66, s62, 1
    s_lshl_b32 s3, s62, 8
    s_lshr_b32 s67, s60, 1
    s_lshl_b32 s67, s67, 7
    s_add_u32 s3, s3, s67
    s_and_b32 s67, s60, 1
    s_lshl_b32 s67, s67, 15
    s_add_u32 s3, s3, s67
    s_mul_i32 s90, s64, 458752
    s_add_u32 s90, s90, s3
    s_lshl_b32 s91, s64, 17
    s_add_u32 s91, s91, s3
    s_lshl_b32 s93, s66, 16
    s_lshl_b32 s3, s61, 2
    s_add_u32 s3, s3, s64
    s_mul_i32 s89, s3, 147456
    s_lshl_b32 s67, s60, 11
    s_add_u32 s89, s89, s67
    s_lshl_b32 s75, s3, 2
    s_add_u32 s75, s75, s62
    s_lshl_b32 s75, s75, 2
    s_add_u32 s75, s75, s60
    s_lshl_b32 s75, s75, 7
    v_lshlrev_b32 v16, 4, v0
    v_and_b32 v17, 3, v0
    v_lshlrev_b32 v17, 2, v17
    v_add_u32 v17, 151552, v17
    v_lshrrev_b32 v1, 3, v0
    v_lshrrev_b32 v2, 4, v0
    v_lshlrev_b32 v2, 1, v2
    v_and_b32 v12, 7, v0
    v_xor_b32 v12, v12, v2
    v_lshlrev_b32 v12, 4, v12
    v_lshl_add_u32 v12, v1, 10, v12
    v_add_u32 v13, 7168, v12
    v_add_u32 v14, 14336, v12
    v_add_u32 v15, 21504, v12
    s_waitcnt vmcnt(13)
    s_barrier
    s_add_u32 m0, s65, 98304
    s_add_u32 s71, s86, s88
    buffer_load_dwordx4 v8, s[28:31], s71 offen offset:0 lds
    buffer_load_dwordx4 v9, s[28:31], s71 offen offset:1024 lds
    buffer_load_dwordx4 v10, s[28:31], s71 offen offset:2048 lds
    buffer_load_dwordx4 v11, s[28:31], s71 offen offset:3072 lds
    s_add_u32 m0, s65, 0
    s_add_u32 s71, s86, s88
    s_add_i32 s71, s71, -1024
    buffer_load_dwordx4 v8, s[28:31], s71 offen offset:0 lds
    buffer_load_dwordx4 v9, s[28:31], s71 offen offset:1024 lds
    buffer_load_dwordx4 v10, s[28:31], s71 offen offset:2048 lds
    buffer_load_dwordx4 v11, s[28:31], s71 offen offset:3072 lds
    s_add_u32 s3, s65, 135168
    v_add_u32 v56, s3, v16
    v_bfe_u32 v1, v0, 3, 1
    v_lshlrev_b32 v1, 12, v1
    v_sub_u32 v58, v56, v1
    v_xor_b32 v1, 4096, v1
    v_sub_u32 v57, v56, v1
    v_lshrrev_b32 v1, 5, v0
    v_lshlrev_b32 v1, 12, v1
    v_sub_u32 v60, v56, v1
    v_xor_b32 v1, 4096, v1
    v_sub_u32 v59, v56, v1
    v_add_u32 v61, 4294832128, v56
    s_mov_b32 s76, 1052289595
    s_or_b32 s3, s61, s60
    s_cmp_eq_u32 s3, 0
    s_cselect_b32 s77, -16, -9
    v_mov_b32 v48, 0x3f803f80
    v_accvgpr_write_b32 a96, v48
    v_accvgpr_write_b32 a97, v48
    v_accvgpr_write_b32 a98, v48
    v_accvgpr_write_b32 a99, v48
    v_mov_b32 v48, 4048155338
    v_and_b32 v49, 15, v0
    v_lshrrev_b32 v50, 4, v0
    v_lshlrev_b32 v50, 2, v50
    v_xor_b32 v51, 8, v49
    v_xor_b32 v52, 8, v50
    v_sub_u32 v51, v51, v52
    v_subrev_u32 v52, 0, v51
    v_cmp_lt_u32 vcc, 7, v52
    v_cmp_lt_i32 s[56:57], s77, v52
    s_nop 0
    s_and_b64 vcc, vcc, s[56:57]
    v_cndmask_b32 v32, 0, v48, vcc
    v_subrev_u32 v52, 1, v51
    v_cmp_lt_u32 vcc, 7, v52
    v_cmp_lt_i32 s[56:57], s77, v52
    s_nop 0
    s_and_b64 vcc, vcc, s[56:57]
    v_cndmask_b32 v33, 0, v48, vcc
    v_subrev_u32 v52, 2, v51
    v_cmp_lt_u32 vcc, 7, v52
    v_cmp_lt_i32 s[56:57], s77, v52
    s_nop 0
    s_and_b64 vcc, vcc, s[56:57]
    v_cndmask_b32 v34, 0, v48, vcc
    v_subrev_u32 v52, 3, v51
    v_cmp_lt_u32 vcc, 7, v52
    v_cmp_lt_i32 s[56:57], s77, v52
    s_nop 0
    s_and_b64 vcc, vcc, s[56:57]
    v_cndmask_b32 v35, 0, v48, vcc
    s_waitcnt vmcnt(17)
    s_barrier
    s_add_u32 m0, s65, 131072
    s_add_u32 s71, s83, 0
    buffer_load_dwordx4 v4, s[24:27], s71 offen offset:0 lds
    buffer_load_dwordx4 v5, s[24:27], s71 offen offset:1024 lds
    buffer_load_dwordx4 v6, s[24:27], s71 offen offset:2048 lds
    buffer_load_dwordx4 v7, s[24:27], s71 offen offset:3072 lds
    s_add_u32 m0, s65, 147456
    s_add_u32 s71, s83, 128
    buffer_load_dwordx4 v4, s[24:27], s71 offen offset:0 lds
    buffer_load_dwordx4 v5, s[24:27], s71 offen offset:1024 lds
    buffer_load_dwordx4 v6, s[24:27], s71 offen offset:2048 lds
    buffer_load_dwordx4 v7, s[24:27], s71 offen offset:3072 lds
    s_lshr_b32 s3, s65, 2
    s_add_u32 m0, s3, 126976
    s_and_b32 s3, s83, 0x300
    buffer_load_dwordx4 v19, s[24:27], s3 offen lds
    s_waitcnt vmcnt(13)
    s_barrier
    s_add_u32 m0, s65, 16384
    s_add_u32 s71, s87, s88
    buffer_load_dwordx4 v8, s[28:31], s71 offen offset:0 lds
    buffer_load_dwordx4 v9, s[28:31], s71 offen offset:1024 lds
    buffer_load_dwordx4 v10, s[28:31], s71 offen offset:2048 lds
    buffer_load_dwordx4 v11, s[28:31], s71 offen offset:3072 lds
    s_add_u32 m0, s65, 32768
    s_add_u32 s71, s87, s88
    s_add_i32 s71, s71, -1024
    buffer_load_dwordx4 v8, s[28:31], s71 offen offset:0 lds
    buffer_load_dwordx4 v9, s[28:31], s71 offen offset:1024 lds
    buffer_load_dwordx4 v10, s[28:31], s71 offen offset:2048 lds
    buffer_load_dwordx4 v11, s[28:31], s71 offen offset:3072 lds
    v_xor_b32 v51, 0, v49
    v_xor_b32 v52, 0, v50
    v_sub_u32 v51, v51, v52
    v_subrev_u32 v52, 0, v51
    v_cmp_lt_u32 vcc, 7, v52
    v_cmp_lt_i32 s[56:57], s77, v52
    s_nop 0
    s_and_b64 vcc, vcc, s[56:57]
    v_cndmask_b32 v36, 0, v48, vcc
    v_subrev_u32 v52, 1, v51
    v_cmp_lt_u32 vcc, 7, v52
    v_cmp_lt_i32 s[56:57], s77, v52
    s_nop 0
    s_and_b64 vcc, vcc, s[56:57]
    v_cndmask_b32 v37, 0, v48, vcc
    v_subrev_u32 v52, 2, v51
    v_cmp_lt_u32 vcc, 7, v52
    v_cmp_lt_i32 s[56:57], s77, v52
    s_nop 0
    s_and_b64 vcc, vcc, s[56:57]
    v_cndmask_b32 v38, 0, v48, vcc
    v_subrev_u32 v52, 3, v51
    v_cmp_lt_u32 vcc, 7, v52
    v_cmp_lt_i32 s[56:57], s77, v52
    s_nop 0
    s_and_b64 vcc, vcc, s[56:57]
    v_cndmask_b32 v39, 0, v48, vcc
    v_mov_b32 v64, 0
    v_mov_b32 v65, 0
    v_mov_b32 v66, 0
    v_mov_b32 v67, 0
    v_mov_b32 v68, 0
    v_mov_b32 v69, 0
    v_mov_b32 v70, 0
    v_mov_b32 v71, 0
    v_mov_b32 v72, 0
    v_mov_b32 v73, 0
    v_mov_b32 v74, 0
    v_mov_b32 v75, 0
    v_mov_b32 v76, 0
    v_mov_b32 v77, 0
    v_mov_b32 v78, 0
    v_mov_b32 v79, 0
    s_mov_b32 s56, 0xff00ff00
    s_mov_b32 s57, 0xff00ff00
    s_not_b64 s[58:59], s[56:57]
    s_waitcnt vmcnt(17)
    s_barrier
    s_add_u32 m0, s65, 49152
    s_add_u32 s71, s84, s88
    s_add_i32 s71, s71, 1024
    buffer_load_dwordx4 v8, s[28:31], s71 offen offset:0 lds
    buffer_load_dwordx4 v9, s[28:31], s71 offen offset:1024 lds
    buffer_load_dwordx4 v10, s[28:31], s71 offen offset:2048 lds
    buffer_load_dwordx4 v11, s[28:31], s71 offen offset:3072 lds
    s_add_u32 m0, s65, 65536
    s_add_u32 s71, s85, s88
    s_add_i32 s71, s71, 1024
    buffer_load_dwordx4 v8, s[28:31], s71 offen offset:0 lds
    buffer_load_dwordx4 v9, s[28:31], s71 offen offset:1024 lds
    buffer_load_dwordx4 v10, s[28:31], s71 offen offset:2048 lds
    buffer_load_dwordx4 v11, s[28:31], s71 offen offset:3072 lds
    s_waitcnt vmcnt(12)
    s_barrier
    s_add_u32 m0, s65, 81920
    s_add_u32 s71, s86, s88
    s_add_i32 s71, s71, 1024
    buffer_load_dwordx4 v8, s[28:31], s71 offen offset:0 lds
    buffer_load_dwordx4 v9, s[28:31], s71 offen offset:1024 lds
    buffer_load_dwordx4 v10, s[28:31], s71 offen offset:2048 lds
    buffer_load_dwordx4 v11, s[28:31], s71 offen offset:3072 lds
    s_add_u32 m0, s65, 98304
    s_add_u32 s71, s87, s88
    s_add_i32 s71, s71, 1024
    buffer_load_dwordx4 v8, s[28:31], s71 offen offset:0 lds
    buffer_load_dwordx4 v9, s[28:31], s71 offen offset:1024 lds
    buffer_load_dwordx4 v10, s[28:31], s71 offen offset:2048 lds
    buffer_load_dwordx4 v11, s[28:31], s71 offen offset:3072 lds
    v_mov_b32 v80, 0
    v_mov_b32 v81, 0
    v_mov_b32 v82, 0
    v_mov_b32 v83, 0
    v_mov_b32 v84, 0
    v_mov_b32 v85, 0
    v_mov_b32 v86, 0
    v_mov_b32 v87, 0
    v_mov_b32 v88, 0
    v_mov_b32 v89, 0
    v_mov_b32 v90, 0
    v_mov_b32 v91, 0
    v_mov_b32 v92, 0
    v_mov_b32 v93, 0
    v_mov_b32 v94, 0
    v_mov_b32 v95, 0
    s_mov_b32 s56, 0xff00ff00
    s_mov_b32 s57, 0xff00ff00
    s_not_b64 s[58:59], s[56:57]
    s_lshl_b32 s3, s61, 2
    s_add_u32 s3, s3, s60
    s_mul_i32 s67, s3, 24576
    s_mul_i32 s68, s64, 256
    s_add_u32 s67, s67, s68
    v_and_b32 v1, 7, v0
    v_mul_u32_u24 v1, 3072, v1
    s_lshl_b32 s68, s66, 7
    s_add_u32 s68, s68, s67
    v_lshlrev_b32 v2, 7, v0
    s_mov_b64 exec, 0xff
    buffer_load_dword v18, v1, s[28:31], s68 offen offset:2048
    s_lshl_b32 s3, s3, 2
    s_add_u32 s3, s3, s62
    s_mul_i32 s67, s3, 1792
    s_mul_i32 s68, s64, 458752
    s_add_u32 s67, s67, s68
    s_mov_b64 exec, 16383
    buffer_load_dword v18, v2, s[40:43], s67 offen
    s_lshl_b32 s67, s3, 9
    s_lshl_b32 s68, s64, 17
    s_add_u32 s67, s67, s68
    s_mov_b64 exec, 15
    buffer_load_dword v18, v2, s[44:47], s67 offen
    s_mov_b64 exec, -1
    s_waitcnt vmcnt(19)
    s_barrier
    s_cmp_eq_u32 s60, 0
    s_cbranch_scc0 L_w036
    s_load_dword s74, s[54:55], 0 glc
L_w036:
    v_lshrrev_b32 v1, 2, v0
    v_bfe_u32 v2, v0, 3, 2
    v_lshlrev_b32 v1, 7, v1
    v_lshl_add_u32 v1, v2, 5, v1
    v_and_b32 v2, 3, v0
    v_lshl_add_u32 v1, v2, 3, v1
    s_lshr_b32 s3, s64, 1
    s_lshl_b32 s3, s3, 13
    s_and_b32 s67, s64, 1
    s_lshl_b32 s67, s67, 6
    s_or_b32 s3, s3, s67
    v_xor_b32 v1, s3, v1
    v_xor_b32 v24, 8256, v1
    v_xor_b32 v25, 8288, v1
    v_xor_b32 v26, 8192, v1
    v_xor_b32 v27, 8224, v1
    v_xor_b32 v28, 64, v1
    v_xor_b32 v29, 96, v1
    v_xor_b32 v30, 0, v1
    v_xor_b32 v31, 32, v1
    s_lshl_b32 s92, s61, 2
    s_add_u32 s92, s92, s62
    s_mul_i32 s92, s92, 98304
    s_lshl_b32 s3, s60, 11
    s_add_u32 s92, s92, s3
    s_add_u32 s92, s92, 10485760
    s_waitcnt vmcnt(15)
    s_barrier
    ds_read_b64 a[64:65], v57 offset:0
    ds_read_b128 a[66:69], v56 offset:0
    ds_read_b64 a[70:71], v58 offset:8
    ds_read_b64 a[72:73], v57 offset:1024
    ds_read_b128 a[74:77], v56 offset:1024
    ds_read_b64 a[78:79], v58 offset:1032
    ds_read_b64 a[80:81], v57 offset:2048
    ds_read_b128 a[82:85], v56 offset:2048
    ds_read_b64 a[86:87], v58 offset:2056
    ds_read_b64 a[88:89], v57 offset:3072
    ds_read_b128 a[90:93], v56 offset:3072
    ds_read_b64 a[94:95], v58 offset:3080
    s_waitcnt lgkmcnt(0)
    s_waitcnt vmcnt(3)
    s_cmp_eq_u32 s60, 0
    s_cbranch_scc0 L_w037
    s_waitcnt lgkmcnt(0)
    s_cmp_ge_u32 s74, 16
    s_cbranch_scc0 L_pp38
L_po39:
L_w037:
    s_mov_b32 s74, 0
    s_barrier
    s_mov_b64 exec, s[56:57]
    ds_read_b64 v[64:65], v61 offset:0
    ds_read_b64 v[68:69], v61 offset:8
    ds_read_b64 v[72:73], v61 offset:1024
    ds_read_b64 v[76:77], v61 offset:1032
    ds_read_b64 v[80:81], v61 offset:2048
    ds_read_b64 v[84:85], v61 offset:2056
    ds_read_b64 v[88:89], v61 offset:3072
    ds_read_b64 v[92:93], v61 offset:3080
    s_mov_b64 exec, s[58:59]
    ds_read_b64 v[66:67], v61 offset:0
    ds_read_b64 v[70:71], v61 offset:8
    ds_read_b64 v[74:75], v61 offset:1024
    ds_read_b64 v[78:79], v61 offset:1032
    ds_read_b64 v[82:83], v61 offset:2048
    ds_read_b64 v[86:87], v61 offset:2056
    ds_read_b64 v[90:91], v61 offset:3072
    ds_read_b64 v[94:95], v61 offset:3080
    s_mov_b64 exec, -1
    s_waitcnt lgkmcnt(0)
    v_mfma_f32_16x16x32_bf16 v[96:99], a[64:67], v[64:67], v[32:35]
    v_mfma_f32_16x16x32_bf16 v[100:103], a[68:71], v[68:71], v[36:39]
    v_mfma_f32_16x16x32_bf16 v[104:107], a[72:75], v[72:75], v[32:35]
    v_mfma_f32_16x16x32_bf16 v[108:111], a[76:79], v[76:79], v[36:39]
    v_mfma_f32_16x16x32_bf16 v[112:115], a[80:83], v[80:83], v[32:35]
    v_mfma_f32_16x16x32_bf16 v[116:119], a[84:87], v[84:87], v[36:39]
    v_mfma_f32_16x16x32_bf16 v[120:123], a[88:91], v[88:91], v[32:35]
    v_mfma_f32_16x16x32_bf16 v[124:127], a[92:95], v[92:95], v[36:39]
    s_load_dword s74, s[52:53], s75 glc
    s_add_u32 m0, s65, 0
    s_add_u32 s71, s90, 0
    buffer_load_dwordx4 v12, s[40:43], s71 offen offset:0 lds
    buffer_load_dwordx4 v13, s[40:43], s71 offen offset:1024 lds
    buffer_load_dwordx4 v14, s[40:43], s71 offen offset:2048 lds
    buffer_load_dwordx4 v15, s[40:43], s71 offen offset:3072 lds
    v_max3_f32 v48, v96, v97, v98
    v_max_f32 v48, v48, v99
    v_max3_f32 v49, v100, v101, v102
    v_max_f32 v49, v49, v103
    v_max3_f32 v50, v104, v105, v106
    v_max_f32 v50, v50, v107
    v_max3_f32 v51, v108, v109, v110
    v_max_f32 v51, v51, v111
    v_max3_f32 v52, v112, v113, v114
    v_max_f32 v52, v52, v115
    v_max3_f32 v53, v116, v117, v118
    v_max_f32 v53, v53, v119
    v_max3_f32 v54, v120, v121, v122
    v_max_f32 v54, v54, v123
    v_max3_f32 v55, v124, v125, v126
    v_max_f32 v55, v55, v127
    v_permlane32_swap_b32 v48, v49
    v_permlane32_swap_b32 v50, v51
    v_permlane32_swap_b32 v52, v53
    v_permlane32_swap_b32 v54, v55
    v_max_f32 v48, v48, v49
    v_max_f32 v50, v50, v51
    v_max_f32 v52, v52, v53
    v_max_f32 v54, v54, v55
    v_permlane16_swap_b32 v48, v50
    s_nop 0
    v_permlane16_swap_b32 v52, v54
    v_max_f32 v48, v48, v50
    v_max_f32 v52, v52, v54
    v_mul_f32 v50, s76, v48
    v_mul_f32 v54, s76, v52
    v_mul_f32 v48, s76, v48
    v_mul_f32 v52, s76, v52
    s_nop 0
    v_permlane16_swap_b32 v48, v50
    v_permlane16_swap_b32 v52, v54
    v_mov_b32 v49, v48
    v_mov_b32 v51, v50
    v_mov_b32 v53, v52
    v_mov_b32 v55, v54
    v_permlane32_swap_b32 v48, v49
    v_permlane32_swap_b32 v50, v51
    v_permlane32_swap_b32 v52, v53
    v_permlane32_swap_b32 v54, v55
    s_add_u32 m0, s65, 16384
    s_add_u32 s71, s90, 65536
    buffer_load_dwordx4 v12, s[40:43], s71 offen offset:0 lds
    buffer_load_dwordx4 v13, s[40:43], s71 offen offset:1024 lds
    buffer_load_dwordx4 v14, s[40:43], s71 offen offset:2048 lds
    buffer_load_dwordx4 v15, s[40:43], s71 offen offset:3072 lds
    v_fma_f32 v96, v96, s76, -v48
    v_fma_f32 v97, v97, s76, -v48
    v_fma_f32 v98, v98, s76, -v48
    v_fma_f32 v99, v99, s76, -v48
    v_exp_f32 v96, v96
    v_exp_f32 v97, v97
    v_exp_f32 v98, v98
    v_exp_f32 v99, v99
    v_fma_f32 v100, v100, s76, -v49
    v_fma_f32 v101, v101, s76, -v49
    v_fma_f32 v102, v102, s76, -v49
    v_fma_f32 v103, v103, s76, -v49
    v_exp_f32 v100, v100
    v_exp_f32 v101, v101
    v_exp_f32 v102, v102
    v_exp_f32 v103, v103
    v_fma_f32 v104, v104, s76, -v50
    v_fma_f32 v105, v105, s76, -v50
    v_fma_f32 v106, v106, s76, -v50
    v_fma_f32 v107, v107, s76, -v50
    v_exp_f32 v104, v104
    v_exp_f32 v105, v105
    v_exp_f32 v106, v106
    v_exp_f32 v107, v107
    v_fma_f32 v108, v108, s76, -v51
    v_fma_f32 v109, v109, s76, -v51
    v_fma_f32 v110, v110, s76, -v51
    v_fma_f32 v111, v111, s76, -v51
    v_exp_f32 v108, v108
    v_exp_f32 v109, v109
    v_exp_f32 v110, v110
    v_exp_f32 v111, v111
    v_fma_f32 v112, v112, s76, -v52
    v_fma_f32 v113, v113, s76, -v52
    v_fma_f32 v114, v114, s76, -v52
    v_fma_f32 v115, v115, s76, -v52
    v_exp_f32 v112, v112
    v_exp_f32 v113, v113
    v_exp_f32 v114, v114
    v_exp_f32 v115, v115
    s_andn2_b32 s70, 17, s74
    s_cbranch_scc1 L_pl41
L_pk40:
    s_load_dword s74, s[52:53], s75 glc
    s_add_u32 s67, s89, 0
    buffer_load_dwordx4 a[0:3], v16, s[32:35], s67 offen offset:0 sc1
    buffer_load_dwordx4 a[4:7], v16, s[32:35], s67 offen offset:1024 sc1
    v_fma_f32 v116, v116, s76, -v53
    v_fma_f32 v117, v117, s76, -v53
    v_fma_f32 v118, v118, s76, -v53
    v_fma_f32 v119, v119, s76, -v53
    v_exp_f32 v116, v116
    v_exp_f32 v117, v117
    v_exp_f32 v118, v118
    v_exp_f32 v119, v119
    s_add_u32 s67, s89, 8192
    buffer_load_dwordx4 a[8:11], v16, s[32:35], s67 offen offset:0 sc1
    buffer_load_dwordx4 a[12:15], v16, s[32:35], s67 offen offset:1024 sc1
    v_fma_f32 v120, v120, s76, -v54
    v_fma_f32 v121, v121, s76, -v54
    v_fma_f32 v122, v122, s76, -v54
    v_fma_f32 v123, v123, s76, -v54
    v_exp_f32 v120, v120
    v_exp_f32 v121, v121
    v_exp_f32 v122, v122
    v_exp_f32 v123, v123
    s_add_u32 s67, s89, 16384
    buffer_load_dwordx4 a[16:19], v16, s[32:35], s67 offen offset:0 sc1
    buffer_load_dwordx4 a[20:23], v16, s[32:35], s67 offen offset:1024 sc1
    v_fma_f32 v124, v124, s76, -v55
    v_fma_f32 v125, v125, s76, -v55
    v_fma_f32 v126, v126, s76, -v55
    v_fma_f32 v127, v127, s76, -v55
    v_exp_f32 v124, v124
    v_exp_f32 v125, v125
    v_exp_f32 v126, v126
    v_exp_f32 v127, v127
    s_add_u32 s67, s89, 24576
    buffer_load_dwordx4 a[24:27], v16, s[32:35], s67 offen offset:0 sc1
    buffer_load_dwordx4 a[28:31], v16, s[32:35], s67 offen offset:1024 sc1
    s_add_u32 m0, s65, 32768
    s_add_u32 s71, s90, 131072
    buffer_load_dwordx4 v12, s[40:43], s71 offen offset:0 lds
    buffer_load_dwordx4 v13, s[40:43], s71 offen offset:1024 lds
    buffer_load_dwordx4 v14, s[40:43], s71 offen offset:2048 lds
    buffer_load_dwordx4 v15, s[40:43], s71 offen offset:3072 lds
    s_add_u32 m0, s79, 151552
    s_mov_b64 exec, 1
    buffer_load_dword v16, s[44:47], s46 offen lds
    s_mov_b64 exec, -1
    s_mov_b64 exec, s[56:57]
    v_cvt_pk_bf16_f32 v64, v96, v97
    v_cvt_pk_bf16_f32 v65, v98, v99
    v_cvt_pk_bf16_f32 v68, v100, v101
    v_cvt_pk_bf16_f32 v69, v102, v103
    v_cvt_pk_bf16_f32 v72, v104, v105
    v_cvt_pk_bf16_f32 v73, v106, v107
    v_cvt_pk_bf16_f32 v76, v108, v109
    v_cvt_pk_bf16_f32 v77, v110, v111
    v_cvt_pk_bf16_f32 v80, v112, v113
    v_cvt_pk_bf16_f32 v81, v114, v115
    v_cvt_pk_bf16_f32 v84, v116, v117
    v_cvt_pk_bf16_f32 v85, v118, v119
    v_cvt_pk_bf16_f32 v88, v120, v121
    v_cvt_pk_bf16_f32 v89, v122, v123
    v_cvt_pk_bf16_f32 v92, v124, v125
    v_cvt_pk_bf16_f32 v93, v126, v127
    s_mov_b64 exec, s[58:59]
    v_cvt_pk_bf16_f32 v66, v96, v97
    v_cvt_pk_bf16_f32 v67, v98, v99
    v_cvt_pk_bf16_f32 v70, v100, v101
    v_cvt_pk_bf16_f32 v71, v102, v103
    v_cvt_pk_bf16_f32 v74, v104, v105
    v_cvt_pk_bf16_f32 v75, v106, v107
    v_cvt_pk_bf16_f32 v78, v108, v109
    v_cvt_pk_bf16_f32 v79, v110, v111
    v_cvt_pk_bf16_f32 v82, v112, v113
    v_cvt_pk_bf16_f32 v83, v114, v115
    v_cvt_pk_bf16_f32 v86, v116, v117
    v_cvt_pk_bf16_f32 v87, v118, v119
    v_cvt_pk_bf16_f32 v90, v120, v121
    v_cvt_pk_bf16_f32 v91, v122, v123
    v_cvt_pk_bf16_f32 v94, v124, v125
    v_cvt_pk_bf16_f32 v95, v126, v127
    s_mov_b64 exec, -1
    v_mfma_f32_16x16x32_bf16 v[96:99], a[96:99], v[64:67], 0
    v_mfma_f32_16x16x32_bf16 v[100:103], a[96:99], v[68:71], 0
    v_mfma_f32_16x16x32_bf16 v[104:107], a[96:99], v[72:75], 0
    v_mfma_f32_16x16x32_bf16 v[108:111], a[96:99], v[76:79], 0
    v_mfma_f32_16x16x32_bf16 v[112:115], a[96:99], v[80:83], 0
    v_mfma_f32_16x16x32_bf16 v[116:119], a[96:99], v[84:87], 0
    v_mfma_f32_16x16x32_bf16 v[120:123], a[96:99], v[88:91], 0
    v_mfma_f32_16x16x32_bf16 v[124:127], a[96:99], v[92:95], 0
    s_nop 0
    v_rcp_f32 v40, v96
    v_rcp_f32 v41, v100
    v_rcp_f32 v42, v104
    v_rcp_f32 v43, v108
    v_rcp_f32 v44, v112
    v_rcp_f32 v45, v116
    v_rcp_f32 v46, v120
    v_rcp_f32 v47, v124
    s_waitcnt vmcnt(13)
    s_andn2_b32 s70, 34, s74
    s_cbranch_scc1 L_pl43
L_pk42:
    s_add_u32 s67, s89, 32768
    buffer_load_dwordx4 a[32:35], v16, s[32:35], s67 offen offset:0 sc1
    buffer_load_dwordx4 a[36:39], v16, s[32:35], s67 offen offset:1024 sc1
    s_add_u32 s67, s89, 40960
    buffer_load_dwordx4 a[40:43], v16, s[32:35], s67 offen offset:0 sc1
    buffer_load_dwordx4 a[44:47], v16, s[32:35], s67 offen offset:1024 sc1
    s_add_u32 s67, s89, 49152
    buffer_load_dwordx4 a[48:51], v16, s[32:35], s67 offen offset:0 sc1
    buffer_load_dwordx4 a[52:55], v16, s[32:35], s67 offen offset:1024 sc1
    s_add_u32 s67, s89, 57344
    buffer_load_dwordx4 a[56:59], v16, s[32:35], s67 offen offset:0 sc1
    buffer_load_dwordx4 a[60:63], v16, s[32:35], s67 offen offset:1024 sc1
    s_barrier
    ds_read_b64 a[64:65], v59 offset:0
    ds_read_b128 a[66:69], v56 offset:0
    ds_read_b64 a[70:71], v60 offset:8
    ds_read_b64 a[72:73], v59 offset:1024
    ds_read_b128 a[74:77], v56 offset:1024
    ds_read_b64 a[78:79], v60 offset:1032
    ds_read_b64 a[80:81], v59 offset:2048
    ds_read_b128 a[82:85], v56 offset:2048
    ds_read_b64 a[86:87], v60 offset:2056
    ds_read_b64 a[88:89], v59 offset:3072
    ds_read_b128 a[90:93], v56 offset:3072
    ds_read_b64 a[94:95], v60 offset:3080
    s_waitcnt lgkmcnt(0)
    s_barrier
    v_mfma_f32_16x16x32_bf16 v[96:99], a[64:67], v[64:67], 0
    v_mfma_f32_16x16x32_bf16 v[100:103], a[68:71], v[68:71], 0
    v_mfma_f32_16x16x32_bf16 v[104:107], a[72:75], v[72:75], 0
    v_mfma_f32_16x16x32_bf16 v[108:111], a[76:79], v[76:79], 0
    v_mfma_f32_16x16x32_bf16 v[112:115], a[80:83], v[80:83], 0
    v_mfma_f32_16x16x32_bf16 v[116:119], a[84:87], v[84:87], 0
    v_mfma_f32_16x16x32_bf16 v[120:123], a[88:91], v[88:91], 0
    v_mfma_f32_16x16x32_bf16 v[124:127], a[92:95], v[92:95], 0
    s_nop 0
    v_pk_mul_f32 v[96:97], v[96:97], v[40:41] op_sel:[0,0] op_sel_hi:[1,0]
    v_pk_mul_f32 v[98:99], v[98:99], v[40:41] op_sel:[0,0] op_sel_hi:[1,0]
    v_cvt_pk_bf16_f32 v56, v96, v97
    v_cvt_pk_bf16_f32 v57, v98, v99
    v_pk_mul_f32 v[100:101], v[100:101], v[40:41] op_sel:[0,1] op_sel_hi:[1,1]
    v_pk_mul_f32 v[102:103], v[102:103], v[40:41] op_sel:[0,1] op_sel_hi:[1,1]
    v_cvt_pk_bf16_f32 v60, v100, v101
    v_cvt_pk_bf16_f32 v61, v102, v103
    v_pk_mul_f32 v[104:105], v[104:105], v[42:43] op_sel:[0,0] op_sel_hi:[1,0]
    v_pk_mul_f32 v[106:107], v[106:107], v[42:43] op_sel:[0,0] op_sel_hi:[1,0]
    v_cvt_pk_bf16_f32 v58, v104, v105
    v_cvt_pk_bf16_f32 v59, v106, v107
    v_pk_mul_f32 v[108:109], v[108:109], v[42:43] op_sel:[0,1] op_sel_hi:[1,1]
    v_pk_mul_f32 v[110:111], v[110:111], v[42:43] op_sel:[0,1] op_sel_hi:[1,1]
    v_cvt_pk_bf16_f32 v62, v108, v109
    v_cvt_pk_bf16_f32 v63, v110, v111
    s_lshr_b32 s67, s93, 2
    s_xor_b32 s67, s67, 0
    s_add_u32 s67, s67, s89
    s_add_u32 s67, s67, 114688
    buffer_store_dwordx4 v[56:59], v16, s[32:35], s67 offen offset:0 sc1
    buffer_store_dwordx4 v[60:63], v16, s[32:35], s67 offen offset:1024 sc1
    v_pk_mul_f32 v[112:113], v[112:113], v[44:45] op_sel:[0,0] op_sel_hi:[1,0]
    v_pk_mul_f32 v[114:115], v[114:115], v[44:45] op_sel:[0,0] op_sel_hi:[1,0]
    v_cvt_pk_bf16_f32 v4, v112, v113
    v_cvt_pk_bf16_f32 v5, v114, v115
    v_pk_mul_f32 v[116:117], v[116:117], v[44:45] op_sel:[0,1] op_sel_hi:[1,1]
    v_pk_mul_f32 v[118:119], v[118:119], v[44:45] op_sel:[0,1] op_sel_hi:[1,1]
    v_cvt_pk_bf16_f32 v8, v116, v117
    v_cvt_pk_bf16_f32 v9, v118, v119
    v_pk_mul_f32 v[120:121], v[120:121], v[46:47] op_sel:[0,0] op_sel_hi:[1,0]
    v_pk_mul_f32 v[122:123], v[122:123], v[46:47] op_sel:[0,0] op_sel_hi:[1,0]
    v_cvt_pk_bf16_f32 v6, v120, v121
    v_cvt_pk_bf16_f32 v7, v122, v123
    v_pk_mul_f32 v[124:125], v[124:125], v[46:47] op_sel:[0,1] op_sel_hi:[1,1]
    v_pk_mul_f32 v[126:127], v[126:127], v[46:47] op_sel:[0,1] op_sel_hi:[1,1]
    v_cvt_pk_bf16_f32 v10, v124, v125
    v_cvt_pk_bf16_f32 v11, v126, v127
    s_lshr_b32 s67, s93, 2
    s_xor_b32 s67, s67, 8192
    s_add_u32 s67, s67, s89
    s_add_u32 s67, s67, 114688
    buffer_store_dwordx4 v[4:7], v16, s[32:35], s67 offen offset:0 sc1
    buffer_store_dwordx4 v[8:11], v16, s[32:35], s67 offen offset:1024 sc1
    s_setprio 1
    ds_read_b64_tr_b16 v[32:33], v24 offset:0
    ds_read_b64_tr_b16 v[34:35], v24 offset:2048
    ds_read_b64_tr_b16 v[36:37], v25 offset:0
    ds_read_b64_tr_b16 v[38:39], v25 offset:2048
    ds_read_b64_tr_b16 v[40:41], v26 offset:0
    ds_read_b64_tr_b16 v[42:43], v26 offset:2048
    ds_read_b64_tr_b16 v[44:45], v27 offset:0
    ds_read_b64_tr_b16 v[46:47], v27 offset:2048
    ds_read_b64_tr_b16 v[48:49], v28 offset:0
    ds_read_b64_tr_b16 v[50:51], v28 offset:2048
    s_waitcnt vmcnt(23)
    s_waitcnt lgkmcnt(6)
    v_mfma_f32_16x16x32_bf16 v[64:67], v[32:35], a[0:3], 0
    ds_read_b64_tr_b16 v[52:53], v29 offset:0
    v_mfma_f32_16x16x32_bf16 v[72:75], v[32:35], a[4:7], 0
    ds_read_b64_tr_b16 v[54:55], v29 offset:2048
    v_mfma_f32_16x16x32_bf16 v[68:71], v[36:39], a[0:3], 0
    ds_read_b64_tr_b16 v[12:13], v30 offset:0
    v_mfma_f32_16x16x32_bf16 v[76:79], v[36:39], a[4:7], 0
    ds_read_b64_tr_b16 v[14:15], v30 offset:2048
    s_waitcnt lgkmcnt(6)
    v_mfma_f32_16x16x32_bf16 v[80:83], v[40:43], a[0:3], 0
    ds_read_b64_tr_b16 v[32:33], v31 offset:0
    v_mfma_f32_16x16x32_bf16 v[88:91], v[40:43], a[4:7], 0
    ds_read_b64_tr_b16 v[34:35], v31 offset:2048
    v_mfma_f32_16x16x32_bf16 v[84:87], v[44:47], a[0:3], 0
    ds_read_b64_tr_b16 v[36:37], v24 offset:4096
    v_mfma_f32_16x16x32_bf16 v[92:95], v[44:47], a[4:7], 0
    ds_read_b64_tr_b16 v[38:39], v24 offset:6144
    s_waitcnt lgkmcnt(6)
    v_mfma_f32_16x16x32_bf16 v[96:99], v[48:51], a[0:3], 0
    ds_read_b64_tr_b16 v[40:41], v25 offset:4096
    v_mfma_f32_16x16x32_bf16 v[104:107], v[48:51], a[4:7], 0
    ds_read_b64_tr_b16 v[42:43], v25 offset:6144
    v_mfma_f32_16x16x32_bf16 v[100:103], v[52:55], a[0:3], 0
    ds_read_b64_tr_b16 v[44:45], v26 offset:4096
    v_mfma_f32_16x16x32_bf16 v[108:111], v[52:55], a[4:7], 0
    ds_read_b64_tr_b16 v[46:47], v26 offset:6144
    s_waitcnt lgkmcnt(6)
    v_mfma_f32_16x16x32_bf16 v[112:115], v[12:15], a[0:3], 0
    ds_read_b64_tr_b16 v[48:49], v27 offset:4096
    v_mfma_f32_16x16x32_bf16 v[120:123], v[12:15], a[4:7], 0
    ds_read_b64_tr_b16 v[50:51], v27 offset:6144
    v_mfma_f32_16x16x32_bf16 v[116:119], v[32:35], a[0:3], 0
    ds_read_b64_tr_b16 v[52:53], v28 offset:4096
    v_mfma_f32_16x16x32_bf16 v[124:127], v[32:35], a[4:7], 0
    ds_read_b64_tr_b16 v[54:55], v28 offset:6144
    s_waitcnt vmcnt(21)
    s_waitcnt lgkmcnt(6)
    v_mfma_f32_16x16x32_bf16 v[64:67], v[36:39], a[8:11], v[64:67]
    ds_read_b64_tr_b16 v[12:13], v29 offset:4096
    v_mfma_f32_16x16x32_bf16 v[72:75], v[36:39], a[12:15], v[72:75]
    ds_read_b64_tr_b16 v[14:15], v29 offset:6144
    s_waitcnt vmcnt(0)
    s_lshl_b32 s68, 64, s62
    s_xor_b32 s3, s75, 512
    s_atomic_or s68, s[52:53], s3
    s_xor_b32 s3, s75, 1024
    s_atomic_or s68, s[52:53], s3
    s_xor_b32 s3, s75, 1536
    s_atomic_or s68, s[52:53], s3
    v_mfma_f32_16x16x32_bf16 v[68:71], v[40:43], a[8:11], v[68:71]
    ds_read_b64_tr_b16 v[32:33], v30 offset:4096
    v_mfma_f32_16x16x32_bf16 v[76:79], v[40:43], a[12:15], v[76:79]
    ds_read_b64_tr_b16 v[34:35], v30 offset:6144
    s_waitcnt lgkmcnt(6)
    v_mfma_f32_16x16x32_bf16 v[80:83], v[44:47], a[8:11], v[80:83]
    ds_read_b64_tr_b16 v[36:37], v31 offset:4096
    v_mfma_f32_16x16x32_bf16 v[88:91], v[44:47], a[12:15], v[88:91]
    ds_read_b64_tr_b16 v[38:39], v31 offset:6144
    v_mfma_f32_16x16x32_bf16 v[84:87], v[48:51], a[8:11], v[84:87]
    ds_read_b64_tr_b16 v[40:41], v24 offset:16384
    v_mfma_f32_16x16x32_bf16 v[92:95], v[48:51], a[12:15], v[92:95]
    ds_read_b64_tr_b16 v[42:43], v24 offset:18432
    s_waitcnt lgkmcnt(6)
    v_mfma_f32_16x16x32_bf16 v[96:99], v[52:55], a[8:11], v[96:99]
    ds_read_b64_tr_b16 v[44:45], v25 offset:16384
    v_mfma_f32_16x16x32_bf16 v[104:107], v[52:55], a[12:15], v[104:107]
    ds_read_b64_tr_b16 v[46:47], v25 offset:18432
    v_mfma_f32_16x16x32_bf16 v[100:103], v[12:15], a[8:11], v[100:103]
    ds_read_b64_tr_b16 v[48:49], v26 offset:16384
    v_mfma_f32_16x16x32_bf16 v[108:111], v[12:15], a[12:15], v[108:111]
    ds_read_b64_tr_b16 v[50:51], v26 offset:18432
    s_waitcnt lgkmcnt(6)
    v_mfma_f32_16x16x32_bf16 v[112:115], v[32:35], a[8:11], v[112:115]
    ds_read_b64_tr_b16 v[52:53], v27 offset:16384
    v_mfma_f32_16x16x32_bf16 v[120:123], v[32:35], a[12:15], v[120:123]
    ds_read_b64_tr_b16 v[54:55], v27 offset:18432
    v_mfma_f32_16x16x32_bf16 v[116:119], v[36:39], a[8:11], v[116:119]
    ds_read_b64_tr_b16 v[12:13], v28 offset:16384
    v_mfma_f32_16x16x32_bf16 v[124:127], v[36:39], a[12:15], v[124:127]
    ds_read_b64_tr_b16 v[14:15], v28 offset:18432
    s_load_dword s74, s[52:53], s75 glc
    s_waitcnt lgkmcnt(6)
    v_mfma_f32_16x16x32_bf16 v[64:67], v[40:43], a[16:19], v[64:67]
    ds_read_b64_tr_b16 v[32:33], v29 offset:16384
    v_mfma_f32_16x16x32_bf16 v[72:75], v[40:43], a[20:23], v[72:75]
    ds_read_b64_tr_b16 v[34:35], v29 offset:18432
    v_mfma_f32_16x16x32_bf16 v[68:71], v[44:47], a[16:19], v[68:71]
    ds_read_b64_tr_b16 v[36:37], v24 offset:20480
    v_mfma_f32_16x16x32_bf16 v[76:79], v[44:47], a[20:23], v[76:79]
    ds_read_b64_tr_b16 v[38:39], v24 offset:22528
    s_waitcnt lgkmcnt(6)
    v_mfma_f32_16x16x32_bf16 v[80:83], v[48:51], a[16:19], v[80:83]
    ds_read_b64_tr_b16 v[40:41], v25 offset:20480
    v_mfma_f32_16x16x32_bf16 v[88:91], v[48:51], a[20:23], v[88:91]
    ds_read_b64_tr_b16 v[42:43], v25 offset:22528
    v_mfma_f32_16x16x32_bf16 v[84:87], v[52:55], a[16:19], v[84:87]
    ds_read_b64_tr_b16 v[44:45], v26 offset:20480
    v_mfma_f32_16x16x32_bf16 v[92:95], v[52:55], a[20:23], v[92:95]
    ds_read_b64_tr_b16 v[46:47], v26 offset:22528
    s_waitcnt lgkmcnt(6)
    v_mfma_f32_16x16x32_bf16 v[96:99], v[12:15], a[16:19], v[96:99]
    ds_read_b64_tr_b16 v[48:49], v27 offset:20480
    v_mfma_f32_16x16x32_bf16 v[104:107], v[12:15], a[20:23], v[104:107]
    ds_read_b64_tr_b16 v[50:51], v27 offset:22528
    ds_read_b32 v3, v17 offset:0
    v_mfma_f32_16x16x32_bf16 v[100:103], v[32:35], a[16:19], v[100:103]
    ds_read_b64_tr_b16 v[52:53], v28 offset:20480
    v_mfma_f32_16x16x32_bf16 v[108:111], v[32:35], a[20:23], v[108:111]
    ds_read_b64_tr_b16 v[54:55], v28 offset:22528
    s_waitcnt lgkmcnt(7)
    v_mfma_f32_16x16x32_bf16 v[64:67], v[36:39], a[24:27], v[64:67]
    ds_read_b64_tr_b16 v[12:13], v29 offset:20480
    v_mfma_f32_16x16x32_bf16 v[72:75], v[36:39], a[28:31], v[72:75]
    ds_read_b64_tr_b16 v[14:15], v29 offset:22528
    v_mfma_f32_16x16x32_bf16 v[68:71], v[40:43], a[24:27], v[68:71]
    s_waitcnt lgkmcnt(4)
    v_cmp_ne_u32 vcc, 0, v3
    s_cbranch_vccnz L_sp50
L_ok49:
    ds_read_b64_tr_b16 v[32:33], v24 offset:32768
    v_mfma_f32_16x16x32_bf16 v[76:79], v[40:43], a[28:31], v[76:79]
    ds_read_b64_tr_b16 v[34:35], v24 offset:34816
    v_mfma_f32_16x16x32_bf16 v[80:83], v[44:47], a[24:27], v[80:83]
    ds_read_b64_tr_b16 v[36:37], v25 offset:32768
    v_mfma_f32_16x16x32_bf16 v[88:91], v[44:47], a[28:31], v[88:91]
    ds_read_b64_tr_b16 v[38:39], v25 offset:34816
    s_lshl_b32 s3, s61, 2
    s_add_u32 s3, s3, s64
    s_lshl_b32 s3, s3, 12
    s_lshr_b32 s67, s65, 2
    s_add_u32 s3, s3, s67
    s_add_u32 s3, s3, 9961472
    buffer_load_dwordx4 v[20:23], v16, s[32:35], s3 offen sc1
    v_mfma_f32_16x16x32_bf16 v[84:87], v[48:51], a[24:27], v[84:87]
    ds_read_b64_tr_b16 v[40:41], v26 offset:32768
    v_mfma_f32_16x16x32_bf16 v[92:95], v[48:51], a[28:31], v[92:95]
    ds_read_b64_tr_b16 v[42:43], v26 offset:34816
    s_waitcnt lgkmcnt(6)
    v_mfma_f32_16x16x32_bf16 v[96:99], v[52:55], a[24:27], v[96:99]
    ds_read_b64_tr_b16 v[44:45], v27 offset:32768
    v_mfma_f32_16x16x32_bf16 v[104:107], v[52:55], a[28:31], v[104:107]
    ds_read_b64_tr_b16 v[46:47], v27 offset:34816
    v_mfma_f32_16x16x32_bf16 v[100:103], v[12:15], a[24:27], v[100:103]
    ds_read_b64_tr_b16 v[48:49], v28 offset:32768
    v_mfma_f32_16x16x32_bf16 v[108:111], v[12:15], a[28:31], v[108:111]
    ds_read_b64_tr_b16 v[50:51], v28 offset:34816
    s_waitcnt lgkmcnt(6)
    v_mfma_f32_16x16x32_bf16 v[64:67], v[32:35], a[32:35], v[64:67]
    ds_read_b64_tr_b16 v[52:53], v29 offset:32768
    v_mfma_f32_16x16x32_bf16 v[72:75], v[32:35], a[36:39], v[72:75]
    ds_read_b64_tr_b16 v[54:55], v29 offset:34816
    v_mfma_f32_16x16x32_bf16 v[68:71], v[36:39], a[32:35], v[68:71]
    ds_read_b64_tr_b16 v[12:13], v24 offset:36864
    v_mfma_f32_16x16x32_bf16 v[76:79], v[36:39], a[36:39], v[76:79]
    ds_read_b64_tr_b16 v[14:15], v24 offset:38912
    s_waitcnt lgkmcnt(6)
    v_mfma_f32_16x16x32_bf16 v[80:83], v[40:43], a[32:35], v[80:83]
    ds_read_b64_tr_b16 v[32:33], v25 offset:36864
    v_mfma_f32_16x16x32_bf16 v[88:91], v[40:43], a[36:39], v[88:91]
    ds_read_b64_tr_b16 v[34:35], v25 offset:38912
    s_andn2_b32 s70, 68, s74
    s_cbranch_scc1 L_pl52
L_pk51:
    v_mfma_f32_16x16x32_bf16 v[84:87], v[44:47], a[32:35], v[84:87]
    ds_read_b64_tr_b16 v[36:37], v26 offset:36864
    s_add_u32 s88, s89, 65536
    buffer_load_dwordx4 a[64:67], v16, s[32:35], s88 offen sc1
    v_mfma_f32_16x16x32_bf16 v[92:95], v[44:47], a[36:39], v[92:95]
    ds_read_b64_tr_b16 v[38:39], v26 offset:38912
    buffer_load_dwordx4 a[68:71], v16, s[32:35], s88 offen offset:1024 sc1
    s_waitcnt lgkmcnt(6)
    v_mfma_f32_16x16x32_bf16 v[96:99], v[48:51], a[32:35], v[96:99]
    ds_read_b64_tr_b16 v[40:41], v27 offset:36864
    s_add_u32 s88, s89, 73728
    buffer_load_dwordx4 a[72:75], v16, s[32:35], s88 offen sc1
    v_mfma_f32_16x16x32_bf16 v[104:107], v[48:51], a[36:39], v[104:107]
    ds_read_b64_tr_b16 v[42:43], v27 offset:38912
    ds_read_b32 v3, v17 offset:16
    buffer_load_dwordx4 a[76:79], v16, s[32:35], s88 offen offset:1024 sc1
    v_mfma_f32_16x16x32_bf16 v[100:103], v[52:55], a[32:35], v[100:103]
    ds_read_b64_tr_b16 v[44:45], v28 offset:36864
    s_add_u32 s88, s89, 81920
    buffer_load_dwordx4 a[80:83], v16, s[32:35], s88 offen sc1
    v_mfma_f32_16x16x32_bf16 v[108:111], v[52:55], a[36:39], v[108:111]
    ds_read_b64_tr_b16 v[46:47], v28 offset:38912
    buffer_load_dwordx4 a[84:87], v16, s[32:35], s88 offen offset:1024 sc1
    s_waitcnt lgkmcnt(7)
    v_mfma_f32_16x16x32_bf16 v[64:67], v[12:15], a[40:43], v[64:67]
    ds_read_b64_tr_b16 v[48:49], v29 offset:36864
    s_add_u32 s88, s89, 90112
    buffer_load_dwordx4 a[88:91], v16, s[32:35], s88 offen sc1
    v_mfma_f32_16x16x32_bf16 v[72:75], v[12:15], a[44:47], v[72:75]
    ds_read_b64_tr_b16 v[50:51], v29 offset:38912
    buffer_load_dwordx4 a[92:95], v16, s[32:35], s88 offen offset:1024 sc1
    v_mfma_f32_16x16x32_bf16 v[68:71], v[32:35], a[40:43], v[68:71]
    s_waitcnt lgkmcnt(4)
    v_cmp_ne_u32 vcc, 0, v3
    s_cbranch_vccnz L_sp54
L_ok53:
    ds_read_b64_tr_b16 v[52:53], v24 offset:49152
    v_mfma_f32_16x16x32_bf16 v[76:79], v[32:35], a[44:47], v[76:79]
    ds_read_b64_tr_b16 v[54:55], v24 offset:51200
    v_mfma_f32_16x16x32_bf16 v[80:83], v[36:39], a[40:43], v[80:83]
    ds_read_b64_tr_b16 v[12:13], v25 offset:49152
    v_mfma_f32_16x16x32_bf16 v[88:91], v[36:39], a[44:47], v[88:91]
    ds_read_b64_tr_b16 v[14:15], v25 offset:51200
    v_mfma_f32_16x16x32_bf16 v[84:87], v[40:43], a[40:43], v[84:87]
    ds_read_b64_tr_b16 v[32:33], v26 offset:49152
    v_mfma_f32_16x16x32_bf16 v[92:95], v[40:43], a[44:47], v[92:95]
    ds_read_b64_tr_b16 v[34:35], v26 offset:51200
    s_load_dword s74, s[52:53], s75 glc
    s_waitcnt lgkmcnt(6)
    v_mfma_f32_16x16x32_bf16 v[96:99], v[44:47], a[40:43], v[96:99]
    ds_read_b64_tr_b16 v[36:37], v27 offset:49152
    v_mfma_f32_16x16x32_bf16 v[104:107], v[44:47], a[44:47], v[104:107]
    ds_read_b64_tr_b16 v[38:39], v27 offset:51200
    v_mfma_f32_16x16x32_bf16 v[100:103], v[48:51], a[40:43], v[100:103]
    ds_read_b64_tr_b16 v[40:41], v28 offset:49152
    v_mfma_f32_16x16x32_bf16 v[108:111], v[48:51], a[44:47], v[108:111]
    ds_read_b64_tr_b16 v[42:43], v28 offset:51200
    s_waitcnt lgkmcnt(6)
    v_mfma_f32_16x16x32_bf16 v[64:67], v[52:55], a[48:51], v[64:67]
    ds_read_b64_tr_b16 v[44:45], v29 offset:49152
    v_mfma_f32_16x16x32_bf16 v[72:75], v[52:55], a[52:55], v[72:75]
    ds_read_b64_tr_b16 v[46:47], v29 offset:51200
    v_mfma_f32_16x16x32_bf16 v[68:71], v[12:15], a[48:51], v[68:71]
    ds_read_b64_tr_b16 v[48:49], v24 offset:53248
    v_mfma_f32_16x16x32_bf16 v[76:79], v[12:15], a[52:55], v[76:79]
    ds_read_b64_tr_b16 v[50:51], v24 offset:55296
    s_waitcnt lgkmcnt(6)
    v_mfma_f32_16x16x32_bf16 v[80:83], v[32:35], a[48:51], v[80:83]
    ds_read_b64_tr_b16 v[52:53], v25 offset:53248
    v_mfma_f32_16x16x32_bf16 v[88:91], v[32:35], a[52:55], v[88:91]
    ds_read_b64_tr_b16 v[54:55], v25 offset:55296
    v_mfma_f32_16x16x32_bf16 v[84:87], v[36:39], a[48:51], v[84:87]
    ds_read_b64_tr_b16 v[12:13], v26 offset:53248
    v_mfma_f32_16x16x32_bf16 v[92:95], v[36:39], a[52:55], v[92:95]
    ds_read_b64_tr_b16 v[14:15], v26 offset:55296
    s_waitcnt lgkmcnt(6)
    v_mfma_f32_16x16x32_bf16 v[96:99], v[40:43], a[48:51], v[96:99]
    ds_read_b64_tr_b16 v[32:33], v27 offset:53248
    v_mfma_f32_16x16x32_bf16 v[104:107], v[40:43], a[52:55], v[104:107]
    ds_read_b64_tr_b16 v[34:35], v27 offset:55296
    ds_read_b32 v3, v17 offset:32
    v_mfma_f32_16x16x32_bf16 v[100:103], v[44:47], a[48:51], v[100:103]
    ds_read_b64_tr_b16 v[36:37], v28 offset:53248
    v_mfma_f32_16x16x32_bf16 v[108:111], v[44:47], a[52:55], v[108:111]
    ds_read_b64_tr_b16 v[38:39], v28 offset:55296
    s_waitcnt lgkmcnt(7)
    v_mfma_f32_16x16x32_bf16 v[64:67], v[48:51], a[56:59], v[64:67]
    ds_read_b64_tr_b16 v[40:41], v29 offset:53248
    v_mfma_f32_16x16x32_bf16 v[72:75], v[48:51], a[60:63], v[72:75]
    ds_read_b64_tr_b16 v[42:43], v29 offset:55296
    v_mfma_f32_16x16x32_bf16 v[68:71], v[52:55], a[56:59], v[68:71]
    s_waitcnt lgkmcnt(4)
    v_cmp_ne_u32 vcc, 0, v3
    s_cbranch_vccnz L_sp56
L_ok55:
    v_add_u32 v24, 65536, v24
    ds_read_b64_tr_b16 v[44:45], v24 offset:0
    v_mfma_f32_16x16x32_bf16 v[76:79], v[52:55], a[60:63], v[76:79]
    ds_read_b64_tr_b16 v[46:47], v24 offset:2048
    v_mfma_f32_16x16x32_bf16 v[80:83], v[12:15], a[56:59], v[80:83]
    v_add_u32 v25, 65536, v25
    ds_read_b64_tr_b16 v[48:49], v25 offset:0
    v_mfma_f32_16x16x32_bf16 v[88:91], v[12:15], a[60:63], v[88:91]
    ds_read_b64_tr_b16 v[50:51], v25 offset:2048
    v_mfma_f32_16x16x32_bf16 v[84:87], v[32:35], a[56:59], v[84:87]
    v_add_u32 v26, 65536, v26
    ds_read_b64_tr_b16 v[52:53], v26 offset:0
    v_mfma_f32_16x16x32_bf16 v[92:95], v[32:35], a[60:63], v[92:95]
    ds_read_b64_tr_b16 v[54:55], v26 offset:2048
    s_waitcnt lgkmcnt(6)
    v_mfma_f32_16x16x32_bf16 v[96:99], v[36:39], a[56:59], v[96:99]
    v_add_u32 v27, 65536, v27
    ds_read_b64_tr_b16 v[12:13], v27 offset:0
    v_mfma_f32_16x16x32_bf16 v[104:107], v[36:39], a[60:63], v[104:107]
    ds_read_b64_tr_b16 v[14:15], v27 offset:2048
    v_mfma_f32_16x16x32_bf16 v[100:103], v[40:43], a[56:59], v[100:103]
    v_add_u32 v28, 65536, v28
    ds_read_b64_tr_b16 v[32:33], v28 offset:0
    v_mfma_f32_16x16x32_bf16 v[108:111], v[40:43], a[60:63], v[108:111]
    ds_read_b64_tr_b16 v[34:35], v28 offset:2048
    s_waitcnt vmcnt(6)
    s_waitcnt lgkmcnt(6)
    v_mfma_f32_16x16x32_bf16 v[64:67], v[44:47], a[64:67], v[64:67]
    v_add_u32 v29, 65536, v29
    ds_read_b64_tr_b16 v[36:37], v29 offset:0
    v_mfma_f32_16x16x32_bf16 v[72:75], v[44:47], a[68:71], v[72:75]
    ds_read_b64_tr_b16 v[38:39], v29 offset:2048
    s_andn2_b32 s70, 136, s74
    s_cbranch_scc1 L_pl58
L_pk57:
    v_mfma_f32_16x16x32_bf16 v[68:71], v[48:51], a[64:67], v[68:71]
    ds_read_b64_tr_b16 v[40:41], v24 offset:4096
    s_add_u32 s88, s89, 98304
    buffer_load_dwordx4 a[96:99], v16, s[32:35], s88 offen sc1
    v_mfma_f32_16x16x32_bf16 v[76:79], v[48:51], a[68:71], v[76:79]
    ds_read_b64_tr_b16 v[42:43], v24 offset:6144
    buffer_load_dwordx4 a[100:103], v16, s[32:35], s88 offen offset:1024 sc1
    s_load_dword s74, s[52:53], s75 glc
    s_waitcnt lgkmcnt(6)
    v_mfma_f32_16x16x32_bf16 v[80:83], v[52:55], a[64:67], v[80:83]
    ds_read_b64_tr_b16 v[44:45], v25 offset:4096
    s_add_u32 s88, s89, 106496
    buffer_load_dwordx4 a[104:107], v16, s[32:35], s88 offen sc1
    v_mfma_f32_16x16x32_bf16 v[88:91], v[52:55], a[68:71], v[88:91]
    ds_read_b64_tr_b16 v[46:47], v25 offset:6144
    buffer_load_dwordx4 a[108:111], v16, s[32:35], s88 offen offset:1024 sc1
    v_mfma_f32_16x16x32_bf16 v[84:87], v[12:15], a[64:67], v[84:87]
    ds_read_b64_tr_b16 v[48:49], v26 offset:4096
    v_mfma_f32_16x16x32_bf16 v[92:95], v[12:15], a[68:71], v[92:95]
    ds_read_b64_tr_b16 v[50:51], v26 offset:6144
    s_waitcnt lgkmcnt(6)
    v_mfma_f32_16x16x32_bf16 v[96:99], v[32:35], a[64:67], v[96:99]
    ds_read_b64_tr_b16 v[52:53], v27 offset:4096
    v_mfma_f32_16x16x32_bf16 v[104:107], v[32:35], a[68:71], v[104:107]
    ds_read_b64_tr_b16 v[54:55], v27 offset:6144
    ds_read_b32 v3, v17 offset:48
    v_mfma_f32_16x16x32_bf16 v[100:103], v[36:39], a[64:67], v[100:103]
    ds_read_b64_tr_b16 v[12:13], v28 offset:4096
    v_mfma_f32_16x16x32_bf16 v[108:111], v[36:39], a[68:71], v[108:111]
    ds_read_b64_tr_b16 v[14:15], v28 offset:6144
    s_waitcnt vmcnt(8)
    s_waitcnt lgkmcnt(7)
    v_mfma_f32_16x16x32_bf16 v[64:67], v[40:43], a[72:75], v[64:67]
    ds_read_b64_tr_b16 v[32:33], v29 offset:4096
    v_mfma_f32_16x16x32_bf16 v[72:75], v[40:43], a[76:79], v[72:75]
    ds_read_b64_tr_b16 v[34:35], v29 offset:6144
    v_mfma_f32_16x16x32_bf16 v[68:71], v[44:47], a[72:75], v[68:71]
    s_waitcnt lgkmcnt(4)
    v_cmp_ne_u32 vcc, 0, v3
    s_cbranch_vccnz L_sp60
L_ok59:
    ds_read_b64_tr_b16 v[36:37], v24 offset:16384
    v_mfma_f32_16x16x32_bf16 v[76:79], v[44:47], a[76:79], v[76:79]
    ds_read_b64_tr_b16 v[38:39], v24 offset:18432
    v_mfma_f32_16x16x32_bf16 v[80:83], v[48:51], a[72:75], v[80:83]
    ds_read_b64_tr_b16 v[40:41], v25 offset:16384
    v_mfma_f32_16x16x32_bf16 v[88:91], v[48:51], a[76:79], v[88:91]
    ds_read_b64_tr_b16 v[42:43], v25 offset:18432
    v_mfma_f32_16x16x32_bf16 v[84:87], v[52:55], a[72:75], v[84:87]
    ds_read_b64_tr_b16 v[44:45], v26 offset:16384
    v_mfma_f32_16x16x32_bf16 v[92:95], v[52:55], a[76:79], v[92:95]
    ds_read_b64_tr_b16 v[46:47], v26 offset:18432
    s_waitcnt lgkmcnt(6)
    v_mfma_f32_16x16x32_bf16 v[96:99], v[12:15], a[72:75], v[96:99]
    ds_read_b64_tr_b16 v[48:49], v27 offset:16384
    v_mfma_f32_16x16x32_bf16 v[104:107], v[12:15], a[76:79], v[104:107]
    ds_read_b64_tr_b16 v[50:51], v27 offset:18432
    v_mfma_f32_16x16x32_bf16 v[100:103], v[32:35], a[72:75], v[100:103]
    ds_read_b64_tr_b16 v[52:53], v28 offset:16384
    v_mfma_f32_16x16x32_bf16 v[108:111], v[32:35], a[76:79], v[108:111]
    ds_read_b64_tr_b16 v[54:55], v28 offset:18432
    s_waitcnt vmcnt(6)
    s_waitcnt lgkmcnt(6)
    v_mfma_f32_16x16x32_bf16 v[64:67], v[36:39], a[80:83], v[64:67]
    ds_read_b64_tr_b16 v[12:13], v29 offset:16384
    v_mfma_f32_16x16x32_bf16 v[72:75], v[36:39], a[84:87], v[72:75]
    ds_read_b64_tr_b16 v[14:15], v29 offset:18432
    s_xor_b32 s77, s62, 1
    s_lshl_b32 s77, 64, s77
    s_andn2_b32 s70, s77, s74
    s_cbranch_scc1 L_pl62
L_pk61:
    v_mfma_f32_16x16x32_bf16 v[68:71], v[40:43], a[80:83], v[68:71]
    ds_read_b64_tr_b16 v[32:33], v24 offset:20480
    s_lshr_b32 s88, s93, 2
    s_xor_b32 s88, s88, 16384
    s_add_u32 s88, s88, s89
    s_add_u32 s88, s88, 114688
    buffer_load_dwordx4 a[112:115], v16, s[32:35], s88 offen sc1
    v_mfma_f32_16x16x32_bf16 v[76:79], v[40:43], a[84:87], v[76:79]
    ds_read_b64_tr_b16 v[34:35], v24 offset:22528
    buffer_load_dwordx4 a[116:119], v16, s[32:35], s88 offen offset:1024 sc1
    s_waitcnt lgkmcnt(6)
    v_mfma_f32_16x16x32_bf16 v[80:83], v[44:47], a[80:83], v[80:83]
    ds_read_b64_tr_b16 v[36:37], v25 offset:20480
    s_lshr_b32 s88, s93, 2
    s_xor_b32 s88, s88, 24576
    s_add_u32 s88, s88, s89
    s_add_u32 s88, s88, 114688
    buffer_load_dwordx4 a[120:123], v16, s[32:35], s88 offen sc1
    v_mfma_f32_16x16x32_bf16 v[88:91], v[44:47], a[84:87], v[88:91]
    ds_read_b64_tr_b16 v[38:39], v25 offset:22528
    buffer_load_dwordx4 a[124:127], v16, s[32:35], s88 offen offset:1024 sc1
    v_mfma_f32_16x16x32_bf16 v[84:87], v[48:51], a[80:83], v[84:87]
    ds_read_b64_tr_b16 v[40:41], v26 offset:20480
    v_mfma_f32_16x16x32_bf16 v[92:95], v[48:51], a[84:87], v[92:95]
    ds_read_b64_tr_b16 v[42:43], v26 offset:22528
    s_waitcnt lgkmcnt(6)
    v_mfma_f32_16x16x32_bf16 v[96:99], v[52:55], a[80:83], v[96:99]
    ds_read_b64_tr_b16 v[44:45], v27 offset:20480
    v_mfma_f32_16x16x32_bf16 v[104:107], v[52:55], a[84:87], v[104:107]
    ds_read_b64_tr_b16 v[46:47], v27 offset:22528
    v_mfma_f32_16x16x32_bf16 v[100:103], v[12:15], a[80:83], v[100:103]
    ds_read_b64_tr_b16 v[48:49], v28 offset:20480
    v_mfma_f32_16x16x32_bf16 v[108:111], v[12:15], a[84:87], v[108:111]
    ds_read_b64_tr_b16 v[50:51], v28 offset:22528
    s_waitcnt vmcnt(8)
    s_waitcnt lgkmcnt(6)
    v_mfma_f32_16x16x32_bf16 v[64:67], v[32:35], a[88:91], v[64:67]
    ds_read_b64_tr_b16 v[52:53], v29 offset:20480
    v_mfma_f32_16x16x32_bf16 v[72:75], v[32:35], a[92:95], v[72:75]
    ds_read_b64_tr_b16 v[54:55], v29 offset:22528
    v_mfma_f32_16x16x32_bf16 v[68:71], v[36:39], a[88:91], v[68:71]
    ds_read_b64_tr_b16 v[12:13], v24 offset:32768
    v_mfma_f32_16x16x32_bf16 v[76:79], v[36:39], a[92:95], v[76:79]
    ds_read_b64_tr_b16 v[14:15], v24 offset:34816
    s_waitcnt lgkmcnt(6)
    v_mfma_f32_16x16x32_bf16 v[80:83], v[40:43], a[88:91], v[80:83]
    ds_read_b64_tr_b16 v[32:33], v25 offset:32768
    v_mfma_f32_16x16x32_bf16 v[88:91], v[40:43], a[92:95], v[88:91]
    ds_read_b64_tr_b16 v[34:35], v25 offset:34816
    v_mfma_f32_16x16x32_bf16 v[84:87], v[44:47], a[88:91], v[84:87]
    ds_read_b64_tr_b16 v[36:37], v26 offset:32768
    v_mfma_f32_16x16x32_bf16 v[92:95], v[44:47], a[92:95], v[92:95]
    ds_read_b64_tr_b16 v[38:39], v26 offset:34816
    s_waitcnt lgkmcnt(6)
    v_mfma_f32_16x16x32_bf16 v[96:99], v[48:51], a[88:91], v[96:99]
    ds_read_b64_tr_b16 v[40:41], v27 offset:32768
    v_mfma_f32_16x16x32_bf16 v[104:107], v[48:51], a[92:95], v[104:107]
    ds_read_b64_tr_b16 v[42:43], v27 offset:34816
    v_mfma_f32_16x16x32_bf16 v[100:103], v[52:55], a[88:91], v[100:103]
    ds_read_b64_tr_b16 v[44:45], v28 offset:32768
    v_mfma_f32_16x16x32_bf16 v[108:111], v[52:55], a[92:95], v[108:111]
    ds_read_b64_tr_b16 v[46:47], v28 offset:34816
    s_waitcnt vmcnt(6)
    s_waitcnt lgkmcnt(6)
    v_mfma_f32_16x16x32_bf16 v[64:67], v[12:15], a[96:99], v[64:67]
    ds_read_b64_tr_b16 v[48:49], v29 offset:32768
    v_mfma_f32_16x16x32_bf16 v[72:75], v[12:15], a[100:103], v[72:75]
    ds_read_b64_tr_b16 v[50:51], v29 offset:34816
    v_mfma_f32_16x16x32_bf16 v[68:71], v[32:35], a[96:99], v[68:71]
    ds_read_b64_tr_b16 v[52:53], v24 offset:36864
    v_mfma_f32_16x16x32_bf16 v[76:79], v[32:35], a[100:103], v[76:79]
    ds_read_b64_tr_b16 v[54:55], v24 offset:38912
    s_waitcnt lgkmcnt(6)
    v_mfma_f32_16x16x32_bf16 v[80:83], v[36:39], a[96:99], v[80:83]
    ds_read_b64_tr_b16 v[12:13], v25 offset:36864
    v_mfma_f32_16x16x32_bf16 v[88:91], v[36:39], a[100:103], v[88:91]
    ds_read_b64_tr_b16 v[14:15], v25 offset:38912
    v_mfma_f32_16x16x32_bf16 v[84:87], v[40:43], a[96:99], v[84:87]
    ds_read_b64_tr_b16 v[32:33], v26 offset:36864
    v_mfma_f32_16x16x32_bf16 v[92:95], v[40:43], a[100:103], v[92:95]
    ds_read_b64_tr_b16 v[34:35], v26 offset:38912
    s_waitcnt lgkmcnt(6)
    v_mfma_f32_16x16x32_bf16 v[96:99], v[44:47], a[96:99], v[96:99]
    ds_read_b64_tr_b16 v[36:37], v27 offset:36864
    v_mfma_f32_16x16x32_bf16 v[104:107], v[44:47], a[100:103], v[104:107]
    ds_read_b64_tr_b16 v[38:39], v27 offset:38912
    ds_read_b32 v3, v17 offset:64
    v_mfma_f32_16x16x32_bf16 v[100:103], v[48:51], a[96:99], v[100:103]
    ds_read_b64_tr_b16 v[40:41], v28 offset:36864
    v_mfma_f32_16x16x32_bf16 v[108:111], v[48:51], a[100:103], v[108:111]
    ds_read_b64_tr_b16 v[42:43], v28 offset:38912
    s_waitcnt vmcnt(4)
    s_waitcnt lgkmcnt(7)
    v_mfma_f32_16x16x32_bf16 v[64:67], v[52:55], a[104:107], v[64:67]
    ds_read_b64_tr_b16 v[44:45], v29 offset:36864
    v_mfma_f32_16x16x32_bf16 v[72:75], v[52:55], a[108:111], v[72:75]
    ds_read_b64_tr_b16 v[46:47], v29 offset:38912
    v_mfma_f32_16x16x32_bf16 v[68:71], v[12:15], a[104:107], v[68:71]
    s_waitcnt lgkmcnt(4)
    v_cmp_ne_u32 vcc, 0, v3
    s_cbranch_vccnz L_sp64
L_ok63:
    v_add_u32 v24, 65536, v24
    ds_read_b64_tr_b16 v[48:49], v24 offset:0
    v_mfma_f32_16x16x32_bf16 v[76:79], v[12:15], a[108:111], v[76:79]
    ds_read_b64_tr_b16 v[50:51], v24 offset:2048
    v_mfma_f32_16x16x32_bf16 v[80:83], v[32:35], a[104:107], v[80:83]
    v_add_u32 v25, 65536, v25
    ds_read_b64_tr_b16 v[52:53], v25 offset:0
    v_mfma_f32_16x16x32_bf16 v[88:91], v[32:35], a[108:111], v[88:91]
    ds_read_b64_tr_b16 v[54:55], v25 offset:2048
    v_mfma_f32_16x16x32_bf16 v[84:87], v[36:39], a[104:107], v[84:87]
    ds_read_b64_tr_b16 v[12:13], v24 offset:4096
    v_mfma_f32_16x16x32_bf16 v[92:95], v[36:39], a[108:111], v[92:95]
    ds_read_b64_tr_b16 v[14:15], v24 offset:6144
    s_waitcnt lgkmcnt(6)
    v_mfma_f32_16x16x32_bf16 v[96:99], v[40:43], a[104:107], v[96:99]
    ds_read_b64_tr_b16 v[32:33], v25 offset:4096
    v_mul_f32 v64, v21, v64
    v_mul_f32 v65, v21, v65
    v_mfma_f32_16x16x32_bf16 v[104:107], v[40:43], a[108:111], v[104:107]
    ds_read_b64_tr_b16 v[34:35], v25 offset:6144
    v_mul_f32 v66, v21, v66
    v_mfma_f32_16x16x32_bf16 v[100:103], v[44:47], a[104:107], v[100:103]
    v_add_u32 v24, 4294901760, v24
    ds_read_b64_tr_b16 v[36:37], v24 offset:49152
    v_mul_f32 v67, v21, v67
    v_mul_f32 v68, v21, v68
    v_mfma_f32_16x16x32_bf16 v[108:111], v[44:47], a[108:111], v[108:111]
    ds_read_b64_tr_b16 v[38:39], v24 offset:51200
    v_mul_f32 v69, v21, v69
    v_mul_f32 v70, v21, v70
    v_mul_f32 v71, v21, v71
    v_mul_f32 v72, v23, v72
    v_mul_f32 v73, v23, v73
    v_mul_f32 v74, v23, v74
    v_mul_f32 v75, v23, v75
    v_mul_f32 v76, v23, v76
    v_mul_f32 v77, v23, v77
    v_mul_f32 v78, v23, v78
    v_mul_f32 v79, v23, v79
    s_waitcnt lgkmcnt(6)
    v_mfma_f32_16x16x32_bf16 v[64:67], v[48:51], v[56:59], v[64:67]
    v_add_u32 v25, 4294901760, v25
    ds_read_b64_tr_b16 v[40:41], v25 offset:49152
    v_mul_f32 v80, v21, v80
    v_mul_f32 v81, v21, v81
    v_mfma_f32_16x16x32_bf16 v[72:75], v[48:51], v[60:63], v[72:75]
    ds_read_b64_tr_b16 v[42:43], v25 offset:51200
    v_mul_f32 v82, v21, v82
    v_mfma_f32_16x16x32_bf16 v[68:71], v[52:55], v[56:59], v[68:71]
    ds_read_b64_tr_b16 v[44:45], v24 offset:53248
    v_mul_f32 v83, v21, v83
    v_mul_f32 v84, v21, v84
    v_mfma_f32_16x16x32_bf16 v[76:79], v[52:55], v[60:63], v[76:79]
    ds_read_b64_tr_b16 v[46:47], v24 offset:55296
    v_mul_f32 v85, v21, v85
    s_waitcnt lgkmcnt(6)
    v_mfma_f32_16x16x32_bf16 v[64:67], v[12:15], v[4:7], v[64:67]
    ds_read_b64_tr_b16 v[48:49], v25 offset:53248
    v_mul_f32 v86, v21, v86
    v_mul_f32 v87, v21, v87
    v_mfma_f32_16x16x32_bf16 v[72:75], v[12:15], v[8:11], v[72:75]
    ds_read_b64_tr_b16 v[50:51], v25 offset:55296
    v_mul_f32 v88, v23, v88
    v_mfma_f32_16x16x32_bf16 v[68:71], v[32:35], v[4:7], v[68:71]
    v_add_u32 v26, 65536, v26
    ds_read_b64_tr_b16 v[52:53], v26 offset:0
    v_mul_f32 v89, v23, v89
    v_mul_f32 v90, v23, v90
    v_mfma_f32_16x16x32_bf16 v[76:79], v[32:35], v[8:11], v[76:79]
    ds_read_b64_tr_b16 v[54:55], v26 offset:2048
    v_mul_f32 v91, v23, v91
    s_waitcnt vmcnt(2)
    s_waitcnt lgkmcnt(6)
    v_mfma_f32_16x16x32_bf16 v[64:67], v[36:39], a[112:115], v[64:67]
    v_add_u32 v27, 65536, v27
    ds_read_b64_tr_b16 v[12:13], v27 offset:0
    v_mul_f32 v92, v23, v92
    v_mul_f32 v93, v23, v93
    v_mfma_f32_16x16x32_bf16 v[72:75], v[36:39], a[116:119], v[72:75]
    ds_read_b64_tr_b16 v[14:15], v27 offset:2048
    v_mul_f32 v94, v23, v94
    v_mfma_f32_16x16x32_bf16 v[68:71], v[40:43], a[112:115], v[68:71]
    ds_read_b64_tr_b16 v[32:33], v26 offset:4096
    v_mul_f32 v95, v23, v95
    v_mul_f32 v96, v21, v96
    v_mfma_f32_16x16x32_bf16 v[76:79], v[40:43], a[116:119], v[76:79]
    ds_read_b64_tr_b16 v[34:35], v26 offset:6144
    v_mul_f32 v97, v21, v97
    s_waitcnt vmcnt(0)
    s_waitcnt lgkmcnt(6)
    v_mfma_f32_16x16x32_bf16 v[64:67], v[44:47], a[120:123], v[64:67]
    ds_read_b64_tr_b16 v[36:37], v27 offset:4096
    v_mul_f32 v98, v21, v98
    v_mul_f32 v99, v21, v99
    v_mfma_f32_16x16x32_bf16 v[72:75], v[44:47], a[124:127], v[72:75]
    ds_read_b64_tr_b16 v[38:39], v27 offset:6144
    v_mul_f32 v100, v21, v100
    v_mfma_f32_16x16x32_bf16 v[68:71], v[48:51], a[120:123], v[68:71]
    v_add_u32 v26, 4294901760, v26
    ds_read_b64_tr_b16 v[40:41], v26 offset:49152
    v_mul_f32 v101, v21, v101
    v_mul_f32 v102, v21, v102
    v_mfma_f32_16x16x32_bf16 v[76:79], v[48:51], a[124:127], v[76:79]
    ds_read_b64_tr_b16 v[42:43], v26 offset:51200
    v_mul_f32 v103, v21, v103
    s_waitcnt lgkmcnt(6)
    v_mfma_f32_16x16x32_bf16 v[80:83], v[52:55], v[56:59], v[80:83]
    v_add_u32 v27, 4294901760, v27
    ds_read_b64_tr_b16 v[44:45], v27 offset:49152
    v_mul_f32 v104, v23, v104
    v_mul_f32 v105, v23, v105
    v_mfma_f32_16x16x32_bf16 v[88:91], v[52:55], v[60:63], v[88:91]
    ds_read_b64_tr_b16 v[46:47], v27 offset:51200
    v_mul_f32 v106, v23, v106
    v_mfma_f32_16x16x32_bf16 v[84:87], v[12:15], v[56:59], v[84:87]
    ds_read_b64_tr_b16 v[48:49], v26 offset:53248
    v_mul_f32 v107, v23, v107
    v_mul_f32 v108, v23, v108
    v_mfma_f32_16x16x32_bf16 v[92:95], v[12:15], v[60:63], v[92:95]
    ds_read_b64_tr_b16 v[50:51], v26 offset:55296
    v_mul_f32 v109, v23, v109
    s_waitcnt lgkmcnt(6)
    v_mfma_f32_16x16x32_bf16 v[80:83], v[32:35], v[4:7], v[80:83]
    ds_read_b64_tr_b16 v[52:53], v27 offset:53248
    v_mul_f32 v110, v23, v110
    v_mul_f32 v111, v23, v111
    v_mfma_f32_16x16x32_bf16 v[88:91], v[32:35], v[8:11], v[88:91]
    ds_read_b64_tr_b16 v[54:55], v27 offset:55296
    s_xor_b32 s94, s64, 3
    s_mul_i32 s94, s94, 24576
    s_add_u32 s94, s94, s92
    s_add_u32 s94, s94, 0
    v_mfma_f32_16x16x32_bf16 v[84:87], v[36:39], v[4:7], v[84:87]
    v_add_u32 v28, 65536, v28
    ds_read_b64_tr_b16 v[12:13], v28 offset:0
    v_cvt_pk_bf16_f32 v64, v64, v65
    v_cvt_pk_bf16_f32 v65, v66, v67
    v_mfma_f32_16x16x32_bf16 v[92:95], v[36:39], v[8:11], v[92:95]
    ds_read_b64_tr_b16 v[14:15], v28 offset:2048
    v_cvt_pk_bf16_f32 v66, v68, v69
    s_waitcnt lgkmcnt(6)
    v_mfma_f32_16x16x32_bf16 v[80:83], v[40:43], a[112:115], v[80:83]
    v_add_u32 v29, 65536, v29
    ds_read_b64_tr_b16 v[32:33], v29 offset:0
    v_cvt_pk_bf16_f32 v67, v70, v71
    v_cvt_pk_bf16_f32 v68, v72, v73
    v_mfma_f32_16x16x32_bf16 v[88:91], v[40:43], a[116:119], v[88:91]
    ds_read_b64_tr_b16 v[34:35], v29 offset:2048
    v_cvt_pk_bf16_f32 v69, v74, v75
    v_mfma_f32_16x16x32_bf16 v[84:87], v[44:47], a[112:115], v[84:87]
    ds_read_b64_tr_b16 v[36:37], v28 offset:4096
    v_cvt_pk_bf16_f32 v70, v76, v77
    v_cvt_pk_bf16_f32 v71, v78, v79
    v_mfma_f32_16x16x32_bf16 v[92:95], v[44:47], a[116:119], v[92:95]
    ds_read_b64_tr_b16 v[38:39], v28 offset:6144
    buffer_store_dwordx4 v[64:67], v16, s[32:35], s94 offen offset:0 sc1
    s_waitcnt lgkmcnt(6)
    v_mfma_f32_16x16x32_bf16 v[80:83], v[48:51], a[120:123], v[80:83]
    ds_read_b64_tr_b16 v[40:41], v29 offset:4096
    buffer_store_dwordx4 v[68:71], v16, s[32:35], s94 offen offset:1024 sc1
    v_mfma_f32_16x16x32_bf16 v[88:91], v[48:51], a[124:127], v[88:91]
    ds_read_b64_tr_b16 v[42:43], v29 offset:6144
    v_mfma_f32_16x16x32_bf16 v[84:87], v[52:55], a[120:123], v[84:87]
    v_add_u32 v28, 4294901760, v28
    ds_read_b64_tr_b16 v[44:45], v28 offset:49152
    v_mfma_f32_16x16x32_bf16 v[92:95], v[52:55], a[124:127], v[92:95]
    ds_read_b64_tr_b16 v[46:47], v28 offset:51200
    s_waitcnt lgkmcnt(6)
    v_mfma_f32_16x16x32_bf16 v[96:99], v[12:15], v[56:59], v[96:99]
    v_add_u32 v29, 4294901760, v29
    ds_read_b64_tr_b16 v[48:49], v29 offset:49152
    v_mfma_f32_16x16x32_bf16 v[104:107], v[12:15], v[60:63], v[104:107]
    ds_read_b64_tr_b16 v[50:51], v29 offset:51200
    v_mfma_f32_16x16x32_bf16 v[100:103], v[32:35], v[56:59], v[100:103]
    ds_read_b64_tr_b16 v[52:53], v28 offset:53248
    v_mfma_f32_16x16x32_bf16 v[108:111], v[32:35], v[60:63], v[108:111]
    ds_read_b64_tr_b16 v[54:55], v28 offset:55296
    s_waitcnt lgkmcnt(6)
    v_mfma_f32_16x16x32_bf16 v[96:99], v[36:39], v[4:7], v[96:99]
    ds_read_b64_tr_b16 v[12:13], v29 offset:53248
    s_xor_b32 s94, s64, 2
    s_mul_i32 s94, s94, 24576
    s_add_u32 s94, s94, s92
    s_add_u32 s94, s94, 8192
    v_cvt_pk_bf16_f32 v80, v80, v81
    v_mfma_f32_16x16x32_bf16 v[104:107], v[36:39], v[8:11], v[104:107]
    ds_read_b64_tr_b16 v[14:15], v29 offset:55296
    v_cvt_pk_bf16_f32 v81, v82, v83
    v_mfma_f32_16x16x32_bf16 v[100:103], v[40:43], v[4:7], v[100:103]
    ds_read_b64_tr_b16 v[32:33], v30 offset:16384
    v_cvt_pk_bf16_f32 v82, v84, v85
    v_cvt_pk_bf16_f32 v83, v86, v87
    v_mfma_f32_16x16x32_bf16 v[108:111], v[40:43], v[8:11], v[108:111]
    ds_read_b64_tr_b16 v[34:35], v30 offset:18432
    v_cvt_pk_bf16_f32 v84, v88, v89
    s_waitcnt lgkmcnt(6)
    v_mfma_f32_16x16x32_bf16 v[96:99], v[44:47], a[112:115], v[96:99]
    ds_read_b64_tr_b16 v[36:37], v31 offset:16384
    v_cvt_pk_bf16_f32 v85, v90, v91
    v_cvt_pk_bf16_f32 v86, v92, v93
    v_mfma_f32_16x16x32_bf16 v[104:107], v[44:47], a[116:119], v[104:107]
    ds_read_b64_tr_b16 v[38:39], v31 offset:18432
    v_cvt_pk_bf16_f32 v87, v94, v95
    v_mfma_f32_16x16x32_bf16 v[100:103], v[48:51], a[112:115], v[100:103]
    ds_read_b64_tr_b16 v[40:41], v30 offset:20480
    buffer_store_dwordx4 v[80:83], v16, s[32:35], s94 offen offset:0 sc1
    v_mfma_f32_16x16x32_bf16 v[108:111], v[48:51], a[116:119], v[108:111]
    ds_read_b64_tr_b16 v[42:43], v30 offset:22528
    buffer_store_dwordx4 v[84:87], v16, s[32:35], s94 offen offset:1024 sc1
    s_waitcnt lgkmcnt(6)
    v_mfma_f32_16x16x32_bf16 v[96:99], v[52:55], a[120:123], v[96:99]
    ds_read_b64_tr_b16 v[44:45], v31 offset:20480
    v_mfma_f32_16x16x32_bf16 v[104:107], v[52:55], a[124:127], v[104:107]
    ds_read_b64_tr_b16 v[46:47], v31 offset:22528
    v_mfma_f32_16x16x32_bf16 v[100:103], v[12:15], a[120:123], v[100:103]
    ds_read_b64_tr_b16 v[48:49], v30 offset:32768
    v_mfma_f32_16x16x32_bf16 v[108:111], v[12:15], a[124:127], v[108:111]
    ds_read_b64_tr_b16 v[50:51], v30 offset:34816
    s_waitcnt lgkmcnt(6)
    v_mfma_f32_16x16x32_bf16 v[112:115], v[32:35], a[16:19], v[112:115]
    ds_read_b64_tr_b16 v[52:53], v31 offset:32768
    v_mfma_f32_16x16x32_bf16 v[120:123], v[32:35], a[20:23], v[120:123]
    ds_read_b64_tr_b16 v[54:55], v31 offset:34816
    v_mfma_f32_16x16x32_bf16 v[116:119], v[36:39], a[16:19], v[116:119]
    ds_read_b64_tr_b16 v[12:13], v30 offset:36864
    v_mfma_f32_16x16x32_bf16 v[124:127], v[36:39], a[20:23], v[124:127]
    ds_read_b64_tr_b16 v[14:15], v30 offset:38912
    s_waitcnt lgkmcnt(6)
    v_mfma_f32_16x16x32_bf16 v[112:115], v[40:43], a[24:27], v[112:115]
    ds_read_b64_tr_b16 v[32:33], v31 offset:36864
    s_xor_b32 s94, s64, 1
    s_mul_i32 s94, s94, 24576
    s_add_u32 s94, s94, s92
    s_add_u32 s94, s94, 16384
    v_cvt_pk_bf16_f32 v96, v96, v97
    v_mfma_f32_16x16x32_bf16 v[120:123], v[40:43], a[28:31], v[120:123]
    ds_read_b64_tr_b16 v[34:35], v31 offset:38912
    v_cvt_pk_bf16_f32 v97, v98, v99
    v_mfma_f32_16x16x32_bf16 v[116:119], v[44:47], a[24:27], v[116:119]
    ds_read_b64_tr_b16 v[36:37], v30 offset:49152
    v_cvt_pk_bf16_f32 v98, v100, v101
    v_cvt_pk_bf16_f32 v99, v102, v103
    v_mfma_f32_16x16x32_bf16 v[124:127], v[44:47], a[28:31], v[124:127]
    ds_read_b64_tr_b16 v[38:39], v30 offset:51200
    v_cvt_pk_bf16_f32 v100, v104, v105
    s_waitcnt lgkmcnt(6)
    v_mfma_f32_16x16x32_bf16 v[112:115], v[48:51], a[32:35], v[112:115]
    ds_read_b64_tr_b16 v[40:41], v31 offset:49152
    v_cvt_pk_bf16_f32 v101, v106, v107
    v_cvt_pk_bf16_f32 v102, v108, v109
    v_mfma_f32_16x16x32_bf16 v[120:123], v[48:51], a[36:39], v[120:123]
    ds_read_b64_tr_b16 v[42:43], v31 offset:51200
    v_cvt_pk_bf16_f32 v103, v110, v111
    v_mfma_f32_16x16x32_bf16 v[116:119], v[52:55], a[32:35], v[116:119]
    ds_read_b64_tr_b16 v[44:45], v30 offset:53248
    buffer_store_dwordx4 v[96:99], v16, s[32:35], s94 offen offset:0 sc1
    v_mfma_f32_16x16x32_bf16 v[124:127], v[52:55], a[36:39], v[124:127]
    ds_read_b64_tr_b16 v[46:47], v30 offset:55296
    buffer_store_dwordx4 v[100:103], v16, s[32:35], s94 offen offset:1024 sc1
    s_waitcnt lgkmcnt(6)
    v_mfma_f32_16x16x32_bf16 v[112:115], v[12:15], a[40:43], v[112:115]
    ds_read_b64_tr_b16 v[48:49], v31 offset:53248
    v_mfma_f32_16x16x32_bf16 v[120:123], v[12:15], a[44:47], v[120:123]
    ds_read_b64_tr_b16 v[50:51], v31 offset:55296
    s_load_dword s74, s[52:53], s75 glc
    v_mfma_f32_16x16x32_bf16 v[116:119], v[32:35], a[40:43], v[116:119]
    v_add_u32 v30, 65536, v30
    ds_read_b64_tr_b16 v[52:53], v30 offset:0
    v_mfma_f32_16x16x32_bf16 v[124:127], v[32:35], a[44:47], v[124:127]
    ds_read_b64_tr_b16 v[54:55], v30 offset:2048
    s_waitcnt lgkmcnt(6)
    v_mfma_f32_16x16x32_bf16 v[112:115], v[36:39], a[48:51], v[112:115]
    v_add_u32 v31, 65536, v31
    ds_read_b64_tr_b16 v[12:13], v31 offset:0
    v_mfma_f32_16x16x32_bf16 v[120:123], v[36:39], a[52:55], v[120:123]
    ds_read_b64_tr_b16 v[14:15], v31 offset:2048
    s_waitcnt vmcnt(4)
    s_xor_b32 s3, s75, 6144
    s_mov_b32 s80, 1024
    s_atomic_or s80, s[52:53], s3
    v_mfma_f32_16x16x32_bf16 v[116:119], v[40:43], a[48:51], v[116:119]
    ds_read_b64_tr_b16 v[32:33], v30 offset:4096
    v_mfma_f32_16x16x32_bf16 v[124:127], v[40:43], a[52:55], v[124:127]
    ds_read_b64_tr_b16 v[34:35], v30 offset:6144
    s_waitcnt lgkmcnt(6)
    v_mfma_f32_16x16x32_bf16 v[112:115], v[44:47], a[56:59], v[112:115]
    ds_read_b64_tr_b16 v[36:37], v31 offset:4096
    v_mfma_f32_16x16x32_bf16 v[120:123], v[44:47], a[60:63], v[120:123]
    ds_read_b64_tr_b16 v[38:39], v31 offset:6144
    v_mfma_f32_16x16x32_bf16 v[116:119], v[48:51], a[56:59], v[116:119]
    ds_read_b64_tr_b16 v[40:41], v30 offset:16384
    v_mfma_f32_16x16x32_bf16 v[124:127], v[48:51], a[60:63], v[124:127]
    ds_read_b64_tr_b16 v[42:43], v30 offset:18432
    s_waitcnt lgkmcnt(6)
    v_mfma_f32_16x16x32_bf16 v[112:115], v[52:55], a[64:67], v[112:115]
    ds_read_b64_tr_b16 v[44:45], v31 offset:16384
    v_mfma_f32_16x16x32_bf16 v[120:123], v[52:55], a[68:71], v[120:123]
    ds_read_b64_tr_b16 v[46:47], v31 offset:18432
    v_mfma_f32_16x16x32_bf16 v[116:119], v[12:15], a[64:67], v[116:119]
    ds_read_b64_tr_b16 v[48:49], v30 offset:20480
    v_mfma_f32_16x16x32_bf16 v[124:127], v[12:15], a[68:71], v[124:127]
    ds_read_b64_tr_b16 v[50:51], v30 offset:22528
    s_waitcnt lgkmcnt(6)
    v_mfma_f32_16x16x32_bf16 v[112:115], v[32:35], a[72:75], v[112:115]
    ds_read_b64_tr_b16 v[52:53], v31 offset:20480
    v_mfma_f32_16x16x32_bf16 v[120:123], v[32:35], a[76:79], v[120:123]
    ds_read_b64_tr_b16 v[54:55], v31 offset:22528
    v_mfma_f32_16x16x32_bf16 v[116:119], v[36:39], a[72:75], v[116:119]
    ds_read_b64_tr_b16 v[12:13], v30 offset:32768
    v_mfma_f32_16x16x32_bf16 v[124:127], v[36:39], a[76:79], v[124:127]
    ds_read_b64_tr_b16 v[14:15], v30 offset:34816
    s_waitcnt lgkmcnt(6)
    v_mfma_f32_16x16x32_bf16 v[112:115], v[40:43], a[80:83], v[112:115]
    ds_read_b64_tr_b16 v[32:33], v31 offset:32768
    v_mfma_f32_16x16x32_bf16 v[120:123], v[40:43], a[84:87], v[120:123]
    ds_read_b64_tr_b16 v[34:35], v31 offset:34816
    v_mfma_f32_16x16x32_bf16 v[116:119], v[44:47], a[80:83], v[116:119]
    ds_read_b64_tr_b16 v[36:37], v30 offset:36864
    v_mfma_f32_16x16x32_bf16 v[124:127], v[44:47], a[84:87], v[124:127]
    ds_read_b64_tr_b16 v[38:39], v30 offset:38912
    s_waitcnt lgkmcnt(6)
    v_mfma_f32_16x16x32_bf16 v[112:115], v[48:51], a[88:91], v[112:115]
    ds_read_b64_tr_b16 v[40:41], v31 offset:36864
    v_mfma_f32_16x16x32_bf16 v[120:123], v[48:51], a[92:95], v[120:123]
    ds_read_b64_tr_b16 v[42:43], v31 offset:38912
    v_mfma_f32_16x16x32_bf16 v[116:119], v[52:55], a[88:91], v[116:119]
    v_add_u32 v30, 65536, v30
    ds_read_b64_tr_b16 v[44:45], v30 offset:0
    v_mfma_f32_16x16x32_bf16 v[124:127], v[52:55], a[92:95], v[124:127]
    ds_read_b64_tr_b16 v[46:47], v30 offset:2048
    s_waitcnt lgkmcnt(6)
    v_mfma_f32_16x16x32_bf16 v[112:115], v[12:15], a[96:99], v[112:115]
    v_add_u32 v31, 65536, v31
    ds_read_b64_tr_b16 v[48:49], v31 offset:0
    v_mfma_f32_16x16x32_bf16 v[120:123], v[12:15], a[100:103], v[120:123]
    ds_read_b64_tr_b16 v[50:51], v31 offset:2048
    v_mfma_f32_16x16x32_bf16 v[116:119], v[32:35], a[96:99], v[116:119]
    ds_read_b64_tr_b16 v[52:53], v30 offset:4096
    v_mfma_f32_16x16x32_bf16 v[124:127], v[32:35], a[100:103], v[124:127]
    ds_read_b64_tr_b16 v[54:55], v30 offset:6144
    s_waitcnt lgkmcnt(6)
    v_mfma_f32_16x16x32_bf16 v[112:115], v[36:39], a[104:107], v[112:115]
    ds_read_b64_tr_b16 v[12:13], v31 offset:4096
    v_mfma_f32_16x16x32_bf16 v[120:123], v[36:39], a[108:111], v[120:123]
    ds_read_b64_tr_b16 v[14:15], v31 offset:6144
    v_mfma_f32_16x16x32_bf16 v[116:119], v[40:43], a[104:107], v[116:119]
    v_add_u32 v30, 4294901760, v30
    ds_read_b64_tr_b16 v[32:33], v30 offset:49152
    v_mfma_f32_16x16x32_bf16 v[124:127], v[40:43], a[108:111], v[124:127]
    ds_read_b64_tr_b16 v[34:35], v30 offset:51200
    s_waitcnt lgkmcnt(6)
    v_mfma_f32_16x16x32_bf16 v[64:67], v[44:47], v[56:59], 0
    v_add_u32 v31, 4294901760, v31
    ds_read_b64_tr_b16 v[36:37], v31 offset:49152
    v_mfma_f32_16x16x32_bf16 v[72:75], v[44:47], v[60:63], 0
    ds_read_b64_tr_b16 v[38:39], v31 offset:51200
    v_mfma_f32_16x16x32_bf16 v[68:71], v[48:51], v[56:59], 0
    ds_read_b64_tr_b16 v[40:41], v30 offset:53248
    v_mfma_f32_16x16x32_bf16 v[76:79], v[48:51], v[60:63], 0
    ds_read_b64_tr_b16 v[42:43], v30 offset:55296
    s_waitcnt lgkmcnt(6)
    v_mfma_f32_16x16x32_bf16 v[64:67], v[52:55], v[4:7], v[64:67]
    ds_read_b64_tr_b16 v[44:45], v31 offset:53248
    v_mul_f32 v112, v21, v112
    v_mul_f32 v113, v21, v113
    v_mfma_f32_16x16x32_bf16 v[72:75], v[52:55], v[8:11], v[72:75]
    ds_read_b64_tr_b16 v[46:47], v31 offset:55296
    v_mul_f32 v114, v21, v114
    v_mfma_f32_16x16x32_bf16 v[68:71], v[12:15], v[4:7], v[68:71]
    v_mul_f32 v115, v21, v115
    v_mul_f32 v116, v21, v116
    v_mfma_f32_16x16x32_bf16 v[76:79], v[12:15], v[8:11], v[76:79]
    v_mul_f32 v117, v21, v117
    s_waitcnt lgkmcnt(0)
    s_waitcnt vmcnt(2)
    s_xor_b32 s3, s75, 4096
    s_mov_b32 s81, 2048
    s_atomic_or s81, s[52:53], s3
    s_waitcnt vmcnt(0)
    s_xor_b32 s3, s75, 2048
    s_mov_b32 s82, 4096
    s_atomic_or s82, s[52:53], s3
    s_load_dword s74, s[52:53], s75 glc
    v_mfma_f32_16x16x32_bf16 v[64:67], v[32:35], a[112:115], v[64:67]
    v_mul_f32 v118, v21, v118
    v_mul_f32 v119, v21, v119
    v_mfma_f32_16x16x32_bf16 v[72:75], v[32:35], a[116:119], v[72:75]
    v_mul_f32 v120, v23, v120
    v_mfma_f32_16x16x32_bf16 v[68:71], v[36:39], a[112:115], v[68:71]
    v_mul_f32 v121, v23, v121
    v_mul_f32 v122, v23, v122
    v_mfma_f32_16x16x32_bf16 v[76:79], v[36:39], a[116:119], v[76:79]
    v_mul_f32 v123, v23, v123
    v_mfma_f32_16x16x32_bf16 v[64:67], v[40:43], a[120:123], v[64:67]
    v_mul_f32 v124, v23, v124
    v_mul_f32 v125, v23, v125
    v_mfma_f32_16x16x32_bf16 v[72:75], v[40:43], a[124:127], v[72:75]
    v_mul_f32 v126, v23, v126
    v_mfma_f32_16x16x32_bf16 v[68:71], v[44:47], a[120:123], v[68:71]
    v_mul_f32 v127, v23, v127
    v_mfma_f32_16x16x32_bf16 v[76:79], v[44:47], a[124:127], v[76:79]
    s_mul_i32 s94, s64, 24576
    s_add_u32 s94, s94, s92
    v_and_b32 v4, 15, v0
    v_bfe_u32 v6, v0, 4, 1
    v_lshlrev_b32 v6, 5, v6
    v_lshrrev_b32 v7, 5, v0
    v_lshl_add_u32 v6, v7, 4, v6
    v_lshl_add_u32 v5, v4, 11, v6
    v_xor_b32 v4, 0x4000, v5
    s_lshl_b32 s88, s61, 17
    s_lshl_b32 s67, s60, 15
    s_add_u32 s88, s88, s67
    s_lshl_b32 s67, s62, 8
    s_add_u32 s88, s88, s67
    s_lshl_b32 s67, s64, 6
    s_add_u32 s88, s88, s67
    v_pk_add_f32 v[112:113], v[112:113], v[64:65]
    v_pk_add_f32 v[114:115], v[114:115], v[66:67]
    v_pk_add_f32 v[116:117], v[116:117], v[68:69]
    v_pk_add_f32 v[118:119], v[118:119], v[70:71]
    v_pk_add_f32 v[120:121], v[120:121], v[72:73]
    v_pk_add_f32 v[122:123], v[122:123], v[74:75]
    v_pk_add_f32 v[124:125], v[124:125], v[76:77]
    v_pk_add_f32 v[126:127], v[126:127], v[78:79]
    s_andn2_b32 s70, 1024, s74
    s_cbranch_scc1 L_pl66
L_pk65:
    buffer_load_dwordx4 v[24:27], v16, s[32:35], s94 offen offset:0 sc1
    buffer_load_dwordx4 v[28:31], v16, s[32:35], s94 offen offset:1024 sc1
    s_add_u32 s94, s94, 8192
    s_andn2_b32 s70, 2048, s74
    s_cbranch_scc1 L_pl68
L_pk67:
    buffer_load_dwordx4 v[32:35], v16, s[32:35], s94 offen offset:0 sc1
    buffer_load_dwordx4 v[36:39], v16, s[32:35], s94 offen offset:1024 sc1
    s_add_u32 s94, s94, 8192
    s_andn2_b32 s70, 4096, s74
    s_cbranch_scc1 L_pl70
L_pk69:
    buffer_load_dwordx4 v[40:43], v16, s[32:35], s94 offen offset:0 sc1
    buffer_load_dwordx4 v[44:47], v16, s[32:35], s94 offen offset:1024 sc1
    s_waitcnt vmcnt(4)
    v_lshlrev_b32 v80, 16, v24
    v_and_b32 v81, 0xffff0000, v24
    v_lshlrev_b32 v82, 16, v25
    v_and_b32 v83, 0xffff0000, v25
    v_lshlrev_b32 v84, 16, v26
    v_and_b32 v85, 0xffff0000, v26
    v_lshlrev_b32 v86, 16, v27
    v_and_b32 v87, 0xffff0000, v27
    v_lshlrev_b32 v88, 16, v28
    v_and_b32 v89, 0xffff0000, v28
    v_lshlrev_b32 v90, 16, v29
    v_and_b32 v91, 0xffff0000, v29
    v_lshlrev_b32 v92, 16, v30
    v_and_b32 v93, 0xffff0000, v30
    v_lshlrev_b32 v94, 16, v31
    v_and_b32 v95, 0xffff0000, v31
    v_pk_add_f32 v[112:113], v[112:113], v[80:81]
    v_pk_add_f32 v[114:115], v[114:115], v[82:83]
    v_pk_add_f32 v[116:117], v[116:117], v[84:85]
    v_pk_add_f32 v[118:119], v[118:119], v[86:87]
    v_pk_add_f32 v[120:121], v[120:121], v[88:89]
    v_pk_add_f32 v[122:123], v[122:123], v[90:91]
    v_pk_add_f32 v[124:125], v[124:125], v[92:93]
    v_pk_add_f32 v[126:127], v[126:127], v[94:95]
    s_waitcnt vmcnt(2)
    v_lshlrev_b32 v80, 16, v32
    v_and_b32 v81, 0xffff0000, v32
    v_lshlrev_b32 v82, 16, v33
    v_and_b32 v83, 0xffff0000, v33
    v_lshlrev_b32 v84, 16, v34
    v_and_b32 v85, 0xffff0000, v34
    v_lshlrev_b32 v86, 16, v35
    v_and_b32 v87, 0xffff0000, v35
    v_lshlrev_b32 v88, 16, v36
    v_and_b32 v89, 0xffff0000, v36
    v_lshlrev_b32 v90, 16, v37
    v_and_b32 v91, 0xffff0000, v37
    v_lshlrev_b32 v92, 16, v38
    v_and_b32 v93, 0xffff0000, v38
    v_lshlrev_b32 v94, 16, v39
    v_and_b32 v95, 0xffff0000, v39
    v_pk_add_f32 v[112:113], v[112:113], v[80:81]
    v_pk_add_f32 v[114:115], v[114:115], v[82:83]
    v_pk_add_f32 v[116:117], v[116:117], v[84:85]
    v_pk_add_f32 v[118:119], v[118:119], v[86:87]
    v_pk_add_f32 v[120:121], v[120:121], v[88:89]
    v_pk_add_f32 v[122:123], v[122:123], v[90:91]
    v_pk_add_f32 v[124:125], v[124:125], v[92:93]
    v_pk_add_f32 v[126:127], v[126:127], v[94:95]
    s_waitcnt vmcnt(0)
    v_lshlrev_b32 v80, 16, v40
    v_and_b32 v81, 0xffff0000, v40
    v_lshlrev_b32 v82, 16, v41
    v_and_b32 v83, 0xffff0000, v41
    v_lshlrev_b32 v84, 16, v42
    v_and_b32 v85, 0xffff0000, v42
    v_lshlrev_b32 v86, 16, v43
    v_and_b32 v87, 0xffff0000, v43
    v_lshlrev_b32 v88, 16, v44
    v_and_b32 v89, 0xffff0000, v44
    v_lshlrev_b32 v90, 16, v45
    v_and_b32 v91, 0xffff0000, v45
    v_lshlrev_b32 v92, 16, v46
    v_and_b32 v93, 0xffff0000, v46
    v_lshlrev_b32 v94, 16, v47
    v_and_b32 v95, 0xffff0000, v47
    v_pk_add_f32 v[112:113], v[112:113], v[80:81]
    v_pk_add_f32 v[114:115], v[114:115], v[82:83]
    v_pk_add_f32 v[116:117], v[116:117], v[84:85]
    v_pk_add_f32 v[118:119], v[118:119], v[86:87]
    v_pk_add_f32 v[120:121], v[120:121], v[88:89]
    v_pk_add_f32 v[122:123], v[122:123], v[90:91]
    v_pk_add_f32 v[124:125], v[124:125], v[92:93]
    v_pk_add_f32 v[126:127], v[126:127], v[94:95]
    v_pk_mul_f32 v[112:113], v[112:113], v[20:21] op_sel_hi:[1,0]
    v_pk_mul_f32 v[114:115], v[114:115], v[20:21] op_sel_hi:[1,0]
    v_pk_mul_f32 v[116:117], v[116:117], v[20:21] op_sel_hi:[1,0]
    v_pk_mul_f32 v[118:119], v[118:119], v[20:21] op_sel_hi:[1,0]
    v_pk_mul_f32 v[120:121], v[120:121], v[22:23] op_sel_hi:[1,0]
    v_pk_mul_f32 v[122:123], v[122:123], v[22:23] op_sel_hi:[1,0]
    v_pk_mul_f32 v[124:125], v[124:125], v[22:23] op_sel_hi:[1,0]
    v_pk_mul_f32 v[126:127], v[126:127], v[22:23] op_sel_hi:[1,0]
    v_cvt_pk_bf16_f32 v112, v112, v113
    v_cvt_pk_bf16_f32 v113, v114, v115
    v_cvt_pk_bf16_f32 v114, v116, v117
    v_cvt_pk_bf16_f32 v115, v118, v119
    v_cvt_pk_bf16_f32 v116, v120, v121
    v_cvt_pk_bf16_f32 v117, v122, v123
    v_cvt_pk_bf16_f32 v118, v124, v125
    v_cvt_pk_bf16_f32 v119, v126, v127
    v_permlane16_swap_b32 v112, v114
    v_permlane16_swap_b32 v113, v115
    buffer_store_dwordx4 v[112:115], v4, s[36:39], s88 offen offset:0
    v_permlane16_swap_b32 v116, v118
    v_permlane16_swap_b32 v117, v119
    buffer_store_dwordx4 v[116:119], v5, s[36:39], s88 offen offset:1024
    s_endpgm
L_pp38:
    s_sleep 8
    s_load_dword s74, s[54:55], 0 glc
    s_waitcnt lgkmcnt(0)
    s_cmp_ge_u32 s74, 16
    s_cbranch_scc1 L_po39
    s_sub_u32 s69, s69, 1
    s_cbranch_scc0 L_pp38
    s_mov_b32 s69, 0
    s_branch L_po39
L_pl41:
    s_waitcnt lgkmcnt(0)
    s_andn2_b32 s70, 17, s74
    s_cbranch_scc0 L_pk40
    s_load_dword s74, s[52:53], s75 glc
    s_sub_u32 s69, s69, 1
    s_cbranch_scc0 L_pl41
    s_mov_b32 s69, 0
    s_branch L_pk40
L_pl43:
    s_waitcnt lgkmcnt(0)
    s_andn2_b32 s70, 34, s74
    s_cbranch_scc0 L_pk42
    s_load_dword s74, s[52:53], s75 glc
    s_sub_u32 s69, s69, 1
    s_cbranch_scc0 L_pl43
    s_mov_b32 s69, 0
    s_branch L_pk42
L_sp50:
    ds_read_b32 v3, v17 offset:0
    s_waitcnt lgkmcnt(0)
    v_cmp_ne_u32 vcc, 0, v3
    s_cbranch_vccz L_ok49
    s_sleep 1
    s_sub_u32 s69, s69, 1
    s_cbranch_scc0 L_sp50
    s_mov_b32 s69, 0
    s_branch L_ok49
L_pl52:
    s_waitcnt lgkmcnt(0)
    s_andn2_b32 s70, 68, s74
    s_cbranch_scc0 L_pk51
    s_load_dword s74, s[52:53], s75 glc
    s_sub_u32 s69, s69, 1
    s_cbranch_scc0 L_pl52
    s_mov_b32 s69, 0
    s_branch L_pk51
L_sp54:
    ds_read_b32 v3, v17 offset:16
    s_waitcnt lgkmcnt(0)
    v_cmp_ne_u32 vcc, 0, v3
    s_cbranch_vccz L_ok53
    s_sleep 1
    s_sub_u32 s69, s69, 1
    s_cbranch_scc0 L_sp54
    s_mov_b32 s69, 0
    s_branch L_ok53
L_sp56:
    ds_read_b32 v3, v17 offset:32
    s_waitcnt lgkmcnt(0)
    v_cmp_ne_u32 vcc, 0, v3
    s_cbranch_vccz L_ok55
    s_sleep 1
    s_sub_u32 s69, s69, 1
    s_cbranch_scc0 L_sp56
    s_mov_b32 s69, 0
    s_branch L_ok55
L_pl58:
    s_waitcnt lgkmcnt(0)
    s_andn2_b32 s70, 136, s74
    s_cbranch_scc0 L_pk57
    s_load_dword s74, s[52:53], s75 glc
    s_sub_u32 s69, s69, 1
    s_cbranch_scc0 L_pl58
    s_mov_b32 s69, 0
    s_branch L_pk57
L_sp60:
    ds_read_b32 v3, v17 offset:48
    s_waitcnt lgkmcnt(0)
    v_cmp_ne_u32 vcc, 0, v3
    s_cbranch_vccz L_ok59
    s_sleep 1
    s_sub_u32 s69, s69, 1
    s_cbranch_scc0 L_sp60
    s_mov_b32 s69, 0
    s_branch L_ok59
L_pl62:
    s_waitcnt lgkmcnt(0)
    s_andn2_b32 s70, s77, s74
    s_cbranch_scc0 L_pk61
    s_load_dword s74, s[52:53], s75 glc
    s_sub_u32 s69, s69, 1
    s_cbranch_scc0 L_pl62
    s_mov_b32 s69, 0
    s_branch L_pk61
L_sp64:
    ds_read_b32 v3, v17 offset:64
    s_waitcnt lgkmcnt(0)
    v_cmp_ne_u32 vcc, 0, v3
    s_cbranch_vccz L_ok63
    s_sleep 1
    s_sub_u32 s69, s69, 1
    s_cbranch_scc0 L_sp64
    s_mov_b32 s69, 0
    s_branch L_ok63
L_pl66:
    s_waitcnt lgkmcnt(0)
    s_andn2_b32 s70, 1024, s74
    s_cbranch_scc0 L_pk65
    s_load_dword s74, s[52:53], s75 glc
    s_sub_u32 s69, s69, 1
    s_cbranch_scc0 L_pl66
    s_mov_b32 s69, 0
    s_branch L_pk65
L_pl68:
    s_waitcnt lgkmcnt(0)
    s_andn2_b32 s70, 2048, s74
    s_cbranch_scc0 L_pk67
    s_load_dword s74, s[52:53], s75 glc
    s_sub_u32 s69, s69, 1
    s_cbranch_scc0 L_pl68
    s_mov_b32 s69, 0
    s_branch L_pk67
L_pl70:
    s_waitcnt lgkmcnt(0)
    s_andn2_b32 s70, 4096, s74
    s_cbranch_scc0 L_pk69
    s_load_dword s74, s[52:53], s75 glc
    s_sub_u32 s69, s69, 1
    s_cbranch_scc0 L_pl70
    s_mov_b32 s69, 0
    s_branch L_pk69
L_C:
    s_setprio 2
    s_lshl_b32 s79, s60, 2
    s_mov_b32 s69, 400000
    s_and_b32 s66, s62, 1
    s_lshl_b32 s3, s62, 8
    s_lshr_b32 s67, s60, 1
    s_lshl_b32 s67, s67, 7
    s_add_u32 s3, s3, s67
    s_and_b32 s67, s60, 1
    s_lshl_b32 s67, s67, 15
    s_add_u32 s3, s3, s67
    s_mul_i32 s90, s64, 458752
    s_add_u32 s90, s90, s3
    s_lshl_b32 s91, s64, 17
    s_add_u32 s91, s91, s3
    s_lshl_b32 s93, s66, 16
    s_lshl_b32 s3, s61, 2
    s_add_u32 s3, s3, s64
    s_mul_i32 s89, s3, 147456
    s_lshl_b32 s67, s60, 11
    s_add_u32 s89, s89, s67
    s_lshl_b32 s75, s3, 2
    s_add_u32 s75, s75, s62
    s_lshl_b32 s75, s75, 2
    s_add_u32 s75, s75, s60
    s_lshl_b32 s75, s75, 7
    v_lshlrev_b32 v16, 4, v0
    v_and_b32 v17, 3, v0
    v_lshlrev_b32 v17, 2, v17
    v_add_u32 v17, 151552, v17
    v_lshrrev_b32 v32, 4, v0
    v_and_b32 v33, 15, v0
    v_bfe_u32 v34, v0, 2, 2
    v_and_b32 v35, 3, v0
    s_waitcnt lgkmcnt(0)
    s_add_u32 s52, s22, 33554432
    s_addc_u32 s53, s23, 0
    s_lshl_b32 s3, s61, 4
    s_add_u32 s54, s20, s3
    s_addc_u32 s55, s21, 0
    s_mov_b32 s32, s22
    s_and_b32 s33, s23, 0xffff
    s_mov_b32 s34, 37748736
    s_mov_b32 s35, 0x20000
    s_mov_b32 s40, s14
    s_and_b32 s41, s15, 0xffff
    s_mov_b32 s42, 1835008
    s_mov_b32 s43, 0x20000
    s_mov_b32 s44, s8
    s_and_b32 s45, s9, 0xffff
    s_mov_b32 s46, 524288
    s_mov_b32 s47, 0x20000
    s_mov_b32 s36, s18
    s_and_b32 s37, s19, 0xffff
    s_mov_b32 s38, 2097152
    s_mov_b32 s39, 0x20000
    s_cmp_eq_u32 s60, 0
    s_cbranch_scc0 L_c_noinit
    s_mov_b32 s80, 0
    s_add_u32 s3, s75, 0
    s_atomic_swap s80, s[52:53], s3 glc
    s_mov_b32 s81, 0
    s_add_u32 s3, s75, 128
    s_atomic_swap s81, s[52:53], s3 glc
    s_mov_b32 s82, 0
    s_add_u32 s3, s75, 256
    s_atomic_swap s82, s[52:53], s3 glc
    s_mov_b32 s83, 0
    s_add_u32 s3, s75, 384
    s_atomic_swap s83, s[52:53], s3 glc
L_c_noinit:
    s_cmp_ge_u32 s62, 2
    s_cbranch_scc1 L_c_att
    v_lshlrev_b32 v2, 2, v0
    v_add_u32 v2, 151552, v2
    v_mov_b32 v1, 1
    ds_write_b32 v2, v1
    s_waitcnt lgkmcnt(0)
    v_xor_b32 v38, 8, v33
    v_and_b32 v39, 8, v38
    v_add_u32 v39, v39, v38
    v_lshlrev_b32 v39, 7, v39
    v_lshrrev_b32 v38, 1, v38
    v_xor_b32 v38, v38, v32
    v_lshl_add_u32 v39, v38, 4, v39
    v_add_u32 v39, s65, v39
    v_add_u32 v12, 0, v39
    v_xor_b32 v13, 64, v12
    v_xor_b32 v38, 0, v33
    v_and_b32 v39, 8, v38
    v_add_u32 v39, v39, v38
    v_lshlrev_b32 v39, 7, v39
    v_lshrrev_b32 v38, 1, v38
    v_xor_b32 v38, v38, v32
    v_lshl_add_u32 v39, v38, 4, v39
    v_add_u32 v39, s65, v39
    v_add_u32 v15, 1024, v39
    v_xor_b32 v14, 64, v15
    v_lshl_add_u32 v38, v32, 3, v34
    v_lshlrev_b32 v38, 7, v38
    v_lshl_add_u32 v38, v35, 3, v38
    v_lshrrev_b32 v39, 1, v34
    v_and_b32 v40, 1, v32
    v_lshl_or_b32 v39, v40, 1, v39
    v_xor_b32 v41, 0, v39
    v_xor_b32 v40, 0, v41
    v_lshl_add_u32 v4, v40, 5, v38
    v_add_u32 v8, 0x10000, v4
    v_xor_b32 v40, 1, v41
    v_lshl_add_u32 v5, v40, 5, v38
    v_add_u32 v9, 0x10000, v5
    v_xor_b32 v40, 2, v41
    v_lshl_add_u32 v6, v40, 5, v38
    v_add_u32 v10, 0x10000, v6
    v_xor_b32 v40, 3, v41
    v_lshl_add_u32 v7, v40, 5, v38
    v_add_u32 v11, 0x10000, v7
    s_cmp_eq_u32 s60, 0
    s_cbranch_scc0 L_ci71
    s_mov_b32 s67, 1
    s_waitcnt lgkmcnt(0)
    s_atomic_add s67, s[54:55], 0
L_ci71:
    v_lshlrev_b32 v18, 4, v32
    v_add_u32 v18, 152576, v18
    s_lshr_b32 s3, s65, 1
    v_add_u32 v21, s3, v16
    v_add_u32 v22, 131072, v21
    s_waitcnt vmcnt(0)
    s_barrier
    ds_read_b64_tr_b16 v[32:33], v8 offset:32768
    ds_read_b64_tr_b16 v[34:35], v8 offset:33280
    v_add_u32 v1, 65536, v12
    ds_read_b128 a[0:3], v1 offset:0
    v_add_u32 v2, 65536, v14
    ds_read_b128 a[64:67], v2 offset:0
    ds_read_b64_tr_b16 v[36:37], v9 offset:32768
    ds_read_b64_tr_b16 v[38:39], v9 offset:33280
    ds_read_b64_tr_b16 v[40:41], v8 offset:36864
    ds_read_b64_tr_b16 v[42:43], v8 offset:37376
    v_add_u32 v1, 65536, v13
    ds_read_b128 a[4:7], v1 offset:0
    v_add_u32 v2, 65536, v15
    ds_read_b128 a[68:71], v2 offset:0
    ds_read_b64_tr_b16 v[44:45], v9 offset:36864
    ds_read_b64_tr_b16 v[46:47], v9 offset:37376
    s_waitcnt lgkmcnt(6)
    v_mfma_f32_16x16x32_bf16 v[64:67], v[32:35], a[0:3], 0
    ds_read_b64_tr_b16 v[48:49], v8 offset:40960
    v_mfma_f32_16x16x32_bf16 v[72:75], v[32:35], a[64:67], 0
    ds_read_b64_tr_b16 v[50:51], v8 offset:41472
    v_add_u32 v1, 65536, v12
    ds_read_b128 a[8:11], v1 offset:16384
    v_add_u32 v2, 65536, v14
    ds_read_b128 a[72:75], v2 offset:16384
    v_mfma_f32_16x16x32_bf16 v[68:71], v[36:39], a[0:3], 0
    ds_read_b64_tr_b16 v[52:53], v9 offset:40960
    v_mfma_f32_16x16x32_bf16 v[76:79], v[36:39], a[64:67], 0
    ds_read_b64_tr_b16 v[54:55], v9 offset:41472
    s_waitcnt lgkmcnt(6)
    v_mfma_f32_16x16x32_bf16 v[64:67], v[40:43], a[4:7], v[64:67]
    ds_read_b64_tr_b16 v[32:33], v8 offset:45056
    v_mfma_f32_16x16x32_bf16 v[72:75], v[40:43], a[68:71], v[72:75]
    ds_read_b64_tr_b16 v[34:35], v8 offset:45568
    v_add_u32 v1, 65536, v13
    ds_read_b128 a[12:15], v1 offset:16384
    v_add_u32 v2, 65536, v15
    ds_read_b128 a[76:79], v2 offset:16384
    v_mfma_f32_16x16x32_bf16 v[68:71], v[44:47], a[4:7], v[68:71]
    ds_read_b64_tr_b16 v[36:37], v9 offset:45056
    v_mfma_f32_16x16x32_bf16 v[76:79], v[44:47], a[68:71], v[76:79]
    ds_read_b64_tr_b16 v[38:39], v9 offset:45568
    s_waitcnt lgkmcnt(6)
    v_mfma_f32_16x16x32_bf16 v[64:67], v[48:51], a[8:11], v[64:67]
    ds_read_b64_tr_b16 v[40:41], v10 offset:32768
    v_mfma_f32_16x16x32_bf16 v[72:75], v[48:51], a[72:75], v[72:75]
    ds_read_b64_tr_b16 v[42:43], v10 offset:33280
    v_mfma_f32_16x16x32_bf16 v[68:71], v[52:55], a[8:11], v[68:71]
    ds_read_b64_tr_b16 v[44:45], v11 offset:32768
    v_mfma_f32_16x16x32_bf16 v[76:79], v[52:55], a[72:75], v[76:79]
    ds_read_b64_tr_b16 v[46:47], v11 offset:33280
    s_waitcnt lgkmcnt(4)
    v_mfma_f32_16x16x32_bf16 v[64:67], v[32:35], a[12:15], v[64:67]
    ds_read_b64_tr_b16 v[48:49], v10 offset:36864
    v_mfma_f32_16x16x32_bf16 v[72:75], v[32:35], a[76:79], v[72:75]
    ds_read_b64_tr_b16 v[50:51], v10 offset:37376
    v_mfma_f32_16x16x32_bf16 v[68:71], v[36:39], a[12:15], v[68:71]
    ds_read_b64_tr_b16 v[52:53], v11 offset:36864
    v_mfma_f32_16x16x32_bf16 v[76:79], v[36:39], a[76:79], v[76:79]
    ds_read_b64_tr_b16 v[54:55], v11 offset:37376
    s_waitcnt lgkmcnt(4)
    v_mfma_f32_16x16x32_bf16 v[80:83], v[40:43], a[0:3], 0
    ds_read_b64_tr_b16 v[32:33], v10 offset:40960
    v_mfma_f32_16x16x32_bf16 v[88:91], v[40:43], a[64:67], 0
    ds_read_b64_tr_b16 v[34:35], v10 offset:41472
    v_mfma_f32_16x16x32_bf16 v[84:87], v[44:47], a[0:3], 0
    ds_read_b64_tr_b16 v[36:37], v11 offset:40960
    v_mfma_f32_16x16x32_bf16 v[92:95], v[44:47], a[64:67], 0
    ds_read_b64_tr_b16 v[38:39], v11 offset:41472
    s_waitcnt lgkmcnt(4)
    v_mfma_f32_16x16x32_bf16 v[80:83], v[48:51], a[4:7], v[80:83]
    ds_read_b64_tr_b16 v[40:41], v10 offset:45056
    v_mfma_f32_16x16x32_bf16 v[88:91], v[48:51], a[68:71], v[88:91]
    ds_read_b64_tr_b16 v[42:43], v10 offset:45568
    v_mfma_f32_16x16x32_bf16 v[84:87], v[52:55], a[4:7], v[84:87]
    ds_read_b64_tr_b16 v[44:45], v11 offset:45056
    v_mfma_f32_16x16x32_bf16 v[92:95], v[52:55], a[68:71], v[92:95]
    ds_read_b64_tr_b16 v[46:47], v11 offset:45568
    s_waitcnt lgkmcnt(4)
    v_mfma_f32_16x16x32_bf16 v[80:83], v[32:35], a[8:11], v[80:83]
    s_barrier
    ds_read_b64_tr_b16 v[48:49], v8 offset:49152
    v_mfma_f32_16x16x32_bf16 v[88:91], v[32:35], a[72:75], v[88:91]
    ds_read_b64_tr_b16 v[50:51], v8 offset:49664
    v_mfma_f32_16x16x32_bf16 v[84:87], v[36:39], a[8:11], v[84:87]
    ds_read_b64_tr_b16 v[52:53], v9 offset:49152
    v_mfma_f32_16x16x32_bf16 v[92:95], v[36:39], a[72:75], v[92:95]
    ds_read_b64_tr_b16 v[54:55], v9 offset:49664
    s_waitcnt lgkmcnt(4)
    v_mfma_f32_16x16x32_bf16 v[80:83], v[40:43], a[12:15], v[80:83]
    ds_read_b64_tr_b16 v[32:33], v8 offset:53248
    v_mfma_f32_16x16x32_bf16 v[88:91], v[40:43], a[76:79], v[88:91]
    ds_read_b64_tr_b16 v[34:35], v8 offset:53760
    s_add_u32 s3, s63, 0
    s_and_b32 s3, s3, 3
    s_lshl_b32 s3, s3, 8
    v_add_u32 v19, s3, v18
    ds_read_b128 v[56:59], v19 offset:0
    v_mfma_f32_16x16x32_bf16 v[84:87], v[44:47], a[12:15], v[84:87]
    ds_read_b64_tr_b16 v[36:37], v9 offset:53248
    v_mfma_f32_16x16x32_bf16 v[92:95], v[44:47], a[76:79], v[92:95]
    ds_read_b64_tr_b16 v[38:39], v9 offset:53760
    s_waitcnt lgkmcnt(5)
    v_mfma_f32_16x16x32_bf16 v[96:99], v[48:51], a[0:3], 0
    ds_read_b64_tr_b16 v[40:41], v8 offset:57344
    v_mfma_f32_16x16x32_bf16 v[104:107], v[48:51], a[64:67], 0
    ds_read_b64_tr_b16 v[42:43], v8 offset:57856
    v_mfma_f32_16x16x32_bf16 v[100:103], v[52:55], a[0:3], 0
    ds_read_b64_tr_b16 v[44:45], v9 offset:57344
    v_mfma_f32_16x16x32_bf16 v[108:111], v[52:55], a[64:67], 0
    ds_read_b64_tr_b16 v[46:47], v9 offset:57856
    s_waitcnt lgkmcnt(4)
    v_mfma_f32_16x16x32_bf16 v[96:99], v[32:35], a[4:7], v[96:99]
    ds_read_b64_tr_b16 v[48:49], v8 offset:61440
    v_mfma_f32_16x16x32_bf16 v[104:107], v[32:35], a[68:71], v[104:107]
    ds_read_b64_tr_b16 v[50:51], v8 offset:61952
    ds_read_b128 v[60:63], v19 offset:64
    v_mfma_f32_16x16x32_bf16 v[24:27], v[56:59], a[0:3], 0
    v_mfma_f32_16x16x32_bf16 v[100:103], v[36:39], a[4:7], v[100:103]
    ds_read_b64_tr_b16 v[52:53], v9 offset:61440
    v_mfma_f32_16x16x32_bf16 v[108:111], v[36:39], a[68:71], v[108:111]
    ds_read_b64_tr_b16 v[54:55], v9 offset:61952
    v_mfma_f32_16x16x32_bf16 v[28:31], v[56:59], a[64:67], 0
    s_waitcnt lgkmcnt(5)
    v_mfma_f32_16x16x32_bf16 v[96:99], v[40:43], a[8:11], v[96:99]
    ds_read_b64_tr_b16 v[32:33], v10 offset:49152
    v_mfma_f32_16x16x32_bf16 v[104:107], v[40:43], a[72:75], v[104:107]
    ds_read_b64_tr_b16 v[34:35], v10 offset:49664
    v_mfma_f32_16x16x32_bf16 v[100:103], v[44:47], a[8:11], v[100:103]
    ds_read_b64_tr_b16 v[36:37], v11 offset:49152
    v_mfma_f32_16x16x32_bf16 v[108:111], v[44:47], a[72:75], v[108:111]
    ds_read_b64_tr_b16 v[38:39], v11 offset:49664
    s_waitcnt lgkmcnt(4)
    v_mfma_f32_16x16x32_bf16 v[96:99], v[48:51], a[12:15], v[96:99]
    ds_read_b64_tr_b16 v[40:41], v10 offset:53248
    v_mfma_f32_16x16x32_bf16 v[104:107], v[48:51], a[76:79], v[104:107]
    ds_read_b64_tr_b16 v[42:43], v10 offset:53760
    ds_read_b128 v[56:59], v19 offset:128
    v_mfma_f32_16x16x32_bf16 v[24:27], v[60:63], a[4:7], v[24:27]
    v_mfma_f32_16x16x32_bf16 v[100:103], v[52:55], a[12:15], v[100:103]
    ds_read_b64_tr_b16 v[44:45], v11 offset:53248
    v_mfma_f32_16x16x32_bf16 v[108:111], v[52:55], a[76:79], v[108:111]
    ds_read_b64_tr_b16 v[46:47], v11 offset:53760
    v_mfma_f32_16x16x32_bf16 v[28:31], v[60:63], a[68:71], v[28:31]
    s_waitcnt lgkmcnt(5)
    v_mfma_f32_16x16x32_bf16 v[112:115], v[32:35], a[0:3], 0
    ds_read_b64_tr_b16 v[48:49], v10 offset:57344
    v_mfma_f32_16x16x32_bf16 v[120:123], v[32:35], a[64:67], 0
    ds_read_b64_tr_b16 v[50:51], v10 offset:57856
    v_mfma_f32_16x16x32_bf16 v[116:119], v[36:39], a[0:3], 0
    ds_read_b64_tr_b16 v[52:53], v11 offset:57344
    v_mfma_f32_16x16x32_bf16 v[124:127], v[36:39], a[64:67], 0
    ds_read_b64_tr_b16 v[54:55], v11 offset:57856
    s_waitcnt lgkmcnt(4)
    v_mfma_f32_16x16x32_bf16 v[112:115], v[40:43], a[4:7], v[112:115]
    ds_read_b64_tr_b16 v[32:33], v10 offset:61440
    v_mfma_f32_16x16x32_bf16 v[120:123], v[40:43], a[68:71], v[120:123]
    ds_read_b64_tr_b16 v[34:35], v10 offset:61952
    ds_read_b128 v[60:63], v19 offset:192
    v_mfma_f32_16x16x32_bf16 v[24:27], v[56:59], a[8:11], v[24:27]
    v_mfma_f32_16x16x32_bf16 v[116:119], v[44:47], a[4:7], v[116:119]
    ds_read_b64_tr_b16 v[36:37], v11 offset:61440
    v_mfma_f32_16x16x32_bf16 v[124:127], v[44:47], a[68:71], v[124:127]
    ds_read_b64_tr_b16 v[38:39], v11 offset:61952
    v_mfma_f32_16x16x32_bf16 v[28:31], v[56:59], a[72:75], v[28:31]
    s_waitcnt lgkmcnt(5)
    v_mfma_f32_16x16x32_bf16 v[112:115], v[48:51], a[8:11], v[112:115]
    s_barrier
    ds_read_b64_tr_b16 v[40:41], v4 offset:16384
    v_mfma_f32_16x16x32_bf16 v[120:123], v[48:51], a[72:75], v[120:123]
    ds_read_b64_tr_b16 v[42:43], v4 offset:16896
    v_add_u32 v1, 131072, v12
    ds_read_b128 a[16:19], v1 offset:0
    v_add_u32 v2, 131072, v14
    ds_read_b128 a[80:83], v2 offset:0
    v_mfma_f32_16x16x32_bf16 v[116:119], v[52:55], a[8:11], v[116:119]
    ds_read_b64_tr_b16 v[44:45], v5 offset:16384
    v_mfma_f32_16x16x32_bf16 v[124:127], v[52:55], a[72:75], v[124:127]
    ds_read_b64_tr_b16 v[46:47], v5 offset:16896
    s_waitcnt lgkmcnt(6)
    v_mfma_f32_16x16x32_bf16 v[112:115], v[32:35], a[12:15], v[112:115]
    ds_read_b64_tr_b16 v[48:49], v4 offset:20480
    v_mfma_f32_16x16x32_bf16 v[120:123], v[32:35], a[76:79], v[120:123]
    ds_read_b64_tr_b16 v[50:51], v4 offset:20992
    v_add_u32 v1, 131072, v13
    ds_read_b128 a[20:23], v1 offset:0
    v_add_u32 v2, 131072, v15
    ds_read_b128 a[84:87], v2 offset:0
    v_mfma_f32_16x16x32_bf16 v[24:27], v[60:63], a[12:15], v[24:27]
    v_mfma_f32_16x16x32_bf16 v[116:119], v[36:39], a[12:15], v[116:119]
    ds_read_b64_tr_b16 v[52:53], v5 offset:20480
    v_mfma_f32_16x16x32_bf16 v[124:127], v[36:39], a[76:79], v[124:127]
    ds_read_b64_tr_b16 v[54:55], v5 offset:20992
    v_mfma_f32_16x16x32_bf16 v[28:31], v[60:63], a[76:79], v[28:31]
    s_waitcnt lgkmcnt(6)
    v_mfma_f32_16x16x32_bf16 v[64:67], v[40:43], a[16:19], v[64:67]
    ds_read_b64_tr_b16 v[32:33], v4 offset:24576
    v_mfma_f32_16x16x32_bf16 v[72:75], v[40:43], a[80:83], v[72:75]
    ds_read_b64_tr_b16 v[34:35], v4 offset:25088
    ds_read_b128 a[24:27], v12 offset:0
    ds_read_b128 a[88:91], v14 offset:0
    v_mfma_f32_16x16x32_bf16 v[68:71], v[44:47], a[16:19], v[68:71]
    ds_read_b64_tr_b16 v[36:37], v5 offset:24576
    v_mfma_f32_16x16x32_bf16 v[76:79], v[44:47], a[80:83], v[76:79]
    ds_read_b64_tr_b16 v[38:39], v5 offset:25088
    s_waitcnt lgkmcnt(6)
    v_mfma_f32_16x16x32_bf16 v[64:67], v[48:51], a[20:23], v[64:67]
    ds_read_b64_tr_b16 v[40:41], v4 offset:28672
    v_mfma_f32_16x16x32_bf16 v[72:75], v[48:51], a[84:87], v[72:75]
    ds_read_b64_tr_b16 v[42:43], v4 offset:29184
    ds_read_b128 a[28:31], v13 offset:0
    ds_read_b128 a[92:95], v15 offset:0
    v_mfma_f32_16x16x32_bf16 v[68:71], v[52:55], a[20:23], v[68:71]
    ds_read_b64_tr_b16 v[44:45], v5 offset:28672
    v_mfma_f32_16x16x32_bf16 v[76:79], v[52:55], a[84:87], v[76:79]
    ds_read_b64_tr_b16 v[46:47], v5 offset:29184
    s_waitcnt lgkmcnt(6)
    v_mfma_f32_16x16x32_bf16 v[64:67], v[32:35], a[24:27], v[64:67]
    ds_read_b64_tr_b16 v[48:49], v6 offset:16384
    v_mfma_f32_16x16x32_bf16 v[72:75], v[32:35], a[88:91], v[72:75]
    ds_read_b64_tr_b16 v[50:51], v6 offset:16896
    v_mfma_f32_16x16x32_bf16 v[68:71], v[36:39], a[24:27], v[68:71]
    ds_read_b64_tr_b16 v[52:53], v7 offset:16384
    v_mfma_f32_16x16x32_bf16 v[76:79], v[36:39], a[88:91], v[76:79]
    ds_read_b64_tr_b16 v[54:55], v7 offset:16896
    s_waitcnt lgkmcnt(4)
    v_mfma_f32_16x16x32_bf16 v[64:67], v[40:43], a[28:31], v[64:67]
    ds_read_b64_tr_b16 v[32:33], v6 offset:20480
    v_mfma_f32_16x16x32_bf16 v[72:75], v[40:43], a[92:95], v[72:75]
    ds_read_b64_tr_b16 v[34:35], v6 offset:20992
    v_mfma_f32_16x16x32_bf16 v[68:71], v[44:47], a[28:31], v[68:71]
    ds_read_b64_tr_b16 v[36:37], v7 offset:20480
    v_mfma_f32_16x16x32_bf16 v[76:79], v[44:47], a[92:95], v[76:79]
    ds_read_b64_tr_b16 v[38:39], v7 offset:20992
    s_waitcnt lgkmcnt(4)
    v_mfma_f32_16x16x32_bf16 v[80:83], v[48:51], a[16:19], v[80:83]
    ds_read_b64_tr_b16 v[40:41], v6 offset:24576
    v_mfma_f32_16x16x32_bf16 v[88:91], v[48:51], a[80:83], v[88:91]
    ds_read_b64_tr_b16 v[42:43], v6 offset:25088
    v_mfma_f32_16x16x32_bf16 v[84:87], v[52:55], a[16:19], v[84:87]
    ds_read_b64_tr_b16 v[44:45], v7 offset:24576
    v_mfma_f32_16x16x32_bf16 v[92:95], v[52:55], a[80:83], v[92:95]
    ds_read_b64_tr_b16 v[46:47], v7 offset:25088
    s_waitcnt lgkmcnt(4)
    v_mfma_f32_16x16x32_bf16 v[80:83], v[32:35], a[20:23], v[80:83]
    ds_read_b64_tr_b16 v[48:49], v6 offset:28672
    v_mfma_f32_16x16x32_bf16 v[88:91], v[32:35], a[84:87], v[88:91]
    ds_read_b64_tr_b16 v[50:51], v6 offset:29184
    v_mfma_f32_16x16x32_bf16 v[84:87], v[36:39], a[20:23], v[84:87]
    ds_read_b64_tr_b16 v[52:53], v7 offset:28672
    v_mfma_f32_16x16x32_bf16 v[92:95], v[36:39], a[84:87], v[92:95]
    ds_read_b64_tr_b16 v[54:55], v7 offset:29184
    s_waitcnt lgkmcnt(4)
    v_mfma_f32_16x16x32_bf16 v[80:83], v[40:43], a[24:27], v[80:83]
    s_barrier
    ds_read_b64_tr_b16 v[32:33], v4 offset:32768
    v_mfma_f32_16x16x32_bf16 v[88:91], v[40:43], a[88:91], v[88:91]
    ds_read_b64_tr_b16 v[34:35], v4 offset:33280
    v_mfma_f32_16x16x32_bf16 v[84:87], v[44:47], a[24:27], v[84:87]
    ds_read_b64_tr_b16 v[36:37], v5 offset:32768
    v_mfma_f32_16x16x32_bf16 v[92:95], v[44:47], a[88:91], v[92:95]
    ds_read_b64_tr_b16 v[38:39], v5 offset:33280
    s_waitcnt lgkmcnt(4)
    v_mfma_f32_16x16x32_bf16 v[80:83], v[48:51], a[28:31], v[80:83]
    ds_read_b64_tr_b16 v[40:41], v4 offset:36864
    v_mfma_f32_16x16x32_bf16 v[88:91], v[48:51], a[92:95], v[88:91]
    ds_read_b64_tr_b16 v[42:43], v4 offset:37376
    s_add_u32 s3, s63, 1
    s_and_b32 s3, s3, 3
    s_lshl_b32 s3, s3, 8
    v_add_u32 v19, s3, v18
    ds_read_b128 v[56:59], v19 offset:0
    v_mfma_f32_16x16x32_bf16 v[84:87], v[52:55], a[28:31], v[84:87]
    ds_read_b64_tr_b16 v[44:45], v5 offset:36864
    v_mfma_f32_16x16x32_bf16 v[92:95], v[52:55], a[92:95], v[92:95]
    ds_read_b64_tr_b16 v[46:47], v5 offset:37376
    s_waitcnt lgkmcnt(5)
    v_mfma_f32_16x16x32_bf16 v[96:99], v[32:35], a[16:19], v[96:99]
    ds_read_b64_tr_b16 v[48:49], v4 offset:40960
    v_mfma_f32_16x16x32_bf16 v[104:107], v[32:35], a[80:83], v[104:107]
    ds_read_b64_tr_b16 v[50:51], v4 offset:41472
    v_mfma_f32_16x16x32_bf16 v[100:103], v[36:39], a[16:19], v[100:103]
    ds_read_b64_tr_b16 v[52:53], v5 offset:40960
    v_mfma_f32_16x16x32_bf16 v[108:111], v[36:39], a[80:83], v[108:111]
    ds_read_b64_tr_b16 v[54:55], v5 offset:41472
    s_waitcnt lgkmcnt(4)
    v_mfma_f32_16x16x32_bf16 v[96:99], v[40:43], a[20:23], v[96:99]
    ds_read_b64_tr_b16 v[32:33], v4 offset:45056
    v_mfma_f32_16x16x32_bf16 v[104:107], v[40:43], a[84:87], v[104:107]
    ds_read_b64_tr_b16 v[34:35], v4 offset:45568
    ds_read_b128 v[60:63], v19 offset:64
    v_mfma_f32_16x16x32_bf16 v[24:27], v[56:59], a[16:19], v[24:27]
    v_mfma_f32_16x16x32_bf16 v[100:103], v[44:47], a[20:23], v[100:103]
    ds_read_b64_tr_b16 v[36:37], v5 offset:45056
    v_mfma_f32_16x16x32_bf16 v[108:111], v[44:47], a[84:87], v[108:111]
    ds_read_b64_tr_b16 v[38:39], v5 offset:45568
    v_mfma_f32_16x16x32_bf16 v[28:31], v[56:59], a[80:83], v[28:31]
    s_waitcnt lgkmcnt(5)
    v_mfma_f32_16x16x32_bf16 v[96:99], v[48:51], a[24:27], v[96:99]
    ds_read_b64_tr_b16 v[40:41], v6 offset:32768
    v_mfma_f32_16x16x32_bf16 v[104:107], v[48:51], a[88:91], v[104:107]
    ds_read_b64_tr_b16 v[42:43], v6 offset:33280
    v_mfma_f32_16x16x32_bf16 v[100:103], v[52:55], a[24:27], v[100:103]
    ds_read_b64_tr_b16 v[44:45], v7 offset:32768
    v_mfma_f32_16x16x32_bf16 v[108:111], v[52:55], a[88:91], v[108:111]
    ds_read_b64_tr_b16 v[46:47], v7 offset:33280
    s_waitcnt lgkmcnt(4)
    v_mfma_f32_16x16x32_bf16 v[96:99], v[32:35], a[28:31], v[96:99]
    ds_read_b64_tr_b16 v[48:49], v6 offset:36864
    v_mfma_f32_16x16x32_bf16 v[104:107], v[32:35], a[92:95], v[104:107]
    ds_read_b64_tr_b16 v[50:51], v6 offset:37376
    ds_read_b128 v[56:59], v19 offset:128
    v_mfma_f32_16x16x32_bf16 v[24:27], v[60:63], a[20:23], v[24:27]
    v_mfma_f32_16x16x32_bf16 v[100:103], v[36:39], a[28:31], v[100:103]
    ds_read_b64_tr_b16 v[52:53], v7 offset:36864
    v_mfma_f32_16x16x32_bf16 v[108:111], v[36:39], a[92:95], v[108:111]
    ds_read_b64_tr_b16 v[54:55], v7 offset:37376
    v_mfma_f32_16x16x32_bf16 v[28:31], v[60:63], a[84:87], v[28:31]
    s_waitcnt lgkmcnt(5)
    v_mfma_f32_16x16x32_bf16 v[112:115], v[40:43], a[16:19], v[112:115]
    ds_read_b64_tr_b16 v[32:33], v6 offset:40960
    v_mfma_f32_16x16x32_bf16 v[120:123], v[40:43], a[80:83], v[120:123]
    ds_read_b64_tr_b16 v[34:35], v6 offset:41472
    v_mfma_f32_16x16x32_bf16 v[116:119], v[44:47], a[16:19], v[116:119]
    ds_read_b64_tr_b16 v[36:37], v7 offset:40960
    v_mfma_f32_16x16x32_bf16 v[124:127], v[44:47], a[80:83], v[124:127]
    ds_read_b64_tr_b16 v[38:39], v7 offset:41472
    s_waitcnt lgkmcnt(4)
    v_mfma_f32_16x16x32_bf16 v[112:115], v[48:51], a[20:23], v[112:115]
    ds_read_b64_tr_b16 v[40:41], v6 offset:45056
    v_mfma_f32_16x16x32_bf16 v[120:123], v[48:51], a[84:87], v[120:123]
    ds_read_b64_tr_b16 v[42:43], v6 offset:45568
    ds_read_b128 v[60:63], v19 offset:192
    v_mfma_f32_16x16x32_bf16 v[24:27], v[56:59], a[24:27], v[24:27]
    v_mfma_f32_16x16x32_bf16 v[116:119], v[52:55], a[20:23], v[116:119]
    ds_read_b64_tr_b16 v[44:45], v7 offset:45056
    v_mfma_f32_16x16x32_bf16 v[124:127], v[52:55], a[84:87], v[124:127]
    ds_read_b64_tr_b16 v[46:47], v7 offset:45568
    v_mfma_f32_16x16x32_bf16 v[28:31], v[56:59], a[88:91], v[28:31]
    s_waitcnt lgkmcnt(5)
    v_mfma_f32_16x16x32_bf16 v[112:115], v[32:35], a[24:27], v[112:115]
    s_barrier
    ds_read_b64_tr_b16 v[48:49], v8 offset:16384
    v_mfma_f32_16x16x32_bf16 v[120:123], v[32:35], a[88:91], v[120:123]
    ds_read_b64_tr_b16 v[50:51], v8 offset:16896
    ds_read_b128 a[32:35], v12 offset:49152
    ds_read_b128 a[96:99], v14 offset:49152
    v_mfma_f32_16x16x32_bf16 v[116:119], v[36:39], a[24:27], v[116:119]
    ds_read_b64_tr_b16 v[52:53], v9 offset:16384
    v_mfma_f32_16x16x32_bf16 v[124:127], v[36:39], a[88:91], v[124:127]
    ds_read_b64_tr_b16 v[54:55], v9 offset:16896
    s_waitcnt lgkmcnt(6)
    v_mfma_f32_16x16x32_bf16 v[112:115], v[40:43], a[28:31], v[112:115]
    ds_read_b64_tr_b16 v[32:33], v8 offset:20480
    v_mfma_f32_16x16x32_bf16 v[120:123], v[40:43], a[92:95], v[120:123]
    ds_read_b64_tr_b16 v[34:35], v8 offset:20992
    ds_read_b128 a[36:39], v13 offset:49152
    ds_read_b128 a[100:103], v15 offset:49152
    v_mfma_f32_16x16x32_bf16 v[24:27], v[60:63], a[28:31], v[24:27]
    v_mfma_f32_16x16x32_bf16 v[116:119], v[44:47], a[28:31], v[116:119]
    ds_read_b64_tr_b16 v[36:37], v9 offset:20480
    v_mfma_f32_16x16x32_bf16 v[124:127], v[44:47], a[92:95], v[124:127]
    ds_read_b64_tr_b16 v[38:39], v9 offset:20992
    v_mfma_f32_16x16x32_bf16 v[28:31], v[60:63], a[92:95], v[28:31]
    s_waitcnt lgkmcnt(6)
    v_mfma_f32_16x16x32_bf16 v[64:67], v[48:51], a[32:35], v[64:67]
    ds_read_b64_tr_b16 v[40:41], v8 offset:24576
    v_mfma_f32_16x16x32_bf16 v[72:75], v[48:51], a[96:99], v[72:75]
    ds_read_b64_tr_b16 v[42:43], v8 offset:25088
    v_add_u32 v1, 65536, v12
    ds_read_b128 a[40:43], v1 offset:0
    v_add_u32 v2, 65536, v14
    ds_read_b128 a[104:107], v2 offset:0
    v_mfma_f32_16x16x32_bf16 v[68:71], v[52:55], a[32:35], v[68:71]
    ds_read_b64_tr_b16 v[44:45], v9 offset:24576
    v_mfma_f32_16x16x32_bf16 v[76:79], v[52:55], a[96:99], v[76:79]
    ds_read_b64_tr_b16 v[46:47], v9 offset:25088
    s_waitcnt lgkmcnt(6)
    v_mfma_f32_16x16x32_bf16 v[64:67], v[32:35], a[36:39], v[64:67]
    ds_read_b64_tr_b16 v[48:49], v8 offset:28672
    v_mfma_f32_16x16x32_bf16 v[72:75], v[32:35], a[100:103], v[72:75]
    ds_read_b64_tr_b16 v[50:51], v8 offset:29184
    v_add_u32 v1, 65536, v13
    ds_read_b128 a[44:47], v1 offset:0
    v_add_u32 v2, 65536, v15
    ds_read_b128 a[108:111], v2 offset:0
    v_mfma_f32_16x16x32_bf16 v[68:71], v[36:39], a[36:39], v[68:71]
    ds_read_b64_tr_b16 v[52:53], v9 offset:28672
    v_mfma_f32_16x16x32_bf16 v[76:79], v[36:39], a[100:103], v[76:79]
    ds_read_b64_tr_b16 v[54:55], v9 offset:29184
    s_waitcnt lgkmcnt(6)
    v_mfma_f32_16x16x32_bf16 v[64:67], v[40:43], a[40:43], v[64:67]
    ds_read_b64_tr_b16 v[32:33], v10 offset:16384
    v_mfma_f32_16x16x32_bf16 v[72:75], v[40:43], a[104:107], v[72:75]
    ds_read_b64_tr_b16 v[34:35], v10 offset:16896
    v_mfma_f32_16x16x32_bf16 v[68:71], v[44:47], a[40:43], v[68:71]
    ds_read_b64_tr_b16 v[36:37], v11 offset:16384
    v_mfma_f32_16x16x32_bf16 v[76:79], v[44:47], a[104:107], v[76:79]
    ds_read_b64_tr_b16 v[38:39], v11 offset:16896
    s_waitcnt lgkmcnt(4)
    v_mfma_f32_16x16x32_bf16 v[64:67], v[48:51], a[44:47], v[64:67]
    ds_read_b64_tr_b16 v[40:41], v10 offset:20480
    v_mfma_f32_16x16x32_bf16 v[72:75], v[48:51], a[108:111], v[72:75]
    ds_read_b64_tr_b16 v[42:43], v10 offset:20992
    v_mfma_f32_16x16x32_bf16 v[68:71], v[52:55], a[44:47], v[68:71]
    ds_read_b64_tr_b16 v[44:45], v11 offset:20480
    v_mfma_f32_16x16x32_bf16 v[76:79], v[52:55], a[108:111], v[76:79]
    ds_read_b64_tr_b16 v[46:47], v11 offset:20992
    s_waitcnt lgkmcnt(4)
    v_mfma_f32_16x16x32_bf16 v[80:83], v[32:35], a[32:35], v[80:83]
    ds_read_b64_tr_b16 v[48:49], v10 offset:24576
    v_mfma_f32_16x16x32_bf16 v[88:91], v[32:35], a[96:99], v[88:91]
    ds_read_b64_tr_b16 v[50:51], v10 offset:25088
    v_mfma_f32_16x16x32_bf16 v[84:87], v[36:39], a[32:35], v[84:87]
    ds_read_b64_tr_b16 v[52:53], v11 offset:24576
    v_mfma_f32_16x16x32_bf16 v[92:95], v[36:39], a[96:99], v[92:95]
    ds_read_b64_tr_b16 v[54:55], v11 offset:25088
    s_waitcnt lgkmcnt(4)
    v_mfma_f32_16x16x32_bf16 v[80:83], v[40:43], a[36:39], v[80:83]
    ds_read_b64_tr_b16 v[32:33], v10 offset:28672
    v_mfma_f32_16x16x32_bf16 v[88:91], v[40:43], a[100:103], v[88:91]
    ds_read_b64_tr_b16 v[34:35], v10 offset:29184
    v_mfma_f32_16x16x32_bf16 v[84:87], v[44:47], a[36:39], v[84:87]
    ds_read_b64_tr_b16 v[36:37], v11 offset:28672
    v_mfma_f32_16x16x32_bf16 v[92:95], v[44:47], a[100:103], v[92:95]
    ds_read_b64_tr_b16 v[38:39], v11 offset:29184
    s_waitcnt lgkmcnt(4)
    v_mfma_f32_16x16x32_bf16 v[80:83], v[48:51], a[40:43], v[80:83]
    s_barrier
    ds_read_b64_tr_b16 v[40:41], v8 offset:32768
    v_mfma_f32_16x16x32_bf16 v[88:91], v[48:51], a[104:107], v[88:91]
    ds_read_b64_tr_b16 v[42:43], v8 offset:33280
    v_mfma_f32_16x16x32_bf16 v[84:87], v[52:55], a[40:43], v[84:87]
    ds_read_b64_tr_b16 v[44:45], v9 offset:32768
    v_mfma_f32_16x16x32_bf16 v[92:95], v[52:55], a[104:107], v[92:95]
    ds_read_b64_tr_b16 v[46:47], v9 offset:33280
    s_waitcnt lgkmcnt(4)
    v_mfma_f32_16x16x32_bf16 v[80:83], v[32:35], a[44:47], v[80:83]
    ds_read_b64_tr_b16 v[48:49], v8 offset:36864
    v_mfma_f32_16x16x32_bf16 v[88:91], v[32:35], a[108:111], v[88:91]
    ds_read_b64_tr_b16 v[50:51], v8 offset:37376
    s_add_u32 s3, s63, 2
    s_and_b32 s3, s3, 3
    s_lshl_b32 s3, s3, 8
    v_add_u32 v19, s3, v18
    ds_read_b128 v[56:59], v19 offset:0
    v_mfma_f32_16x16x32_bf16 v[84:87], v[36:39], a[44:47], v[84:87]
    ds_read_b64_tr_b16 v[52:53], v9 offset:36864
    v_mfma_f32_16x16x32_bf16 v[92:95], v[36:39], a[108:111], v[92:95]
    ds_read_b64_tr_b16 v[54:55], v9 offset:37376
    s_waitcnt lgkmcnt(5)
    v_mfma_f32_16x16x32_bf16 v[96:99], v[40:43], a[32:35], v[96:99]
    ds_read_b64_tr_b16 v[32:33], v8 offset:40960
    v_mfma_f32_16x16x32_bf16 v[104:107], v[40:43], a[96:99], v[104:107]
    ds_read_b64_tr_b16 v[34:35], v8 offset:41472
    v_mfma_f32_16x16x32_bf16 v[100:103], v[44:47], a[32:35], v[100:103]
    ds_read_b64_tr_b16 v[36:37], v9 offset:40960
    v_mfma_f32_16x16x32_bf16 v[108:111], v[44:47], a[96:99], v[108:111]
    ds_read_b64_tr_b16 v[38:39], v9 offset:41472
    s_waitcnt lgkmcnt(4)
    v_mfma_f32_16x16x32_bf16 v[96:99], v[48:51], a[36:39], v[96:99]
    ds_read_b64_tr_b16 v[40:41], v8 offset:45056
    v_mfma_f32_16x16x32_bf16 v[104:107], v[48:51], a[100:103], v[104:107]
    ds_read_b64_tr_b16 v[42:43], v8 offset:45568
    ds_read_b128 v[60:63], v19 offset:64
    v_mfma_f32_16x16x32_bf16 v[24:27], v[56:59], a[32:35], v[24:27]
    v_mfma_f32_16x16x32_bf16 v[100:103], v[52:55], a[36:39], v[100:103]
    ds_read_b64_tr_b16 v[44:45], v9 offset:45056
    v_mfma_f32_16x16x32_bf16 v[108:111], v[52:55], a[100:103], v[108:111]
    ds_read_b64_tr_b16 v[46:47], v9 offset:45568
    v_mfma_f32_16x16x32_bf16 v[28:31], v[56:59], a[96:99], v[28:31]
    s_waitcnt lgkmcnt(5)
    v_mfma_f32_16x16x32_bf16 v[96:99], v[32:35], a[40:43], v[96:99]
    ds_read_b64_tr_b16 v[48:49], v10 offset:32768
    v_mfma_f32_16x16x32_bf16 v[104:107], v[32:35], a[104:107], v[104:107]
    ds_read_b64_tr_b16 v[50:51], v10 offset:33280
    v_mfma_f32_16x16x32_bf16 v[100:103], v[36:39], a[40:43], v[100:103]
    ds_read_b64_tr_b16 v[52:53], v11 offset:32768
    v_mfma_f32_16x16x32_bf16 v[108:111], v[36:39], a[104:107], v[108:111]
    ds_read_b64_tr_b16 v[54:55], v11 offset:33280
    s_waitcnt lgkmcnt(4)
    v_mfma_f32_16x16x32_bf16 v[96:99], v[40:43], a[44:47], v[96:99]
    ds_read_b64_tr_b16 v[32:33], v10 offset:36864
    v_mfma_f32_16x16x32_bf16 v[104:107], v[40:43], a[108:111], v[104:107]
    ds_read_b64_tr_b16 v[34:35], v10 offset:37376
    ds_read_b128 v[56:59], v19 offset:128
    v_mfma_f32_16x16x32_bf16 v[24:27], v[60:63], a[36:39], v[24:27]
    v_mfma_f32_16x16x32_bf16 v[100:103], v[44:47], a[44:47], v[100:103]
    ds_read_b64_tr_b16 v[36:37], v11 offset:36864
    v_mfma_f32_16x16x32_bf16 v[108:111], v[44:47], a[108:111], v[108:111]
    ds_read_b64_tr_b16 v[38:39], v11 offset:37376
    v_mfma_f32_16x16x32_bf16 v[28:31], v[60:63], a[100:103], v[28:31]
    s_waitcnt lgkmcnt(5)
    v_mfma_f32_16x16x32_bf16 v[112:115], v[48:51], a[32:35], v[112:115]
    ds_read_b64_tr_b16 v[40:41], v10 offset:40960
    v_mfma_f32_16x16x32_bf16 v[120:123], v[48:51], a[96:99], v[120:123]
    ds_read_b64_tr_b16 v[42:43], v10 offset:41472
    v_mfma_f32_16x16x32_bf16 v[116:119], v[52:55], a[32:35], v[116:119]
    ds_read_b64_tr_b16 v[44:45], v11 offset:40960
    v_mfma_f32_16x16x32_bf16 v[124:127], v[52:55], a[96:99], v[124:127]
    ds_read_b64_tr_b16 v[46:47], v11 offset:41472
    s_waitcnt lgkmcnt(4)
    v_mfma_f32_16x16x32_bf16 v[112:115], v[32:35], a[36:39], v[112:115]
    ds_read_b64_tr_b16 v[48:49], v10 offset:45056
    v_mfma_f32_16x16x32_bf16 v[120:123], v[32:35], a[100:103], v[120:123]
    ds_read_b64_tr_b16 v[50:51], v10 offset:45568
    ds_read_b128 v[60:63], v19 offset:192
    v_mfma_f32_16x16x32_bf16 v[24:27], v[56:59], a[40:43], v[24:27]
    v_mfma_f32_16x16x32_bf16 v[116:119], v[36:39], a[36:39], v[116:119]
    ds_read_b64_tr_b16 v[52:53], v11 offset:45056
    v_mfma_f32_16x16x32_bf16 v[124:127], v[36:39], a[100:103], v[124:127]
    ds_read_b64_tr_b16 v[54:55], v11 offset:45568
    v_mfma_f32_16x16x32_bf16 v[28:31], v[56:59], a[104:107], v[28:31]
    s_waitcnt lgkmcnt(5)
    v_mfma_f32_16x16x32_bf16 v[112:115], v[40:43], a[40:43], v[112:115]
    s_barrier
    ds_read_b64_tr_b16 v[32:33], v4 offset:0
    v_mfma_f32_16x16x32_bf16 v[120:123], v[40:43], a[104:107], v[120:123]
    ds_read_b64_tr_b16 v[34:35], v4 offset:512
    v_add_u32 v1, 65536, v12
    ds_read_b128 a[48:51], v1 offset:49152
    v_add_u32 v2, 65536, v14
    ds_read_b128 a[112:115], v2 offset:49152
    v_mfma_f32_16x16x32_bf16 v[116:119], v[44:47], a[40:43], v[116:119]
    ds_read_b64_tr_b16 v[36:37], v5 offset:0
    v_mfma_f32_16x16x32_bf16 v[124:127], v[44:47], a[104:107], v[124:127]
    ds_read_b64_tr_b16 v[38:39], v5 offset:512
    s_waitcnt lgkmcnt(6)
    v_mfma_f32_16x16x32_bf16 v[112:115], v[48:51], a[44:47], v[112:115]
    ds_read_b64_tr_b16 v[40:41], v4 offset:4096
    v_mfma_f32_16x16x32_bf16 v[120:123], v[48:51], a[108:111], v[120:123]
    ds_read_b64_tr_b16 v[42:43], v4 offset:4608
    v_add_u32 v1, 65536, v13
    ds_read_b128 a[52:55], v1 offset:49152
    v_add_u32 v2, 65536, v15
    ds_read_b128 a[116:119], v2 offset:49152
    v_mfma_f32_16x16x32_bf16 v[24:27], v[60:63], a[44:47], v[24:27]
    v_mfma_f32_16x16x32_bf16 v[116:119], v[52:55], a[44:47], v[116:119]
    ds_read_b64_tr_b16 v[44:45], v5 offset:4096
    v_mfma_f32_16x16x32_bf16 v[124:127], v[52:55], a[108:111], v[124:127]
    ds_read_b64_tr_b16 v[46:47], v5 offset:4608
    v_mfma_f32_16x16x32_bf16 v[28:31], v[60:63], a[108:111], v[28:31]
    s_waitcnt lgkmcnt(6)
    v_mfma_f32_16x16x32_bf16 v[64:67], v[32:35], a[48:51], v[64:67]
    ds_read_b64_tr_b16 v[48:49], v4 offset:8192
    v_mfma_f32_16x16x32_bf16 v[72:75], v[32:35], a[112:115], v[72:75]
    ds_read_b64_tr_b16 v[50:51], v4 offset:8704
    v_add_u32 v1, 131072, v12
    ds_read_b128 a[56:59], v1 offset:0
    v_add_u32 v2, 131072, v14
    ds_read_b128 a[120:123], v2 offset:0
    v_mfma_f32_16x16x32_bf16 v[68:71], v[36:39], a[48:51], v[68:71]
    ds_read_b64_tr_b16 v[52:53], v5 offset:8192
    v_mfma_f32_16x16x32_bf16 v[76:79], v[36:39], a[112:115], v[76:79]
    ds_read_b64_tr_b16 v[54:55], v5 offset:8704
    s_waitcnt lgkmcnt(6)
    v_mfma_f32_16x16x32_bf16 v[64:67], v[40:43], a[52:55], v[64:67]
    ds_read_b64_tr_b16 v[32:33], v4 offset:12288
    v_mfma_f32_16x16x32_bf16 v[72:75], v[40:43], a[116:119], v[72:75]
    ds_read_b64_tr_b16 v[34:35], v4 offset:12800
    v_add_u32 v1, 131072, v13
    ds_read_b128 a[60:63], v1 offset:0
    v_add_u32 v2, 131072, v15
    ds_read_b128 a[124:127], v2 offset:0
    v_mfma_f32_16x16x32_bf16 v[68:71], v[44:47], a[52:55], v[68:71]
    ds_read_b64_tr_b16 v[36:37], v5 offset:12288
    v_mfma_f32_16x16x32_bf16 v[76:79], v[44:47], a[116:119], v[76:79]
    ds_read_b64_tr_b16 v[38:39], v5 offset:12800
    s_waitcnt lgkmcnt(6)
    v_mfma_f32_16x16x32_bf16 v[64:67], v[48:51], a[56:59], v[64:67]
    ds_read_b64_tr_b16 v[40:41], v6 offset:0
    v_mfma_f32_16x16x32_bf16 v[72:75], v[48:51], a[120:123], v[72:75]
    ds_read_b64_tr_b16 v[42:43], v6 offset:512
    v_mfma_f32_16x16x32_bf16 v[68:71], v[52:55], a[56:59], v[68:71]
    ds_read_b64_tr_b16 v[44:45], v7 offset:0
    v_mfma_f32_16x16x32_bf16 v[76:79], v[52:55], a[120:123], v[76:79]
    ds_read_b64_tr_b16 v[46:47], v7 offset:512
    s_waitcnt lgkmcnt(4)
    v_mfma_f32_16x16x32_bf16 v[64:67], v[32:35], a[60:63], v[64:67]
    ds_read_b64_tr_b16 v[48:49], v6 offset:4096
    v_mfma_f32_16x16x32_bf16 v[72:75], v[32:35], a[124:127], v[72:75]
    ds_read_b64_tr_b16 v[50:51], v6 offset:4608
    v_mfma_f32_16x16x32_bf16 v[68:71], v[36:39], a[60:63], v[68:71]
    ds_read_b64_tr_b16 v[52:53], v7 offset:4096
    v_mfma_f32_16x16x32_bf16 v[76:79], v[36:39], a[124:127], v[76:79]
    ds_read_b64_tr_b16 v[54:55], v7 offset:4608
    s_waitcnt lgkmcnt(4)
    v_mfma_f32_16x16x32_bf16 v[80:83], v[40:43], a[48:51], v[80:83]
    ds_read_b64_tr_b16 v[32:33], v6 offset:8192
    v_mfma_f32_16x16x32_bf16 v[88:91], v[40:43], a[112:115], v[88:91]
    ds_read_b64_tr_b16 v[34:35], v6 offset:8704
    v_mfma_f32_16x16x32_bf16 v[84:87], v[44:47], a[48:51], v[84:87]
    ds_read_b64_tr_b16 v[36:37], v7 offset:8192
    v_cvt_pk_bf16_f32 v64, v64, v65
    v_mfma_f32_16x16x32_bf16 v[92:95], v[44:47], a[112:115], v[92:95]
    ds_read_b64_tr_b16 v[38:39], v7 offset:8704
    v_cvt_pk_bf16_f32 v65, v66, v67
    s_waitcnt lgkmcnt(4)
    v_mfma_f32_16x16x32_bf16 v[80:83], v[48:51], a[52:55], v[80:83]
    ds_read_b64_tr_b16 v[40:41], v6 offset:12288
    v_cvt_pk_bf16_f32 v66, v68, v69
    v_mfma_f32_16x16x32_bf16 v[88:91], v[48:51], a[116:119], v[88:91]
    ds_read_b64_tr_b16 v[42:43], v6 offset:12800
    v_cvt_pk_bf16_f32 v67, v70, v71
    v_mfma_f32_16x16x32_bf16 v[84:87], v[52:55], a[52:55], v[84:87]
    ds_read_b64_tr_b16 v[44:45], v7 offset:12288
    v_cvt_pk_bf16_f32 v68, v72, v73
    v_mfma_f32_16x16x32_bf16 v[92:95], v[52:55], a[116:119], v[92:95]
    ds_read_b64_tr_b16 v[46:47], v7 offset:12800
    v_cvt_pk_bf16_f32 v69, v74, v75
    s_waitcnt lgkmcnt(4)
    v_mfma_f32_16x16x32_bf16 v[80:83], v[32:35], a[56:59], v[80:83]
    s_barrier
    ds_read_b64_tr_b16 v[48:49], v4 offset:16384
    v_cvt_pk_bf16_f32 v70, v76, v77
    v_mfma_f32_16x16x32_bf16 v[88:91], v[32:35], a[120:123], v[88:91]
    ds_read_b64_tr_b16 v[50:51], v4 offset:16896
    v_cvt_pk_bf16_f32 v71, v78, v79
    v_mfma_f32_16x16x32_bf16 v[84:87], v[36:39], a[56:59], v[84:87]
    ds_read_b64_tr_b16 v[52:53], v5 offset:16384
    s_lshr_b32 s94, s93, 2
    s_add_u32 s94, s94, s89
    s_add_u32 s94, s94, 0
    v_mfma_f32_16x16x32_bf16 v[92:95], v[36:39], a[120:123], v[92:95]
    ds_read_b64_tr_b16 v[54:55], v5 offset:16896
    v_pk_max_i16 v64, v64, 0
    s_waitcnt lgkmcnt(4)
    v_mfma_f32_16x16x32_bf16 v[80:83], v[40:43], a[60:63], v[80:83]
    ds_read_b64_tr_b16 v[32:33], v4 offset:20480
    v_pk_max_i16 v65, v65, 0
    v_mfma_f32_16x16x32_bf16 v[88:91], v[40:43], a[124:127], v[88:91]
    ds_read_b64_tr_b16 v[34:35], v4 offset:20992
    s_add_u32 s3, s63, 3
    s_and_b32 s3, s3, 3
    s_lshl_b32 s3, s3, 8
    v_add_u32 v19, s3, v18
    ds_read_b128 v[56:59], v19 offset:0
    v_pk_max_i16 v66, v66, 0
    v_mfma_f32_16x16x32_bf16 v[84:87], v[44:47], a[60:63], v[84:87]
    ds_read_b64_tr_b16 v[36:37], v5 offset:20480
    v_pk_max_i16 v67, v67, 0
    v_mfma_f32_16x16x32_bf16 v[92:95], v[44:47], a[124:127], v[92:95]
    ds_read_b64_tr_b16 v[38:39], v5 offset:20992
    buffer_store_dwordx4 v[64:67], v16, s[32:35], s94 offen offset:0 sc1
    s_waitcnt lgkmcnt(5)
    v_mfma_f32_16x16x32_bf16 v[96:99], v[48:51], a[48:51], v[96:99]
    ds_read_b64_tr_b16 v[40:41], v4 offset:24576
    v_pk_max_i16 v68, v68, 0
    v_mfma_f32_16x16x32_bf16 v[104:107], v[48:51], a[112:115], v[104:107]
    ds_read_b64_tr_b16 v[42:43], v4 offset:25088
    v_pk_max_i16 v69, v69, 0
    v_mfma_f32_16x16x32_bf16 v[100:103], v[52:55], a[48:51], v[100:103]
    ds_read_b64_tr_b16 v[44:45], v5 offset:24576
    v_pk_max_i16 v70, v70, 0
    v_mfma_f32_16x16x32_bf16 v[108:111], v[52:55], a[112:115], v[108:111]
    ds_read_b64_tr_b16 v[46:47], v5 offset:25088
    v_pk_max_i16 v71, v71, 0
    s_waitcnt lgkmcnt(4)
    v_mfma_f32_16x16x32_bf16 v[96:99], v[32:35], a[52:55], v[96:99]
    ds_read_b64_tr_b16 v[48:49], v4 offset:28672
    buffer_store_dwordx4 v[68:71], v16, s[32:35], s94 offen offset:1024 sc1
    v_mfma_f32_16x16x32_bf16 v[104:107], v[32:35], a[116:119], v[104:107]
    ds_read_b64_tr_b16 v[50:51], v4 offset:29184
    ds_read_b128 v[60:63], v19 offset:64
    v_mfma_f32_16x16x32_bf16 v[24:27], v[56:59], a[48:51], v[24:27]
    v_cvt_pk_bf16_f32 v80, v80, v81
    v_mfma_f32_16x16x32_bf16 v[100:103], v[36:39], a[52:55], v[100:103]
    ds_read_b64_tr_b16 v[52:53], v5 offset:28672
    v_cvt_pk_bf16_f32 v81, v82, v83
    v_mfma_f32_16x16x32_bf16 v[108:111], v[36:39], a[116:119], v[108:111]
    ds_read_b64_tr_b16 v[54:55], v5 offset:29184
    v_mfma_f32_16x16x32_bf16 v[28:31], v[56:59], a[112:115], v[28:31]
    v_cvt_pk_bf16_f32 v82, v84, v85
    s_waitcnt lgkmcnt(5)
    v_mfma_f32_16x16x32_bf16 v[96:99], v[40:43], a[56:59], v[96:99]
    ds_read_b64_tr_b16 v[32:33], v6 offset:16384
    v_cvt_pk_bf16_f32 v83, v86, v87
    v_mfma_f32_16x16x32_bf16 v[104:107], v[40:43], a[120:123], v[104:107]
    ds_read_b64_tr_b16 v[34:35], v6 offset:16896
    v_cvt_pk_bf16_f32 v84, v88, v89
    v_mfma_f32_16x16x32_bf16 v[100:103], v[44:47], a[56:59], v[100:103]
    ds_read_b64_tr_b16 v[36:37], v7 offset:16384
    v_cvt_pk_bf16_f32 v85, v90, v91
    v_mfma_f32_16x16x32_bf16 v[108:111], v[44:47], a[120:123], v[108:111]
    ds_read_b64_tr_b16 v[38:39], v7 offset:16896
    v_cvt_pk_bf16_f32 v86, v92, v93
    s_waitcnt lgkmcnt(4)
    v_mfma_f32_16x16x32_bf16 v[96:99], v[48:51], a[60:63], v[96:99]
    ds_read_b64_tr_b16 v[40:41], v6 offset:20480
    v_cvt_pk_bf16_f32 v87, v94, v95
    v_mfma_f32_16x16x32_bf16 v[104:107], v[48:51], a[124:127], v[104:107]
    ds_read_b64_tr_b16 v[42:43], v6 offset:20992
    ds_read_b128 v[56:59], v19 offset:128
    v_mfma_f32_16x16x32_bf16 v[24:27], v[60:63], a[52:55], v[24:27]
    s_lshr_b32 s94, s93, 2
    s_add_u32 s94, s94, s89
    s_add_u32 s94, s94, 8192
    v_mfma_f32_16x16x32_bf16 v[100:103], v[52:55], a[60:63], v[100:103]
    ds_read_b64_tr_b16 v[44:45], v7 offset:20480
    v_pk_max_i16 v80, v80, 0
    v_mfma_f32_16x16x32_bf16 v[108:111], v[52:55], a[124:127], v[108:111]
    ds_read_b64_tr_b16 v[46:47], v7 offset:20992
    v_mfma_f32_16x16x32_bf16 v[28:31], v[60:63], a[116:119], v[28:31]
    v_pk_max_i16 v81, v81, 0
    s_waitcnt lgkmcnt(5)
    v_mfma_f32_16x16x32_bf16 v[112:115], v[32:35], a[48:51], v[112:115]
    ds_read_b64_tr_b16 v[48:49], v6 offset:24576
    v_pk_max_i16 v82, v82, 0
    v_mfma_f32_16x16x32_bf16 v[120:123], v[32:35], a[112:115], v[120:123]
    ds_read_b64_tr_b16 v[50:51], v6 offset:25088
    v_pk_max_i16 v83, v83, 0
    v_mfma_f32_16x16x32_bf16 v[116:119], v[36:39], a[48:51], v[116:119]
    ds_read_b64_tr_b16 v[52:53], v7 offset:24576
    buffer_store_dwordx4 v[80:83], v16, s[32:35], s94 offen offset:0 sc1
    v_mfma_f32_16x16x32_bf16 v[124:127], v[36:39], a[112:115], v[124:127]
    ds_read_b64_tr_b16 v[54:55], v7 offset:25088
    v_pk_max_i16 v84, v84, 0
    s_waitcnt lgkmcnt(4)
    v_mfma_f32_16x16x32_bf16 v[112:115], v[40:43], a[52:55], v[112:115]
    ds_read_b64_tr_b16 v[32:33], v6 offset:28672
    v_pk_max_i16 v85, v85, 0
    v_mfma_f32_16x16x32_bf16 v[120:123], v[40:43], a[116:119], v[120:123]
    ds_read_b64_tr_b16 v[34:35], v6 offset:29184
    ds_read_b128 v[60:63], v19 offset:192
    v_mfma_f32_16x16x32_bf16 v[24:27], v[56:59], a[56:59], v[24:27]
    v_pk_max_i16 v86, v86, 0
    v_mfma_f32_16x16x32_bf16 v[116:119], v[44:47], a[52:55], v[116:119]
    ds_read_b64_tr_b16 v[36:37], v7 offset:28672
    v_pk_max_i16 v87, v87, 0
    v_mfma_f32_16x16x32_bf16 v[124:127], v[44:47], a[116:119], v[124:127]
    ds_read_b64_tr_b16 v[38:39], v7 offset:29184
    v_mfma_f32_16x16x32_bf16 v[28:31], v[56:59], a[120:123], v[28:31]
    buffer_store_dwordx4 v[84:87], v16, s[32:35], s94 offen offset:1024 sc1
    s_waitcnt lgkmcnt(5)
    v_mfma_f32_16x16x32_bf16 v[112:115], v[48:51], a[56:59], v[112:115]
    s_barrier
    ds_read_b64_tr_b16 v[40:41], v4 offset:32768
    v_cvt_pk_bf16_f32 v96, v96, v97
    v_mfma_f32_16x16x32_bf16 v[120:123], v[48:51], a[120:123], v[120:123]
    ds_read_b64_tr_b16 v[42:43], v4 offset:33280
    v_cvt_pk_bf16_f32 v97, v98, v99
    v_mfma_f32_16x16x32_bf16 v[116:119], v[52:55], a[56:59], v[116:119]
    ds_read_b64_tr_b16 v[44:45], v5 offset:32768
    v_cvt_pk_bf16_f32 v98, v100, v101
    v_mfma_f32_16x16x32_bf16 v[124:127], v[52:55], a[120:123], v[124:127]
    ds_read_b64_tr_b16 v[46:47], v5 offset:33280
    v_cvt_pk_bf16_f32 v99, v102, v103
    s_waitcnt lgkmcnt(4)
    v_mfma_f32_16x16x32_bf16 v[112:115], v[32:35], a[60:63], v[112:115]
    ds_read_b64_tr_b16 v[48:49], v4 offset:36864
    v_cvt_pk_bf16_f32 v100, v104, v105
    v_mfma_f32_16x16x32_bf16 v[120:123], v[32:35], a[124:127], v[120:123]
    ds_read_b64_tr_b16 v[50:51], v4 offset:37376
    v_mfma_f32_16x16x32_bf16 v[24:27], v[60:63], a[60:63], v[24:27]
    v_cvt_pk_bf16_f32 v101, v106, v107
    v_mfma_f32_16x16x32_bf16 v[116:119], v[36:39], a[60:63], v[116:119]
    ds_read_b64_tr_b16 v[52:53], v5 offset:36864
    v_cvt_pk_bf16_f32 v102, v108, v109
    v_mfma_f32_16x16x32_bf16 v[124:127], v[36:39], a[124:127], v[124:127]
    ds_read_b64_tr_b16 v[54:55], v5 offset:37376
    v_mfma_f32_16x16x32_bf16 v[28:31], v[60:63], a[124:127], v[28:31]
    v_cvt_pk_bf16_f32 v103, v110, v111
    s_waitcnt lgkmcnt(4)
    v_mfma_f32_16x16x32_bf16 v[64:67], v[40:43], a[0:3], 0
    ds_read_b64_tr_b16 v[32:33], v4 offset:40960
    s_lshr_b32 s94, s93, 2
    s_add_u32 s94, s94, s89
    s_add_u32 s94, s94, 32768
    v_mfma_f32_16x16x32_bf16 v[72:75], v[40:43], a[64:67], 0
    ds_read_b64_tr_b16 v[34:35], v4 offset:41472
    v_pk_max_i16 v96, v96, 0
    v_mfma_f32_16x16x32_bf16 v[68:71], v[44:47], a[0:3], 0
    ds_read_b64_tr_b16 v[36:37], v5 offset:40960
    v_pk_max_i16 v97, v97, 0
    v_mfma_f32_16x16x32_bf16 v[76:79], v[44:47], a[64:67], 0
    ds_read_b64_tr_b16 v[38:39], v5 offset:41472
    v_pk_max_i16 v98, v98, 0
    s_waitcnt lgkmcnt(4)
    v_mfma_f32_16x16x32_bf16 v[64:67], v[48:51], a[4:7], v[64:67]
    ds_read_b64_tr_b16 v[40:41], v4 offset:45056
    v_pk_max_i16 v99, v99, 0
    v_mfma_f32_16x16x32_bf16 v[72:75], v[48:51], a[68:71], v[72:75]
    ds_read_b64_tr_b16 v[42:43], v4 offset:45568
    buffer_store_dwordx4 v[96:99], v16, s[32:35], s94 offen offset:0 sc1
    v_mfma_f32_16x16x32_bf16 v[68:71], v[52:55], a[4:7], v[68:71]
    ds_read_b64_tr_b16 v[44:45], v5 offset:45056
    v_pk_max_i16 v100, v100, 0
    v_mfma_f32_16x16x32_bf16 v[76:79], v[52:55], a[68:71], v[76:79]
    ds_read_b64_tr_b16 v[46:47], v5 offset:45568
    v_pk_max_i16 v101, v101, 0
    s_waitcnt lgkmcnt(4)
    v_mfma_f32_16x16x32_bf16 v[64:67], v[32:35], a[8:11], v[64:67]
    ds_read_b64_tr_b16 v[48:49], v6 offset:32768
    v_pk_max_i16 v102, v102, 0
    v_mfma_f32_16x16x32_bf16 v[72:75], v[32:35], a[72:75], v[72:75]
    ds_read_b64_tr_b16 v[50:51], v6 offset:33280
    v_pk_max_i16 v103, v103, 0
    v_mfma_f32_16x16x32_bf16 v[68:71], v[36:39], a[8:11], v[68:71]
    ds_read_b64_tr_b16 v[52:53], v7 offset:32768
    buffer_store_dwordx4 v[100:103], v16, s[32:35], s94 offen offset:1024 sc1
    v_mfma_f32_16x16x32_bf16 v[76:79], v[36:39], a[72:75], v[76:79]
    ds_read_b64_tr_b16 v[54:55], v7 offset:33280
    v_cvt_pk_bf16_f32 v112, v112, v113
    s_waitcnt lgkmcnt(4)
    v_mfma_f32_16x16x32_bf16 v[64:67], v[40:43], a[12:15], v[64:67]
    ds_read_b64_tr_b16 v[32:33], v6 offset:36864
    v_cvt_pk_bf16_f32 v113, v114, v115
    v_mfma_f32_16x16x32_bf16 v[72:75], v[40:43], a[76:79], v[72:75]
    ds_read_b64_tr_b16 v[34:35], v6 offset:37376
    v_cvt_pk_bf16_f32 v114, v116, v117
    v_mfma_f32_16x16x32_bf16 v[68:71], v[44:47], a[12:15], v[68:71]
    ds_read_b64_tr_b16 v[36:37], v7 offset:36864
    v_cvt_pk_bf16_f32 v115, v118, v119
    v_mfma_f32_16x16x32_bf16 v[76:79], v[44:47], a[76:79], v[76:79]
    ds_read_b64_tr_b16 v[38:39], v7 offset:37376
    v_cvt_pk_bf16_f32 v116, v120, v121
    s_waitcnt lgkmcnt(4)
    v_mfma_f32_16x16x32_bf16 v[80:83], v[48:51], a[0:3], 0
    ds_read_b64_tr_b16 v[40:41], v6 offset:40960
    v_cvt_pk_bf16_f32 v117, v122, v123
    v_mfma_f32_16x16x32_bf16 v[88:91], v[48:51], a[64:67], 0
    ds_read_b64_tr_b16 v[42:43], v6 offset:41472
    v_cvt_pk_bf16_f32 v118, v124, v125
    v_mfma_f32_16x16x32_bf16 v[84:87], v[52:55], a[0:3], 0
    ds_read_b64_tr_b16 v[44:45], v7 offset:40960
    v_cvt_pk_bf16_f32 v119, v126, v127
    v_mfma_f32_16x16x32_bf16 v[92:95], v[52:55], a[64:67], 0
    ds_read_b64_tr_b16 v[46:47], v7 offset:41472
    s_lshr_b32 s94, s93, 2
    s_add_u32 s94, s94, s89
    s_add_u32 s94, s94, 40960
    s_waitcnt lgkmcnt(4)
    v_mfma_f32_16x16x32_bf16 v[80:83], v[32:35], a[4:7], v[80:83]
    ds_read_b64_tr_b16 v[48:49], v6 offset:45056
    v_pk_max_i16 v112, v112, 0
    v_mfma_f32_16x16x32_bf16 v[88:91], v[32:35], a[68:71], v[88:91]
    ds_read_b64_tr_b16 v[50:51], v6 offset:45568
    v_pk_max_i16 v113, v113, 0
    v_mfma_f32_16x16x32_bf16 v[84:87], v[36:39], a[4:7], v[84:87]
    ds_read_b64_tr_b16 v[52:53], v7 offset:45056
    v_pk_max_i16 v114, v114, 0
    v_mfma_f32_16x16x32_bf16 v[92:95], v[36:39], a[68:71], v[92:95]
    ds_read_b64_tr_b16 v[54:55], v7 offset:45568
    v_pk_max_i16 v115, v115, 0
    s_waitcnt lgkmcnt(4)
    v_mfma_f32_16x16x32_bf16 v[80:83], v[40:43], a[8:11], v[80:83]
    s_barrier
    ds_read_b64_tr_b16 v[32:33], v4 offset:49152
    buffer_store_dwordx4 v[112:115], v16, s[32:35], s94 offen offset:0 sc1
    v_mfma_f32_16x16x32_bf16 v[88:91], v[40:43], a[72:75], v[88:91]
    ds_read_b64_tr_b16 v[34:35], v4 offset:49664
    v_pk_max_i16 v116, v116, 0
    v_mfma_f32_16x16x32_bf16 v[84:87], v[44:47], a[8:11], v[84:87]
    ds_read_b64_tr_b16 v[36:37], v5 offset:49152
    v_pk_max_i16 v117, v117, 0
    v_mfma_f32_16x16x32_bf16 v[92:95], v[44:47], a[72:75], v[92:95]
    ds_read_b64_tr_b16 v[38:39], v5 offset:49664
    v_pk_max_i16 v118, v118, 0
    s_waitcnt lgkmcnt(4)
    v_mfma_f32_16x16x32_bf16 v[80:83], v[48:51], a[12:15], v[80:83]
    ds_read_b64_tr_b16 v[40:41], v4 offset:53248
    v_pk_max_i16 v119, v119, 0
    v_mfma_f32_16x16x32_bf16 v[88:91], v[48:51], a[76:79], v[88:91]
    ds_read_b64_tr_b16 v[42:43], v4 offset:53760
    buffer_store_dwordx4 v[116:119], v16, s[32:35], s94 offen offset:1024 sc1
    v_mfma_f32_16x16x32_bf16 v[84:87], v[52:55], a[12:15], v[84:87]
    ds_read_b64_tr_b16 v[44:45], v5 offset:53248
    v_cvt_pk_bf16_f32 v3, v24, v28
    v_mfma_f32_16x16x32_bf16 v[92:95], v[52:55], a[76:79], v[92:95]
    ds_read_b64_tr_b16 v[46:47], v5 offset:53760
    v_lshlrev_b32 v56, 16, v3
    s_waitcnt lgkmcnt(4)
    v_mfma_f32_16x16x32_bf16 v[64:67], v[32:35], a[16:19], v[64:67]
    ds_read_b64_tr_b16 v[48:49], v4 offset:57344
    v_and_b32 v58, 0xffff0000, v3
    v_mfma_f32_16x16x32_bf16 v[72:75], v[32:35], a[80:83], v[72:75]
    ds_read_b64_tr_b16 v[50:51], v4 offset:57856
    v_mul_f32 v56, 3216550459, v56
    v_mfma_f32_16x16x32_bf16 v[68:71], v[36:39], a[16:19], v[68:71]
    ds_read_b64_tr_b16 v[52:53], v5 offset:57344
    v_mul_f32 v58, 3216550459, v58
    v_mfma_f32_16x16x32_bf16 v[76:79], v[36:39], a[80:83], v[76:79]
    ds_read_b64_tr_b16 v[54:55], v5 offset:57856
    v_exp_f32 v56, v56
    s_waitcnt lgkmcnt(4)
    v_mfma_f32_16x16x32_bf16 v[64:67], v[40:43], a[20:23], v[64:67]
    ds_read_b64_tr_b16 v[32:33], v4 offset:61440
    v_exp_f32 v58, v58
    v_mfma_f32_16x16x32_bf16 v[72:75], v[40:43], a[84:87], v[72:75]
    ds_read_b64_tr_b16 v[34:35], v4 offset:61952
    v_add_f32 v56, 1.0, v56
    v_mfma_f32_16x16x32_bf16 v[68:71], v[44:47], a[20:23], v[68:71]
    ds_read_b64_tr_b16 v[36:37], v5 offset:61440
    v_add_f32 v58, 1.0, v58
    v_mfma_f32_16x16x32_bf16 v[76:79], v[44:47], a[84:87], v[76:79]
    ds_read_b64_tr_b16 v[38:39], v5 offset:61952
    v_rcp_f32 v56, v56
    s_waitcnt lgkmcnt(4)
    v_mfma_f32_16x16x32_bf16 v[64:67], v[48:51], a[24:27], v[64:67]
    ds_read_b64_tr_b16 v[40:41], v6 offset:49152
    v_rcp_f32 v58, v58
    v_mfma_f32_16x16x32_bf16 v[72:75], v[48:51], a[88:91], v[72:75]
    ds_read_b64_tr_b16 v[42:43], v6 offset:49664
    v_cvt_pk_bf16_f32 v3, v56, v58
    v_mfma_f32_16x16x32_bf16 v[68:71], v[52:55], a[24:27], v[68:71]
    ds_read_b64_tr_b16 v[44:45], v7 offset:49152
    v_lshlrev_b32 v56, 16, v3
    v_mfma_f32_16x16x32_bf16 v[76:79], v[52:55], a[88:91], v[76:79]
    ds_read_b64_tr_b16 v[46:47], v7 offset:49664
    v_and_b32 v58, 0xffff0000, v3
    s_waitcnt lgkmcnt(4)
    v_mfma_f32_16x16x32_bf16 v[64:67], v[32:35], a[28:31], v[64:67]
    ds_read_b64_tr_b16 v[48:49], v6 offset:53248
    v_sub_f32 v57, 1.0, v56
    v_mfma_f32_16x16x32_bf16 v[72:75], v[32:35], a[92:95], v[72:75]
    ds_read_b64_tr_b16 v[50:51], v6 offset:53760
    v_sub_f32 v59, 1.0, v58
    v_mfma_f32_16x16x32_bf16 v[68:71], v[36:39], a[28:31], v[68:71]
    ds_read_b64_tr_b16 v[52:53], v7 offset:53248
    v_cvt_pk_bf16_f32 v3, v57, v59
    v_mfma_f32_16x16x32_bf16 v[76:79], v[36:39], a[92:95], v[76:79]
    ds_read_b64_tr_b16 v[54:55], v7 offset:53760
    v_lshlrev_b32 v57, 16, v3
    s_waitcnt lgkmcnt(4)
    v_mfma_f32_16x16x32_bf16 v[80:83], v[40:43], a[16:19], v[80:83]
    ds_read_b64_tr_b16 v[32:33], v6 offset:57344
    v_and_b32 v59, 0xffff0000, v3
    v_mfma_f32_16x16x32_bf16 v[88:91], v[40:43], a[80:83], v[88:91]
    ds_read_b64_tr_b16 v[34:35], v6 offset:57856
    v_max_f32 v56, 562036736, v56
    v_mfma_f32_16x16x32_bf16 v[84:87], v[44:47], a[16:19], v[84:87]
    ds_read_b64_tr_b16 v[36:37], v7 offset:57344
    v_max_f32 v58, 562036736, v58
    v_mfma_f32_16x16x32_bf16 v[92:95], v[44:47], a[80:83], v[92:95]
    ds_read_b64_tr_b16 v[38:39], v7 offset:57856
    v_rcp_f32 v60, v56
    s_waitcnt lgkmcnt(4)
    v_mfma_f32_16x16x32_bf16 v[80:83], v[48:51], a[20:23], v[80:83]
    ds_read_b64_tr_b16 v[40:41], v6 offset:61440
    v_rcp_f32 v61, v58
    v_mfma_f32_16x16x32_bf16 v[88:91], v[48:51], a[84:87], v[88:91]
    ds_read_b64_tr_b16 v[42:43], v6 offset:61952
    v_mul_f32 v57, v60, v57
    v_mfma_f32_16x16x32_bf16 v[84:87], v[52:55], a[20:23], v[84:87]
    ds_read_b64_tr_b16 v[44:45], v7 offset:61440
    v_mul_f32 v59, v61, v59
    v_mfma_f32_16x16x32_bf16 v[92:95], v[52:55], a[84:87], v[92:95]
    ds_read_b64_tr_b16 v[46:47], v7 offset:61952
    s_lshl_b32 s3, s61, 2
    s_add_u32 s3, s3, s64
    s_lshl_b32 s3, s3, 12
    s_lshr_b32 s67, s65, 2
    s_add_u32 s3, s3, s67
    s_add_u32 s3, s3, 9961472
    s_lshl_b32 s67, s66, 28
    s_add_u32 s3, s3, s67
    buffer_store_dwordx4 v[56:59], v16, s[32:35], s3 offen sc1
    s_waitcnt lgkmcnt(4)
    v_mfma_f32_16x16x32_bf16 v[80:83], v[32:35], a[24:27], v[80:83]
    s_waitcnt vmcnt(5)
    s_barrier
    ds_read_b64_tr_b16 v[48:49], v8 offset:0
    v_mfma_f32_16x16x32_bf16 v[88:91], v[32:35], a[88:91], v[88:91]
    ds_read_b64_tr_b16 v[50:51], v8 offset:512
    v_mfma_f32_16x16x32_bf16 v[84:87], v[36:39], a[24:27], v[84:87]
    ds_read_b64_tr_b16 v[52:53], v9 offset:0
    v_mfma_f32_16x16x32_bf16 v[92:95], v[36:39], a[88:91], v[92:95]
    ds_read_b64_tr_b16 v[54:55], v9 offset:512
    s_waitcnt lgkmcnt(4)
    v_mfma_f32_16x16x32_bf16 v[80:83], v[40:43], a[28:31], v[80:83]
    ds_read_b64_tr_b16 v[32:33], v8 offset:4096
    v_mfma_f32_16x16x32_bf16 v[88:91], v[40:43], a[92:95], v[88:91]
    ds_read_b64_tr_b16 v[34:35], v8 offset:4608
    v_mfma_f32_16x16x32_bf16 v[84:87], v[44:47], a[28:31], v[84:87]
    ds_read_b64_tr_b16 v[36:37], v9 offset:4096
    v_mfma_f32_16x16x32_bf16 v[92:95], v[44:47], a[92:95], v[92:95]
    ds_read_b64_tr_b16 v[38:39], v9 offset:4608
    s_waitcnt lgkmcnt(4)
    v_mfma_f32_16x16x32_bf16 v[64:67], v[48:51], a[32:35], v[64:67]
    ds_read_b64_tr_b16 v[40:41], v8 offset:8192
    v_mfma_f32_16x16x32_bf16 v[72:75], v[48:51], a[96:99], v[72:75]
    ds_read_b64_tr_b16 v[42:43], v8 offset:8704
    v_mfma_f32_16x16x32_bf16 v[68:71], v[52:55], a[32:35], v[68:71]
    ds_read_b64_tr_b16 v[44:45], v9 offset:8192
    v_mfma_f32_16x16x32_bf16 v[76:79], v[52:55], a[96:99], v[76:79]
    ds_read_b64_tr_b16 v[46:47], v9 offset:8704
    s_waitcnt lgkmcnt(4)
    v_mfma_f32_16x16x32_bf16 v[64:67], v[32:35], a[36:39], v[64:67]
    ds_read_b64_tr_b16 v[48:49], v8 offset:12288
    v_mfma_f32_16x16x32_bf16 v[72:75], v[32:35], a[100:103], v[72:75]
    ds_read_b64_tr_b16 v[50:51], v8 offset:12800
    v_mfma_f32_16x16x32_bf16 v[68:71], v[36:39], a[36:39], v[68:71]
    ds_read_b64_tr_b16 v[52:53], v9 offset:12288
    v_mfma_f32_16x16x32_bf16 v[76:79], v[36:39], a[100:103], v[76:79]
    ds_read_b64_tr_b16 v[54:55], v9 offset:12800
    s_waitcnt lgkmcnt(4)
    v_mfma_f32_16x16x32_bf16 v[64:67], v[40:43], a[40:43], v[64:67]
    ds_read_b64_tr_b16 v[32:33], v10 offset:0
    v_mfma_f32_16x16x32_bf16 v[72:75], v[40:43], a[104:107], v[72:75]
    ds_read_b64_tr_b16 v[34:35], v10 offset:512
    v_mfma_f32_16x16x32_bf16 v[68:71], v[44:47], a[40:43], v[68:71]
    ds_read_b64_tr_b16 v[36:37], v11 offset:0
    v_mfma_f32_16x16x32_bf16 v[76:79], v[44:47], a[104:107], v[76:79]
    ds_read_b64_tr_b16 v[38:39], v11 offset:512
    s_waitcnt lgkmcnt(4)
    v_mfma_f32_16x16x32_bf16 v[64:67], v[48:51], a[44:47], v[64:67]
    ds_read_b64_tr_b16 v[40:41], v10 offset:4096
    v_mfma_f32_16x16x32_bf16 v[72:75], v[48:51], a[108:111], v[72:75]
    ds_read_b64_tr_b16 v[42:43], v10 offset:4608
    v_mfma_f32_16x16x32_bf16 v[68:71], v[52:55], a[44:47], v[68:71]
    ds_read_b64_tr_b16 v[44:45], v11 offset:4096
    v_mfma_f32_16x16x32_bf16 v[76:79], v[52:55], a[108:111], v[76:79]
    ds_read_b64_tr_b16 v[46:47], v11 offset:4608
    s_waitcnt lgkmcnt(4)
    v_mfma_f32_16x16x32_bf16 v[80:83], v[32:35], a[32:35], v[80:83]
    ds_read_b64_tr_b16 v[48:49], v10 offset:8192
    v_mfma_f32_16x16x32_bf16 v[88:91], v[32:35], a[96:99], v[88:91]
    ds_read_b64_tr_b16 v[50:51], v10 offset:8704
    v_mfma_f32_16x16x32_bf16 v[84:87], v[36:39], a[32:35], v[84:87]
    ds_read_b64_tr_b16 v[52:53], v11 offset:8192
    v_mfma_f32_16x16x32_bf16 v[92:95], v[36:39], a[96:99], v[92:95]
    ds_read_b64_tr_b16 v[54:55], v11 offset:8704
    s_waitcnt lgkmcnt(4)
    v_mfma_f32_16x16x32_bf16 v[80:83], v[40:43], a[36:39], v[80:83]
    ds_read_b64_tr_b16 v[32:33], v10 offset:12288
    v_mfma_f32_16x16x32_bf16 v[88:91], v[40:43], a[100:103], v[88:91]
    ds_read_b64_tr_b16 v[34:35], v10 offset:12800
    v_mfma_f32_16x16x32_bf16 v[84:87], v[44:47], a[36:39], v[84:87]
    ds_read_b64_tr_b16 v[36:37], v11 offset:12288
    v_mfma_f32_16x16x32_bf16 v[92:95], v[44:47], a[100:103], v[92:95]
    ds_read_b64_tr_b16 v[38:39], v11 offset:12800
    s_waitcnt lgkmcnt(4)
    v_mfma_f32_16x16x32_bf16 v[80:83], v[48:51], a[40:43], v[80:83]
    s_waitcnt vmcnt(1)
    s_waitcnt vmcnt(0)
    s_barrier
    ds_read_b64_tr_b16 v[40:41], v8 offset:16384
    v_mfma_f32_16x16x32_bf16 v[88:91], v[48:51], a[104:107], v[88:91]
    ds_read_b64_tr_b16 v[42:43], v8 offset:16896
    v_mfma_f32_16x16x32_bf16 v[84:87], v[52:55], a[40:43], v[84:87]
    ds_read_b64_tr_b16 v[44:45], v9 offset:16384
    v_mfma_f32_16x16x32_bf16 v[92:95], v[52:55], a[104:107], v[92:95]
    ds_read_b64_tr_b16 v[46:47], v9 offset:16896
    s_waitcnt lgkmcnt(4)
    v_mfma_f32_16x16x32_bf16 v[80:83], v[32:35], a[44:47], v[80:83]
    ds_read_b64_tr_b16 v[48:49], v8 offset:20480
    v_mfma_f32_16x16x32_bf16 v[88:91], v[32:35], a[108:111], v[88:91]
    ds_read_b64_tr_b16 v[50:51], v8 offset:20992
    v_mfma_f32_16x16x32_bf16 v[84:87], v[36:39], a[44:47], v[84:87]
    ds_read_b64_tr_b16 v[52:53], v9 offset:20480
    v_mfma_f32_16x16x32_bf16 v[92:95], v[36:39], a[108:111], v[92:95]
    ds_read_b64_tr_b16 v[54:55], v9 offset:20992
    s_waitcnt lgkmcnt(4)
    v_mfma_f32_16x16x32_bf16 v[64:67], v[40:43], a[48:51], v[64:67]
    ds_read_b64_tr_b16 v[32:33], v8 offset:24576
    v_mfma_f32_16x16x32_bf16 v[72:75], v[40:43], a[112:115], v[72:75]
    ds_read_b64_tr_b16 v[34:35], v8 offset:25088
    v_mfma_f32_16x16x32_bf16 v[68:71], v[44:47], a[48:51], v[68:71]
    ds_read_b64_tr_b16 v[36:37], v9 offset:24576
    v_mfma_f32_16x16x32_bf16 v[76:79], v[44:47], a[112:115], v[76:79]
    ds_read_b64_tr_b16 v[38:39], v9 offset:25088
    s_waitcnt lgkmcnt(4)
    v_mfma_f32_16x16x32_bf16 v[64:67], v[48:51], a[52:55], v[64:67]
    ds_read_b64_tr_b16 v[40:41], v8 offset:28672
    v_mfma_f32_16x16x32_bf16 v[72:75], v[48:51], a[116:119], v[72:75]
    ds_read_b64_tr_b16 v[42:43], v8 offset:29184
    v_mfma_f32_16x16x32_bf16 v[68:71], v[52:55], a[52:55], v[68:71]
    ds_read_b64_tr_b16 v[44:45], v9 offset:28672
    v_mfma_f32_16x16x32_bf16 v[76:79], v[52:55], a[116:119], v[76:79]
    ds_read_b64_tr_b16 v[46:47], v9 offset:29184
    s_waitcnt lgkmcnt(4)
    v_mfma_f32_16x16x32_bf16 v[64:67], v[32:35], a[56:59], v[64:67]
    ds_read_b64_tr_b16 v[48:49], v10 offset:16384
    v_mfma_f32_16x16x32_bf16 v[72:75], v[32:35], a[120:123], v[72:75]
    ds_read_b64_tr_b16 v[50:51], v10 offset:16896
    v_mfma_f32_16x16x32_bf16 v[68:71], v[36:39], a[56:59], v[68:71]
    ds_read_b64_tr_b16 v[52:53], v11 offset:16384
    v_mfma_f32_16x16x32_bf16 v[76:79], v[36:39], a[120:123], v[76:79]
    ds_read_b64_tr_b16 v[54:55], v11 offset:16896
    s_waitcnt lgkmcnt(4)
    v_mfma_f32_16x16x32_bf16 v[64:67], v[40:43], a[60:63], v[64:67]
    ds_read_b64_tr_b16 v[32:33], v10 offset:20480
    v_mfma_f32_16x16x32_bf16 v[72:75], v[40:43], a[124:127], v[72:75]
    ds_read_b64_tr_b16 v[34:35], v10 offset:20992
    v_mfma_f32_16x16x32_bf16 v[68:71], v[44:47], a[60:63], v[68:71]
    ds_read_b64_tr_b16 v[36:37], v11 offset:20480
    v_mfma_f32_16x16x32_bf16 v[76:79], v[44:47], a[124:127], v[76:79]
    ds_read_b64_tr_b16 v[38:39], v11 offset:20992
    s_waitcnt lgkmcnt(4)
    v_mfma_f32_16x16x32_bf16 v[80:83], v[48:51], a[48:51], v[80:83]
    ds_read_b64_tr_b16 v[40:41], v10 offset:24576
    v_mfma_f32_16x16x32_bf16 v[88:91], v[48:51], a[112:115], v[88:91]
    ds_read_b64_tr_b16 v[42:43], v10 offset:25088
    v_mfma_f32_16x16x32_bf16 v[84:87], v[52:55], a[48:51], v[84:87]
    ds_read_b64_tr_b16 v[44:45], v11 offset:24576
    v_cvt_pk_bf16_f32 v64, v64, v65
    v_mfma_f32_16x16x32_bf16 v[92:95], v[52:55], a[112:115], v[92:95]
    ds_read_b64_tr_b16 v[46:47], v11 offset:25088
    v_cvt_pk_bf16_f32 v65, v66, v67
    s_waitcnt lgkmcnt(4)
    v_mfma_f32_16x16x32_bf16 v[80:83], v[32:35], a[52:55], v[80:83]
    ds_read_b64_tr_b16 v[48:49], v10 offset:28672
    v_cvt_pk_bf16_f32 v66, v68, v69
    v_mfma_f32_16x16x32_bf16 v[88:91], v[32:35], a[116:119], v[88:91]
    ds_read_b64_tr_b16 v[50:51], v10 offset:29184
    v_cvt_pk_bf16_f32 v67, v70, v71
    v_mfma_f32_16x16x32_bf16 v[84:87], v[36:39], a[52:55], v[84:87]
    ds_read_b64_tr_b16 v[52:53], v11 offset:28672
    v_cvt_pk_bf16_f32 v68, v72, v73
    v_mfma_f32_16x16x32_bf16 v[92:95], v[36:39], a[116:119], v[92:95]
    ds_read_b64_tr_b16 v[54:55], v11 offset:29184
    v_cvt_pk_bf16_f32 v69, v74, v75
    s_waitcnt lgkmcnt(4)
    v_mfma_f32_16x16x32_bf16 v[80:83], v[40:43], a[56:59], v[80:83]
    s_barrier
    ds_read_b64_tr_b16 v[32:33], v8 offset:32768
    v_cvt_pk_bf16_f32 v70, v76, v77
    v_mfma_f32_16x16x32_bf16 v[88:91], v[40:43], a[120:123], v[88:91]
    ds_read_b64_tr_b16 v[34:35], v8 offset:33280
    v_cvt_pk_bf16_f32 v71, v78, v79
    v_mfma_f32_16x16x32_bf16 v[84:87], v[44:47], a[56:59], v[84:87]
    ds_read_b64_tr_b16 v[36:37], v9 offset:32768
    s_lshr_b32 s94, s93, 2
    s_add_u32 s94, s94, s89
    s_add_u32 s94, s94, 65536
    v_mfma_f32_16x16x32_bf16 v[92:95], v[44:47], a[120:123], v[92:95]
    ds_read_b64_tr_b16 v[38:39], v9 offset:33280
    v_pk_max_i16 v64, v64, 0
    s_waitcnt lgkmcnt(4)
    v_mfma_f32_16x16x32_bf16 v[80:83], v[48:51], a[60:63], v[80:83]
    ds_read_b64_tr_b16 v[40:41], v8 offset:36864
    v_pk_max_i16 v65, v65, 0
    v_mfma_f32_16x16x32_bf16 v[88:91], v[48:51], a[124:127], v[88:91]
    ds_read_b64_tr_b16 v[42:43], v8 offset:37376
    v_pk_max_i16 v66, v66, 0
    v_mfma_f32_16x16x32_bf16 v[84:87], v[52:55], a[60:63], v[84:87]
    ds_read_b64_tr_b16 v[44:45], v9 offset:36864
    v_pk_max_i16 v67, v67, 0
    v_mfma_f32_16x16x32_bf16 v[92:95], v[52:55], a[124:127], v[92:95]
    ds_read_b64_tr_b16 v[46:47], v9 offset:37376
    buffer_store_dwordx4 v[64:67], v16, s[32:35], s94 offen offset:0 sc1
    s_waitcnt lgkmcnt(4)
    v_mfma_f32_16x16x32_bf16 v[96:99], v[32:35], a[0:3], 0
    ds_read_b64_tr_b16 v[48:49], v8 offset:40960
    v_pk_max_i16 v68, v68, 0
    v_mfma_f32_16x16x32_bf16 v[104:107], v[32:35], a[64:67], 0
    ds_read_b64_tr_b16 v[50:51], v8 offset:41472
    v_pk_max_i16 v69, v69, 0
    v_mfma_f32_16x16x32_bf16 v[100:103], v[36:39], a[0:3], 0
    ds_read_b64_tr_b16 v[52:53], v9 offset:40960
    v_pk_max_i16 v70, v70, 0
    v_mfma_f32_16x16x32_bf16 v[108:111], v[36:39], a[64:67], 0
    ds_read_b64_tr_b16 v[54:55], v9 offset:41472
    v_pk_max_i16 v71, v71, 0
    s_waitcnt lgkmcnt(4)
    v_mfma_f32_16x16x32_bf16 v[96:99], v[40:43], a[4:7], v[96:99]
    ds_read_b64_tr_b16 v[32:33], v8 offset:45056
    buffer_store_dwordx4 v[68:71], v16, s[32:35], s94 offen offset:1024 sc1
    v_mfma_f32_16x16x32_bf16 v[104:107], v[40:43], a[68:71], v[104:107]
    ds_read_b64_tr_b16 v[34:35], v8 offset:45568
    v_cvt_pk_bf16_f32 v80, v80, v81
    v_mfma_f32_16x16x32_bf16 v[100:103], v[44:47], a[4:7], v[100:103]
    ds_read_b64_tr_b16 v[36:37], v9 offset:45056
    v_cvt_pk_bf16_f32 v81, v82, v83
    v_mfma_f32_16x16x32_bf16 v[108:111], v[44:47], a[68:71], v[108:111]
    ds_read_b64_tr_b16 v[38:39], v9 offset:45568
    v_cvt_pk_bf16_f32 v82, v84, v85
    s_waitcnt lgkmcnt(4)
    v_mfma_f32_16x16x32_bf16 v[96:99], v[48:51], a[8:11], v[96:99]
    ds_read_b64_tr_b16 v[40:41], v10 offset:32768
    v_cvt_pk_bf16_f32 v83, v86, v87
    v_mfma_f32_16x16x32_bf16 v[104:107], v[48:51], a[72:75], v[104:107]
    ds_read_b64_tr_b16 v[42:43], v10 offset:33280
    v_cvt_pk_bf16_f32 v84, v88, v89
    v_mfma_f32_16x16x32_bf16 v[100:103], v[52:55], a[8:11], v[100:103]
    ds_read_b64_tr_b16 v[44:45], v11 offset:32768
    v_cvt_pk_bf16_f32 v85, v90, v91
    v_mfma_f32_16x16x32_bf16 v[108:111], v[52:55], a[72:75], v[108:111]
    ds_read_b64_tr_b16 v[46:47], v11 offset:33280
    v_cvt_pk_bf16_f32 v86, v92, v93
    s_waitcnt lgkmcnt(4)
    v_mfma_f32_16x16x32_bf16 v[96:99], v[32:35], a[12:15], v[96:99]
    ds_read_b64_tr_b16 v[48:49], v10 offset:36864
    v_cvt_pk_bf16_f32 v87, v94, v95
    v_mfma_f32_16x16x32_bf16 v[104:107], v[32:35], a[76:79], v[104:107]
    ds_read_b64_tr_b16 v[50:51], v10 offset:37376
    s_lshr_b32 s94, s93, 2
    s_add_u32 s94, s94, s89
    s_add_u32 s94, s94, 73728
    v_mfma_f32_16x16x32_bf16 v[100:103], v[36:39], a[12:15], v[100:103]
    ds_read_b64_tr_b16 v[52:53], v11 offset:36864
    v_pk_max_i16 v80, v80, 0
    v_mfma_f32_16x16x32_bf16 v[108:111], v[36:39], a[76:79], v[108:111]
    ds_read_b64_tr_b16 v[54:55], v11 offset:37376
    v_pk_max_i16 v81, v81, 0
    s_waitcnt lgkmcnt(4)
    v_mfma_f32_16x16x32_bf16 v[96:99], v[40:43], a[32:35], v[96:99]
    ds_read_b64_tr_b16 v[32:33], v10 offset:40960
    v_pk_max_i16 v82, v82, 0
    v_mfma_f32_16x16x32_bf16 v[104:107], v[40:43], a[96:99], v[104:107]
    ds_read_b64_tr_b16 v[34:35], v10 offset:41472
    v_pk_max_i16 v83, v83, 0
    v_mfma_f32_16x16x32_bf16 v[100:103], v[44:47], a[32:35], v[100:103]
    ds_read_b64_tr_b16 v[36:37], v11 offset:40960
    buffer_store_dwordx4 v[80:83], v16, s[32:35], s94 offen offset:0 sc1
    v_mfma_f32_16x16x32_bf16 v[108:111], v[44:47], a[96:99], v[108:111]
    ds_read_b64_tr_b16 v[38:39], v11 offset:41472
    v_pk_max_i16 v84, v84, 0
    s_waitcnt lgkmcnt(4)
    v_mfma_f32_16x16x32_bf16 v[96:99], v[48:51], a[36:39], v[96:99]
    ds_read_b64_tr_b16 v[40:41], v10 offset:45056
    v_pk_max_i16 v85, v85, 0
    v_mfma_f32_16x16x32_bf16 v[104:107], v[48:51], a[100:103], v[104:107]
    ds_read_b64_tr_b16 v[42:43], v10 offset:45568
    v_pk_max_i16 v86, v86, 0
    v_mfma_f32_16x16x32_bf16 v[100:103], v[52:55], a[36:39], v[100:103]
    ds_read_b64_tr_b16 v[44:45], v11 offset:45056
    v_pk_max_i16 v87, v87, 0
    v_mfma_f32_16x16x32_bf16 v[108:111], v[52:55], a[100:103], v[108:111]
    ds_read_b64_tr_b16 v[46:47], v11 offset:45568
    buffer_store_dwordx4 v[84:87], v16, s[32:35], s94 offen offset:1024 sc1
    s_waitcnt lgkmcnt(4)
    v_mfma_f32_16x16x32_bf16 v[96:99], v[32:35], a[40:43], v[96:99]
    s_barrier
    ds_read_b64_tr_b16 v[48:49], v8 offset:49152
    v_mfma_f32_16x16x32_bf16 v[104:107], v[32:35], a[104:107], v[104:107]
    ds_read_b64_tr_b16 v[50:51], v8 offset:49664
    v_mfma_f32_16x16x32_bf16 v[100:103], v[36:39], a[40:43], v[100:103]
    ds_read_b64_tr_b16 v[52:53], v9 offset:49152
    v_mfma_f32_16x16x32_bf16 v[108:111], v[36:39], a[104:107], v[108:111]
    ds_read_b64_tr_b16 v[54:55], v9 offset:49664
    s_waitcnt lgkmcnt(4)
    v_mfma_f32_16x16x32_bf16 v[96:99], v[40:43], a[44:47], v[96:99]
    ds_read_b64_tr_b16 v[32:33], v8 offset:53248
    v_mfma_f32_16x16x32_bf16 v[104:107], v[40:43], a[108:111], v[104:107]
    ds_read_b64_tr_b16 v[34:35], v8 offset:53760
    v_mfma_f32_16x16x32_bf16 v[100:103], v[44:47], a[44:47], v[100:103]
    ds_read_b64_tr_b16 v[36:37], v9 offset:53248
    v_mfma_f32_16x16x32_bf16 v[108:111], v[44:47], a[108:111], v[108:111]
    ds_read_b64_tr_b16 v[38:39], v9 offset:53760
    s_waitcnt lgkmcnt(4)
    v_mfma_f32_16x16x32_bf16 v[96:99], v[48:51], a[16:19], v[96:99]
    ds_read_b64_tr_b16 v[40:41], v8 offset:57344
    v_mfma_f32_16x16x32_bf16 v[104:107], v[48:51], a[80:83], v[104:107]
    ds_read_b64_tr_b16 v[42:43], v8 offset:57856
    v_mfma_f32_16x16x32_bf16 v[100:103], v[52:55], a[16:19], v[100:103]
    ds_read_b64_tr_b16 v[44:45], v9 offset:57344
    v_mfma_f32_16x16x32_bf16 v[108:111], v[52:55], a[80:83], v[108:111]
    ds_read_b64_tr_b16 v[46:47], v9 offset:57856
    s_waitcnt lgkmcnt(4)
    v_mfma_f32_16x16x32_bf16 v[96:99], v[32:35], a[20:23], v[96:99]
    ds_read_b64_tr_b16 v[48:49], v8 offset:61440
    v_mfma_f32_16x16x32_bf16 v[104:107], v[32:35], a[84:87], v[104:107]
    ds_read_b64_tr_b16 v[50:51], v8 offset:61952
    v_mfma_f32_16x16x32_bf16 v[100:103], v[36:39], a[20:23], v[100:103]
    ds_read_b64_tr_b16 v[52:53], v9 offset:61440
    v_mfma_f32_16x16x32_bf16 v[108:111], v[36:39], a[84:87], v[108:111]
    ds_read_b64_tr_b16 v[54:55], v9 offset:61952
    s_waitcnt lgkmcnt(4)
    v_mfma_f32_16x16x32_bf16 v[96:99], v[40:43], a[24:27], v[96:99]
    ds_read_b64_tr_b16 v[32:33], v10 offset:49152
    v_mfma_f32_16x16x32_bf16 v[104:107], v[40:43], a[88:91], v[104:107]
    ds_read_b64_tr_b16 v[34:35], v10 offset:49664
    v_mfma_f32_16x16x32_bf16 v[100:103], v[44:47], a[24:27], v[100:103]
    ds_read_b64_tr_b16 v[36:37], v11 offset:49152
    v_mfma_f32_16x16x32_bf16 v[108:111], v[44:47], a[88:91], v[108:111]
    ds_read_b64_tr_b16 v[38:39], v11 offset:49664
    s_waitcnt lgkmcnt(4)
    v_mfma_f32_16x16x32_bf16 v[96:99], v[48:51], a[28:31], v[96:99]
    ds_read_b64_tr_b16 v[40:41], v10 offset:53248
    v_mfma_f32_16x16x32_bf16 v[104:107], v[48:51], a[92:95], v[104:107]
    ds_read_b64_tr_b16 v[42:43], v10 offset:53760
    v_mfma_f32_16x16x32_bf16 v[100:103], v[52:55], a[28:31], v[100:103]
    ds_read_b64_tr_b16 v[44:45], v11 offset:53248
    v_mfma_f32_16x16x32_bf16 v[108:111], v[52:55], a[92:95], v[108:111]
    ds_read_b64_tr_b16 v[46:47], v11 offset:53760
    s_waitcnt lgkmcnt(4)
    v_mfma_f32_16x16x32_bf16 v[96:99], v[32:35], a[48:51], v[96:99]
    ds_read_b64_tr_b16 v[48:49], v10 offset:57344
    v_mfma_f32_16x16x32_bf16 v[104:107], v[32:35], a[112:115], v[104:107]
    ds_read_b64_tr_b16 v[50:51], v10 offset:57856
    v_mfma_f32_16x16x32_bf16 v[100:103], v[36:39], a[48:51], v[100:103]
    ds_read_b64_tr_b16 v[52:53], v11 offset:57344
    v_mfma_f32_16x16x32_bf16 v[108:111], v[36:39], a[112:115], v[108:111]
    ds_read_b64_tr_b16 v[54:55], v11 offset:57856
    s_waitcnt lgkmcnt(4)
    v_mfma_f32_16x16x32_bf16 v[96:99], v[40:43], a[52:55], v[96:99]
    ds_read_b64_tr_b16 v[32:33], v10 offset:61440
    v_mfma_f32_16x16x32_bf16 v[104:107], v[40:43], a[116:119], v[104:107]
    ds_read_b64_tr_b16 v[34:35], v10 offset:61952
    v_mfma_f32_16x16x32_bf16 v[100:103], v[44:47], a[52:55], v[100:103]
    ds_read_b64_tr_b16 v[36:37], v11 offset:61440
    v_mfma_f32_16x16x32_bf16 v[108:111], v[44:47], a[116:119], v[108:111]
    ds_read_b64_tr_b16 v[38:39], v11 offset:61952
    s_waitcnt lgkmcnt(4)
    v_mfma_f32_16x16x32_bf16 v[96:99], v[48:51], a[56:59], v[96:99]
    v_mfma_f32_16x16x32_bf16 v[104:107], v[48:51], a[120:123], v[104:107]
    v_mfma_f32_16x16x32_bf16 v[100:103], v[52:55], a[56:59], v[100:103]
    v_mfma_f32_16x16x32_bf16 v[108:111], v[52:55], a[120:123], v[108:111]
    s_waitcnt lgkmcnt(0)
    v_mfma_f32_16x16x32_bf16 v[96:99], v[32:35], a[60:63], v[96:99]
    v_mfma_f32_16x16x32_bf16 v[104:107], v[32:35], a[124:127], v[104:107]
    v_mfma_f32_16x16x32_bf16 v[100:103], v[36:39], a[60:63], v[100:103]
    v_mfma_f32_16x16x32_bf16 v[108:111], v[36:39], a[124:127], v[108:111]
    s_barrier
    s_nop 3
    v_cvt_pk_bf16_f32 v96, v96, v97
    v_cvt_pk_bf16_f32 v97, v98, v99
    v_cvt_pk_bf16_f32 v98, v100, v101
    v_cvt_pk_bf16_f32 v99, v102, v103
    v_cvt_pk_bf16_f32 v100, v104, v105
    v_cvt_pk_bf16_f32 v101, v106, v107
    v_cvt_pk_bf16_f32 v102, v108, v109
    v_cvt_pk_bf16_f32 v103, v110, v111
    s_lshr_b32 s94, s93, 3
    s_add_u32 s94, s94, s89
    s_add_u32 s94, s94, 98304
    v_pk_max_i16 v96, v96, 0
    v_pk_max_i16 v97, v97, 0
    v_pk_max_i16 v98, v98, 0
    v_pk_max_i16 v99, v99, 0
    buffer_store_dwordx4 v[96:99], v16, s[32:35], s94 offen offset:0 sc1
    v_pk_max_i16 v100, v100, 0
    v_pk_max_i16 v101, v101, 0
    v_pk_max_i16 v102, v102, 0
    v_pk_max_i16 v103, v103, 0
    buffer_store_dwordx4 v[100:103], v16, s[32:35], s94 offen offset:1024 sc1
    s_waitcnt vmcnt(2)
    s_lshl_b32 s68, s62, 2
    s_lshl_b32 s68, 4, s68
    s_xor_b32 s3, s75, 0
    s_atomic_or s68, s[52:53], s3
    s_xor_b32 s3, s75, 512
    s_atomic_or s68, s[52:53], s3
    s_xor_b32 s3, s75, 1024
    s_atomic_or s68, s[52:53], s3
    s_xor_b32 s3, s75, 1536
    s_atomic_or s68, s[52:53], s3
    v_lshrrev_b32 v1, 3, v0
    v_lshrrev_b32 v2, 4, v0
    v_lshlrev_b32 v2, 1, v2
    v_and_b32 v4, 7, v0
    v_xor_b32 v4, v4, v2
    v_lshlrev_b32 v4, 4, v4
    v_lshl_add_u32 v4, v1, 10, v4
    v_add_u32 v5, 7168, v4
    v_add_u32 v6, 14336, v4
    v_add_u32 v7, 21504, v4
    s_setprio 0
    s_add_u32 m0, s65, 49152
    s_add_u32 s71, s90, 196608
    buffer_load_dwordx4 v4, s[40:43], s71 offen offset:0 lds
    buffer_load_dwordx4 v5, s[40:43], s71 offen offset:1024 lds
    buffer_load_dwordx4 v6, s[40:43], s71 offen offset:2048 lds
    buffer_load_dwordx4 v7, s[40:43], s71 offen offset:3072 lds
    s_add_u32 m0, s79, 151568
    s_mov_b64 exec, 1
    buffer_load_dword v16, s[44:47], s46 offen lds
    s_mov_b64 exec, -1
    s_add_u32 m0, s65, 65536
    s_add_u32 s71, s90, 262144
    buffer_load_dwordx4 v4, s[40:43], s71 offen offset:0 lds
    buffer_load_dwordx4 v5, s[40:43], s71 offen offset:1024 lds
    buffer_load_dwordx4 v6, s[40:43], s71 offen offset:2048 lds
    buffer_load_dwordx4 v7, s[40:43], s71 offen offset:3072 lds
    s_add_u32 m0, s79, 151584
    s_mov_b64 exec, 1
    buffer_load_dword v16, s[44:47], s46 offen lds
    s_mov_b64 exec, -1
    s_waitcnt vmcnt(10)
    s_lshl_b32 s68, s62, 2
    s_lshl_b32 s68, 8, s68
    s_xor_b32 s3, s75, 0
    s_atomic_or s68, s[52:53], s3
    s_xor_b32 s3, s75, 512
    s_atomic_or s68, s[52:53], s3
    s_xor_b32 s3, s75, 1024
    s_atomic_or s68, s[52:53], s3
    s_xor_b32 s3, s75, 1536
    s_atomic_or s68, s[52:53], s3
    s_waitcnt vmcnt(5)
    s_add_u32 m0, s65, 81920
    s_add_u32 s71, s90, 327680
    buffer_load_dwordx4 v4, s[40:43], s71 offen offset:0 lds
    buffer_load_dwordx4 v5, s[40:43], s71 offen offset:1024 lds
    buffer_load_dwordx4 v6, s[40:43], s71 offen offset:2048 lds
    buffer_load_dwordx4 v7, s[40:43], s71 offen offset:3072 lds
    s_waitcnt vmcnt(5)
    s_add_u32 m0, s65, 98304
    s_add_u32 s71, s90, 393216
    buffer_load_dwordx4 v4, s[40:43], s71 offen offset:0 lds
    buffer_load_dwordx4 v5, s[40:43], s71 offen offset:1024 lds
    buffer_load_dwordx4 v6, s[40:43], s71 offen offset:2048 lds
    buffer_load_dwordx4 v7, s[40:43], s71 offen offset:3072 lds
    s_add_u32 m0, s79, 151600
    s_mov_b64 exec, 1
    buffer_load_dword v16, s[44:47], s46 offen lds
    s_mov_b64 exec, -1
    s_waitcnt vmcnt(5)
    s_add_u32 m0, s65, 131072
    s_xor_b32 s71, s93, 0
    s_add_u32 s71, s71, s91
    buffer_load_dwordx4 v4, s[44:47], s71 offen offset:0 lds
    buffer_load_dwordx4 v5, s[44:47], s71 offen offset:1024 lds
    buffer_load_dwordx4 v6, s[44:47], s71 offen offset:2048 lds
    buffer_load_dwordx4 v7, s[44:47], s71 offen offset:3072 lds
    s_waitcnt vmcnt(5)
    s_add_u32 m0, s65, 114688
    s_xor_b32 s71, s93, 65536
    s_add_u32 s71, s71, s91
    buffer_load_dwordx4 v4, s[44:47], s71 offen offset:0 lds
    buffer_load_dwordx4 v5, s[44:47], s71 offen offset:1024 lds
    buffer_load_dwordx4 v6, s[44:47], s71 offen offset:2048 lds
    buffer_load_dwordx4 v7, s[44:47], s71 offen offset:3072 lds
    s_add_u32 m0, s79, 151616
    s_mov_b64 exec, 1
    buffer_load_dword v16, s[44:47], s46 offen lds
    s_mov_b64 exec, -1
    s_waitcnt vmcnt(0) lgkmcnt(0)
    s_endpgm
L_c_att:
    v_xor_b32 v38, 8, v33
    v_and_b32 v39, 8, v38
    v_add_u32 v39, v39, v38
    v_lshlrev_b32 v39, 7, v39
    v_lshrrev_b32 v38, 1, v38
    v_xor_b32 v38, v38, v32
    v_lshl_add_u32 v39, v38, 4, v39
    v_add_u32 v39, s65, v39
    v_add_u32 v12, 0, v39
    v_xor_b32 v13, 64, v12
    v_xor_b32 v38, 0, v33
    v_and_b32 v39, 8, v38
    v_add_u32 v39, v39, v38
    v_lshlrev_b32 v39, 7, v39
    v_lshrrev_b32 v38, 1, v38
    v_xor_b32 v38, v38, v32
    v_lshl_add_u32 v39, v38, 4, v39
    v_add_u32 v39, s65, v39
    v_add_u32 v15, 1024, v39
    v_xor_b32 v14, 64, v15
    v_lshl_add_u32 v38, v32, 3, v34
    v_lshlrev_b32 v38, 7, v38
    v_lshl_add_u32 v38, v35, 3, v38
    v_lshrrev_b32 v39, 1, v34
    v_and_b32 v40, 1, v32
    v_lshl_or_b32 v39, v40, 1, v39
    v_xor_b32 v41, s60, v39
    v_xor_b32 v40, 0, v41
    v_lshl_add_u32 v4, v40, 5, v38
    v_add_u32 v8, 0x10000, v4
    v_xor_b32 v40, 1, v41
    v_lshl_add_u32 v5, v40, 5, v38
    v_add_u32 v9, 0x10000, v5
    v_xor_b32 v40, 2, v41
    v_lshl_add_u32 v6, v40, 5, v38
    v_add_u32 v10, 0x10000, v6
    v_xor_b32 v40, 3, v41
    v_lshl_add_u32 v7, v40, 5, v38
    v_add_u32 v11, 0x10000, v7
    v_lshrrev_b32 v38, 1, v33
    v_xor_b32 v38, v38, v32
    v_lshlrev_b32 v38, 4, v38
    v_lshl_add_u32 v38, v33, 7, v38
    v_add_u32 v18, 114688, v38
    v_xor_b32 v19, 64, v18
    s_mul_i32 s3, s60, 5120
    s_add_u32 s3, s3, 135168
    v_add_u32 v3, s3, v16
    s_cmp_eq_u32 s60, 0
    s_cbranch_scc0 L_ci72
    s_mov_b32 s67, 1
    s_waitcnt lgkmcnt(0)
    s_atomic_add s67, s[54:55], 0
L_ci72:
    s_waitcnt vmcnt(0)
    s_barrier
    ds_read_b64_tr_b16 v[32:33], v4 offset:0
    ds_read_b64_tr_b16 v[34:35], v4 offset:512
    v_add_u32 v1, 65536, v12
    ds_read_b128 a[0:3], v1 offset:16384
    v_add_u32 v2, 65536, v14
    ds_read_b128 a[64:67], v2 offset:16384
    ds_read_b128 v[24:27], v18 offset:0
    ds_read_b64_tr_b16 v[36:37], v5 offset:0
    ds_read_b64_tr_b16 v[38:39], v5 offset:512
    ds_read_b64_tr_b16 v[40:41], v4 offset:4096
    ds_read_b64_tr_b16 v[42:43], v4 offset:4608
    v_add_u32 v1, 65536, v13
    ds_read_b128 a[4:7], v1 offset:16384
    v_add_u32 v2, 65536, v15
    ds_read_b128 a[68:71], v2 offset:16384
    ds_read_b128 v[56:59], v19 offset:0
    ds_read_b64_tr_b16 v[44:45], v5 offset:4096
    ds_read_b64_tr_b16 v[46:47], v5 offset:4608
    s_waitcnt lgkmcnt(7)
    v_mfma_f32_16x16x32_bf16 v[64:67], v[32:35], a[0:3], 0
    ds_read_b64_tr_b16 v[48:49], v4 offset:8192
    v_mfma_f32_16x16x32_bf16 v[68:71], v[32:35], a[64:67], 0
    ds_read_b64_tr_b16 v[50:51], v4 offset:8704
    v_add_u32 v1, 65536, v12
    ds_read_b128 a[8:11], v1 offset:32768
    v_add_u32 v2, 65536, v14
    ds_read_b128 a[72:75], v2 offset:32768
    ds_read_b128 v[60:63], v18 offset:2048
    v_mfma_f32_16x16x32_bf16 v[28:31], v[32:35], v[24:27], 0
    v_mfma_f32_16x16x32_bf16 v[72:75], v[36:39], a[0:3], 0
    ds_read_b64_tr_b16 v[52:53], v5 offset:8192
    v_mfma_f32_16x16x32_bf16 v[76:79], v[36:39], a[64:67], 0
    ds_read_b64_tr_b16 v[54:55], v5 offset:8704
    s_waitcnt lgkmcnt(7)
    v_mfma_f32_16x16x32_bf16 v[64:67], v[40:43], a[4:7], v[64:67]
    ds_read_b64_tr_b16 v[32:33], v4 offset:12288
    v_mfma_f32_16x16x32_bf16 v[68:71], v[40:43], a[68:71], v[68:71]
    ds_read_b64_tr_b16 v[34:35], v4 offset:12800
    v_add_u32 v1, 65536, v13
    ds_read_b128 a[12:15], v1 offset:32768
    v_add_u32 v2, 65536, v15
    ds_read_b128 a[76:79], v2 offset:32768
    ds_read_b128 v[24:27], v19 offset:2048
    v_mfma_f32_16x16x32_bf16 v[28:31], v[40:43], v[56:59], v[28:31]
    v_mfma_f32_16x16x32_bf16 v[72:75], v[44:47], a[4:7], v[72:75]
    ds_read_b64_tr_b16 v[36:37], v5 offset:12288
    v_mfma_f32_16x16x32_bf16 v[76:79], v[44:47], a[68:71], v[76:79]
    ds_read_b64_tr_b16 v[38:39], v5 offset:12800
    s_waitcnt lgkmcnt(7)
    v_mfma_f32_16x16x32_bf16 v[64:67], v[48:51], a[8:11], v[64:67]
    ds_read_b64_tr_b16 v[40:41], v6 offset:0
    v_mfma_f32_16x16x32_bf16 v[68:71], v[48:51], a[72:75], v[68:71]
    ds_read_b64_tr_b16 v[42:43], v6 offset:512
    v_mfma_f32_16x16x32_bf16 v[28:31], v[48:51], v[60:63], v[28:31]
    v_mfma_f32_16x16x32_bf16 v[72:75], v[52:55], a[8:11], v[72:75]
    ds_read_b64_tr_b16 v[44:45], v7 offset:0
    v_mfma_f32_16x16x32_bf16 v[76:79], v[52:55], a[72:75], v[76:79]
    ds_read_b64_tr_b16 v[46:47], v7 offset:512
    s_waitcnt lgkmcnt(4)
    v_mfma_f32_16x16x32_bf16 v[64:67], v[32:35], a[12:15], v[64:67]
    ds_read_b64_tr_b16 v[48:49], v6 offset:4096
    v_mfma_f32_16x16x32_bf16 v[68:71], v[32:35], a[76:79], v[68:71]
    ds_read_b64_tr_b16 v[50:51], v6 offset:4608
    v_mfma_f32_16x16x32_bf16 v[28:31], v[32:35], v[24:27], v[28:31]
    v_mfma_f32_16x16x32_bf16 v[72:75], v[36:39], a[12:15], v[72:75]
    ds_read_b64_tr_b16 v[52:53], v7 offset:4096
    v_mfma_f32_16x16x32_bf16 v[76:79], v[36:39], a[76:79], v[76:79]
    ds_read_b64_tr_b16 v[54:55], v7 offset:4608
    s_waitcnt lgkmcnt(4)
    v_mfma_f32_16x16x32_bf16 v[80:83], v[40:43], a[0:3], 0
    ds_read_b64_tr_b16 v[32:33], v6 offset:8192
    v_mfma_f32_16x16x32_bf16 v[84:87], v[40:43], a[64:67], 0
    ds_read_b64_tr_b16 v[34:35], v6 offset:8704
    v_mfma_f32_16x16x32_bf16 v[88:91], v[44:47], a[0:3], 0
    ds_read_b64_tr_b16 v[36:37], v7 offset:8192
    v_mfma_f32_16x16x32_bf16 v[92:95], v[44:47], a[64:67], 0
    ds_read_b64_tr_b16 v[38:39], v7 offset:8704
    s_waitcnt lgkmcnt(4)
    v_mfma_f32_16x16x32_bf16 v[80:83], v[48:51], a[4:7], v[80:83]
    ds_read_b64_tr_b16 v[40:41], v6 offset:12288
    v_mfma_f32_16x16x32_bf16 v[84:87], v[48:51], a[68:71], v[84:87]
    ds_read_b64_tr_b16 v[42:43], v6 offset:12800
    v_mfma_f32_16x16x32_bf16 v[88:91], v[52:55], a[4:7], v[88:91]
    ds_read_b64_tr_b16 v[44:45], v7 offset:12288
    v_mfma_f32_16x16x32_bf16 v[92:95], v[52:55], a[68:71], v[92:95]
    ds_read_b64_tr_b16 v[46:47], v7 offset:12800
    s_waitcnt lgkmcnt(4)
    v_mfma_f32_16x16x32_bf16 v[80:83], v[32:35], a[8:11], v[80:83]
    v_add_u32 v8, 0x10000, v8
    v_add_u32 v9, 0x10000, v9
    v_add_u32 v10, 0x10000, v10
    v_add_u32 v11, 0x10000, v11
    s_barrier
    ds_read_b64_tr_b16 v[48:49], v8 offset:0
    v_mfma_f32_16x16x32_bf16 v[84:87], v[32:35], a[72:75], v[84:87]
    ds_read_b64_tr_b16 v[50:51], v8 offset:512
    v_mfma_f32_16x16x32_bf16 v[88:91], v[36:39], a[8:11], v[88:91]
    ds_read_b64_tr_b16 v[52:53], v9 offset:0
    v_mfma_f32_16x16x32_bf16 v[92:95], v[36:39], a[72:75], v[92:95]
    ds_read_b64_tr_b16 v[54:55], v9 offset:512
    s_waitcnt lgkmcnt(4)
    v_mfma_f32_16x16x32_bf16 v[80:83], v[40:43], a[12:15], v[80:83]
    ds_read_b64_tr_b16 v[32:33], v8 offset:4096
    v_mfma_f32_16x16x32_bf16 v[84:87], v[40:43], a[76:79], v[84:87]
    ds_read_b64_tr_b16 v[34:35], v8 offset:4608
    v_mfma_f32_16x16x32_bf16 v[88:91], v[44:47], a[12:15], v[88:91]
    ds_read_b64_tr_b16 v[36:37], v9 offset:4096
    v_mfma_f32_16x16x32_bf16 v[92:95], v[44:47], a[76:79], v[92:95]
    ds_read_b64_tr_b16 v[38:39], v9 offset:4608
    s_waitcnt lgkmcnt(4)
    v_mfma_f32_16x16x32_bf16 v[96:99], v[48:51], a[0:3], 0
    ds_read_b64_tr_b16 v[40:41], v8 offset:8192
    v_mfma_f32_16x16x32_bf16 v[100:103], v[48:51], a[64:67], 0
    ds_read_b64_tr_b16 v[42:43], v8 offset:8704
    v_mfma_f32_16x16x32_bf16 v[104:107], v[52:55], a[0:3], 0
    ds_read_b64_tr_b16 v[44:45], v9 offset:8192
    v_mfma_f32_16x16x32_bf16 v[108:111], v[52:55], a[64:67], 0
    ds_read_b64_tr_b16 v[46:47], v9 offset:8704
    s_waitcnt lgkmcnt(4)
    v_mfma_f32_16x16x32_bf16 v[96:99], v[32:35], a[4:7], v[96:99]
    ds_read_b64_tr_b16 v[48:49], v8 offset:12288
    v_mfma_f32_16x16x32_bf16 v[100:103], v[32:35], a[68:71], v[100:103]
    ds_read_b64_tr_b16 v[50:51], v8 offset:12800
    v_mfma_f32_16x16x32_bf16 v[104:107], v[36:39], a[4:7], v[104:107]
    ds_read_b64_tr_b16 v[52:53], v9 offset:12288
    v_mfma_f32_16x16x32_bf16 v[108:111], v[36:39], a[68:71], v[108:111]
    ds_read_b64_tr_b16 v[54:55], v9 offset:12800
    s_waitcnt lgkmcnt(4)
    v_mfma_f32_16x16x32_bf16 v[96:99], v[40:43], a[8:11], v[96:99]
    ds_read_b64_tr_b16 v[32:33], v10 offset:0
    v_mfma_f32_16x16x32_bf16 v[100:103], v[40:43], a[72:75], v[100:103]
    ds_read_b64_tr_b16 v[34:35], v10 offset:512
    v_mfma_f32_16x16x32_bf16 v[104:107], v[44:47], a[8:11], v[104:107]
    ds_read_b64_tr_b16 v[36:37], v11 offset:0
    v_mfma_f32_16x16x32_bf16 v[108:111], v[44:47], a[72:75], v[108:111]
    ds_read_b64_tr_b16 v[38:39], v11 offset:512
    s_waitcnt lgkmcnt(4)
    v_mfma_f32_16x16x32_bf16 v[96:99], v[48:51], a[12:15], v[96:99]
    ds_read_b64_tr_b16 v[40:41], v10 offset:4096
    v_mfma_f32_16x16x32_bf16 v[100:103], v[48:51], a[76:79], v[100:103]
    ds_read_b64_tr_b16 v[42:43], v10 offset:4608
    v_mfma_f32_16x16x32_bf16 v[104:107], v[52:55], a[12:15], v[104:107]
    ds_read_b64_tr_b16 v[44:45], v11 offset:4096
    v_mfma_f32_16x16x32_bf16 v[108:111], v[52:55], a[76:79], v[108:111]
    ds_read_b64_tr_b16 v[46:47], v11 offset:4608
    s_waitcnt lgkmcnt(4)
    v_mfma_f32_16x16x32_bf16 v[112:115], v[32:35], a[0:3], 0
    ds_read_b64_tr_b16 v[48:49], v10 offset:8192
    v_mfma_f32_16x16x32_bf16 v[116:119], v[32:35], a[64:67], 0
    ds_read_b64_tr_b16 v[50:51], v10 offset:8704
    v_mfma_f32_16x16x32_bf16 v[120:123], v[36:39], a[0:3], 0
    ds_read_b64_tr_b16 v[52:53], v11 offset:8192
    v_mfma_f32_16x16x32_bf16 v[124:127], v[36:39], a[64:67], 0
    ds_read_b64_tr_b16 v[54:55], v11 offset:8704
    s_waitcnt lgkmcnt(4)
    v_mfma_f32_16x16x32_bf16 v[112:115], v[40:43], a[4:7], v[112:115]
    ds_read_b64_tr_b16 v[32:33], v10 offset:12288
    v_mfma_f32_16x16x32_bf16 v[116:119], v[40:43], a[68:71], v[116:119]
    ds_read_b64_tr_b16 v[34:35], v10 offset:12800
    v_mfma_f32_16x16x32_bf16 v[120:123], v[44:47], a[4:7], v[120:123]
    ds_read_b64_tr_b16 v[36:37], v11 offset:12288
    v_mfma_f32_16x16x32_bf16 v[124:127], v[44:47], a[68:71], v[124:127]
    ds_read_b64_tr_b16 v[38:39], v11 offset:12800
    s_waitcnt lgkmcnt(4)
    v_mfma_f32_16x16x32_bf16 v[112:115], v[48:51], a[8:11], v[112:115]
    v_subrev_u32 v8, 0x10000, v8
    v_subrev_u32 v9, 0x10000, v9
    v_subrev_u32 v10, 0x10000, v10
    v_subrev_u32 v11, 0x10000, v11
    s_barrier
    ds_read_b64_tr_b16 v[40:41], v4 offset:32768
    v_mfma_f32_16x16x32_bf16 v[116:119], v[48:51], a[72:75], v[116:119]
    ds_read_b64_tr_b16 v[42:43], v4 offset:33280
    v_add_u32 v1, 131072, v12
    ds_read_b128 a[16:19], v1 offset:16384
    v_add_u32 v2, 131072, v14
    ds_read_b128 a[80:83], v2 offset:16384
    ds_read_b128 v[56:59], v18 offset:4096
    v_mfma_f32_16x16x32_bf16 v[120:123], v[52:55], a[8:11], v[120:123]
    ds_read_b64_tr_b16 v[44:45], v5 offset:32768
    v_mfma_f32_16x16x32_bf16 v[124:127], v[52:55], a[72:75], v[124:127]
    ds_read_b64_tr_b16 v[46:47], v5 offset:33280
    s_waitcnt lgkmcnt(7)
    v_mfma_f32_16x16x32_bf16 v[112:115], v[32:35], a[12:15], v[112:115]
    ds_read_b64_tr_b16 v[48:49], v4 offset:36864
    v_mfma_f32_16x16x32_bf16 v[116:119], v[32:35], a[76:79], v[116:119]
    ds_read_b64_tr_b16 v[50:51], v4 offset:37376
    v_add_u32 v1, 131072, v13
    ds_read_b128 a[20:23], v1 offset:16384
    v_add_u32 v2, 131072, v15
    ds_read_b128 a[84:87], v2 offset:16384
    ds_read_b128 v[60:63], v19 offset:4096
    v_mfma_f32_16x16x32_bf16 v[120:123], v[36:39], a[12:15], v[120:123]
    ds_read_b64_tr_b16 v[52:53], v5 offset:36864
    v_mfma_f32_16x16x32_bf16 v[124:127], v[36:39], a[76:79], v[124:127]
    ds_read_b64_tr_b16 v[54:55], v5 offset:37376
    s_waitcnt lgkmcnt(7)
    v_mfma_f32_16x16x32_bf16 v[64:67], v[40:43], a[16:19], v[64:67]
    ds_read_b64_tr_b16 v[32:33], v4 offset:40960
    v_mfma_f32_16x16x32_bf16 v[68:71], v[40:43], a[80:83], v[68:71]
    ds_read_b64_tr_b16 v[34:35], v4 offset:41472
    ds_read_b128 a[24:27], v12 offset:16384
    ds_read_b128 a[88:91], v14 offset:16384
    ds_read_b128 v[24:27], v18 offset:6144
    v_mfma_f32_16x16x32_bf16 v[28:31], v[40:43], v[56:59], v[28:31]
    v_mfma_f32_16x16x32_bf16 v[72:75], v[44:47], a[16:19], v[72:75]
    ds_read_b64_tr_b16 v[36:37], v5 offset:40960
    v_mfma_f32_16x16x32_bf16 v[76:79], v[44:47], a[80:83], v[76:79]
    ds_read_b64_tr_b16 v[38:39], v5 offset:41472
    s_waitcnt lgkmcnt(7)
    v_mfma_f32_16x16x32_bf16 v[64:67], v[48:51], a[20:23], v[64:67]
    ds_read_b64_tr_b16 v[40:41], v4 offset:45056
    v_mfma_f32_16x16x32_bf16 v[68:71], v[48:51], a[84:87], v[68:71]
    ds_read_b64_tr_b16 v[42:43], v4 offset:45568
    ds_read_b128 a[28:31], v13 offset:16384
    ds_read_b128 a[92:95], v15 offset:16384
    ds_read_b128 v[56:59], v19 offset:6144
    v_mfma_f32_16x16x32_bf16 v[28:31], v[48:51], v[60:63], v[28:31]
    v_mfma_f32_16x16x32_bf16 v[72:75], v[52:55], a[20:23], v[72:75]
    ds_read_b64_tr_b16 v[44:45], v5 offset:45056
    v_mfma_f32_16x16x32_bf16 v[76:79], v[52:55], a[84:87], v[76:79]
    ds_read_b64_tr_b16 v[46:47], v5 offset:45568
    s_waitcnt lgkmcnt(7)
    v_mfma_f32_16x16x32_bf16 v[64:67], v[32:35], a[24:27], v[64:67]
    ds_read_b64_tr_b16 v[48:49], v6 offset:32768
    v_mfma_f32_16x16x32_bf16 v[68:71], v[32:35], a[88:91], v[68:71]
    ds_read_b64_tr_b16 v[50:51], v6 offset:33280
    v_mfma_f32_16x16x32_bf16 v[28:31], v[32:35], v[24:27], v[28:31]
    v_mfma_f32_16x16x32_bf16 v[72:75], v[36:39], a[24:27], v[72:75]
    ds_read_b64_tr_b16 v[52:53], v7 offset:32768
    v_mfma_f32_16x16x32_bf16 v[76:79], v[36:39], a[88:91], v[76:79]
    ds_read_b64_tr_b16 v[54:55], v7 offset:33280
    s_waitcnt lgkmcnt(4)
    v_mfma_f32_16x16x32_bf16 v[64:67], v[40:43], a[28:31], v[64:67]
    ds_read_b64_tr_b16 v[32:33], v6 offset:36864
    v_mfma_f32_16x16x32_bf16 v[68:71], v[40:43], a[92:95], v[68:71]
    ds_read_b64_tr_b16 v[34:35], v6 offset:37376
    v_mfma_f32_16x16x32_bf16 v[28:31], v[40:43], v[56:59], v[28:31]
    v_mfma_f32_16x16x32_bf16 v[72:75], v[44:47], a[28:31], v[72:75]
    ds_read_b64_tr_b16 v[36:37], v7 offset:36864
    v_mfma_f32_16x16x32_bf16 v[76:79], v[44:47], a[92:95], v[76:79]
    ds_read_b64_tr_b16 v[38:39], v7 offset:37376
    s_waitcnt lgkmcnt(4)
    v_mfma_f32_16x16x32_bf16 v[80:83], v[48:51], a[16:19], v[80:83]
    ds_read_b64_tr_b16 v[40:41], v6 offset:40960
    v_mfma_f32_16x16x32_bf16 v[84:87], v[48:51], a[80:83], v[84:87]
    ds_read_b64_tr_b16 v[42:43], v6 offset:41472
    v_mfma_f32_16x16x32_bf16 v[88:91], v[52:55], a[16:19], v[88:91]
    ds_read_b64_tr_b16 v[44:45], v7 offset:40960
    v_mfma_f32_16x16x32_bf16 v[92:95], v[52:55], a[80:83], v[92:95]
    ds_read_b64_tr_b16 v[46:47], v7 offset:41472
    s_waitcnt lgkmcnt(4)
    v_mfma_f32_16x16x32_bf16 v[80:83], v[32:35], a[20:23], v[80:83]
    ds_read_b64_tr_b16 v[48:49], v6 offset:45056
    v_mfma_f32_16x16x32_bf16 v[84:87], v[32:35], a[84:87], v[84:87]
    ds_read_b64_tr_b16 v[50:51], v6 offset:45568
    v_mfma_f32_16x16x32_bf16 v[88:91], v[36:39], a[20:23], v[88:91]
    ds_read_b64_tr_b16 v[52:53], v7 offset:45056
    v_mfma_f32_16x16x32_bf16 v[92:95], v[36:39], a[84:87], v[92:95]
    ds_read_b64_tr_b16 v[54:55], v7 offset:45568
    s_waitcnt lgkmcnt(4)
    v_mfma_f32_16x16x32_bf16 v[80:83], v[40:43], a[24:27], v[80:83]
    s_barrier
    ds_read_b64_tr_b16 v[32:33], v4 offset:49152
    v_mfma_f32_16x16x32_bf16 v[84:87], v[40:43], a[88:91], v[84:87]
    ds_read_b64_tr_b16 v[34:35], v4 offset:49664
    v_mfma_f32_16x16x32_bf16 v[88:91], v[44:47], a[24:27], v[88:91]
    ds_read_b64_tr_b16 v[36:37], v5 offset:49152
    v_mfma_f32_16x16x32_bf16 v[92:95], v[44:47], a[88:91], v[92:95]
    ds_read_b64_tr_b16 v[38:39], v5 offset:49664
    s_waitcnt lgkmcnt(4)
    v_mfma_f32_16x16x32_bf16 v[80:83], v[48:51], a[28:31], v[80:83]
    ds_read_b64_tr_b16 v[40:41], v4 offset:53248
    v_mfma_f32_16x16x32_bf16 v[84:87], v[48:51], a[92:95], v[84:87]
    ds_read_b64_tr_b16 v[42:43], v4 offset:53760
    v_mfma_f32_16x16x32_bf16 v[88:91], v[52:55], a[28:31], v[88:91]
    ds_read_b64_tr_b16 v[44:45], v5 offset:53248
    v_mfma_f32_16x16x32_bf16 v[92:95], v[52:55], a[92:95], v[92:95]
    ds_read_b64_tr_b16 v[46:47], v5 offset:53760
    s_waitcnt lgkmcnt(4)
    v_mfma_f32_16x16x32_bf16 v[96:99], v[32:35], a[16:19], v[96:99]
    ds_read_b64_tr_b16 v[48:49], v4 offset:57344
    v_mfma_f32_16x16x32_bf16 v[100:103], v[32:35], a[80:83], v[100:103]
    ds_read_b64_tr_b16 v[50:51], v4 offset:57856
    v_mfma_f32_16x16x32_bf16 v[104:107], v[36:39], a[16:19], v[104:107]
    ds_read_b64_tr_b16 v[52:53], v5 offset:57344
    v_mfma_f32_16x16x32_bf16 v[108:111], v[36:39], a[80:83], v[108:111]
    ds_read_b64_tr_b16 v[54:55], v5 offset:57856
    s_waitcnt lgkmcnt(4)
    v_mfma_f32_16x16x32_bf16 v[96:99], v[40:43], a[20:23], v[96:99]
    ds_read_b64_tr_b16 v[32:33], v4 offset:61440
    v_mfma_f32_16x16x32_bf16 v[100:103], v[40:43], a[84:87], v[100:103]
    ds_read_b64_tr_b16 v[34:35], v4 offset:61952
    v_mfma_f32_16x16x32_bf16 v[104:107], v[44:47], a[20:23], v[104:107]
    ds_read_b64_tr_b16 v[36:37], v5 offset:61440
    v_mfma_f32_16x16x32_bf16 v[108:111], v[44:47], a[84:87], v[108:111]
    ds_read_b64_tr_b16 v[38:39], v5 offset:61952
    s_waitcnt lgkmcnt(4)
    v_mfma_f32_16x16x32_bf16 v[96:99], v[48:51], a[24:27], v[96:99]
    ds_read_b64_tr_b16 v[40:41], v6 offset:49152
    v_mfma_f32_16x16x32_bf16 v[100:103], v[48:51], a[88:91], v[100:103]
    ds_read_b64_tr_b16 v[42:43], v6 offset:49664
    v_mfma_f32_16x16x32_bf16 v[104:107], v[52:55], a[24:27], v[104:107]
    ds_read_b64_tr_b16 v[44:45], v7 offset:49152
    v_mfma_f32_16x16x32_bf16 v[108:111], v[52:55], a[88:91], v[108:111]
    ds_read_b64_tr_b16 v[46:47], v7 offset:49664
    s_waitcnt lgkmcnt(4)
    v_mfma_f32_16x16x32_bf16 v[96:99], v[32:35], a[28:31], v[96:99]
    ds_read_b64_tr_b16 v[48:49], v6 offset:53248
    v_mfma_f32_16x16x32_bf16 v[100:103], v[32:35], a[92:95], v[100:103]
    ds_read_b64_tr_b16 v[50:51], v6 offset:53760
    v_mfma_f32_16x16x32_bf16 v[104:107], v[36:39], a[28:31], v[104:107]
    ds_read_b64_tr_b16 v[52:53], v7 offset:53248
    v_mfma_f32_16x16x32_bf16 v[108:111], v[36:39], a[92:95], v[108:111]
    ds_read_b64_tr_b16 v[54:55], v7 offset:53760
    s_waitcnt lgkmcnt(4)
    v_mfma_f32_16x16x32_bf16 v[112:115], v[40:43], a[16:19], v[112:115]
    ds_read_b64_tr_b16 v[32:33], v6 offset:57344
    v_mfma_f32_16x16x32_bf16 v[116:119], v[40:43], a[80:83], v[116:119]
    ds_read_b64_tr_b16 v[34:35], v6 offset:57856
    v_mfma_f32_16x16x32_bf16 v[120:123], v[44:47], a[16:19], v[120:123]
    ds_read_b64_tr_b16 v[36:37], v7 offset:57344
    v_mfma_f32_16x16x32_bf16 v[124:127], v[44:47], a[80:83], v[124:127]
    ds_read_b64_tr_b16 v[38:39], v7 offset:57856
    s_waitcnt lgkmcnt(4)
    v_mfma_f32_16x16x32_bf16 v[112:115], v[48:51], a[20:23], v[112:115]
    ds_read_b64_tr_b16 v[40:41], v6 offset:61440
    v_mfma_f32_16x16x32_bf16 v[116:119], v[48:51], a[84:87], v[116:119]
    ds_read_b64_tr_b16 v[42:43], v6 offset:61952
    v_mfma_f32_16x16x32_bf16 v[120:123], v[52:55], a[20:23], v[120:123]
    ds_read_b64_tr_b16 v[44:45], v7 offset:61440
    v_mfma_f32_16x16x32_bf16 v[124:127], v[52:55], a[84:87], v[124:127]
    ds_read_b64_tr_b16 v[46:47], v7 offset:61952
    s_waitcnt lgkmcnt(4)
    v_mfma_f32_16x16x32_bf16 v[112:115], v[32:35], a[24:27], v[112:115]
    s_barrier
    ds_read_b64_tr_b16 v[48:49], v8 offset:32768
    v_mfma_f32_16x16x32_bf16 v[116:119], v[32:35], a[88:91], v[116:119]
    ds_read_b64_tr_b16 v[50:51], v8 offset:33280
    v_add_u32 v1, 65536, v12
    ds_read_b128 a[32:35], v1 offset:0
    v_add_u32 v2, 65536, v14
    ds_read_b128 a[96:99], v2 offset:0
    ds_read_b128 v[60:63], v18 offset:8192
    v_mfma_f32_16x16x32_bf16 v[120:123], v[36:39], a[24:27], v[120:123]
    ds_read_b64_tr_b16 v[52:53], v9 offset:32768
    v_mfma_f32_16x16x32_bf16 v[124:127], v[36:39], a[88:91], v[124:127]
    ds_read_b64_tr_b16 v[54:55], v9 offset:33280
    s_waitcnt lgkmcnt(7)
    v_mfma_f32_16x16x32_bf16 v[112:115], v[40:43], a[28:31], v[112:115]
    ds_read_b64_tr_b16 v[32:33], v8 offset:36864
    v_mfma_f32_16x16x32_bf16 v[116:119], v[40:43], a[92:95], v[116:119]
    ds_read_b64_tr_b16 v[34:35], v8 offset:37376
    v_add_u32 v1, 65536, v13
    ds_read_b128 a[36:39], v1 offset:0
    v_add_u32 v2, 65536, v15
    ds_read_b128 a[100:103], v2 offset:0
    ds_read_b128 v[24:27], v19 offset:8192
    v_mfma_f32_16x16x32_bf16 v[120:123], v[44:47], a[28:31], v[120:123]
    ds_read_b64_tr_b16 v[36:37], v9 offset:36864
    v_mfma_f32_16x16x32_bf16 v[124:127], v[44:47], a[92:95], v[124:127]
    ds_read_b64_tr_b16 v[38:39], v9 offset:37376
    s_waitcnt lgkmcnt(7)
    v_mfma_f32_16x16x32_bf16 v[64:67], v[48:51], a[32:35], v[64:67]
    ds_read_b64_tr_b16 v[40:41], v8 offset:40960
    v_mfma_f32_16x16x32_bf16 v[68:71], v[48:51], a[96:99], v[68:71]
    ds_read_b64_tr_b16 v[42:43], v8 offset:41472
    v_add_u32 v1, 65536, v12
    ds_read_b128 a[40:43], v1 offset:16384
    v_add_u32 v2, 65536, v14
    ds_read_b128 a[104:107], v2 offset:16384
    ds_read_b128 v[56:59], v18 offset:10240
    v_mfma_f32_16x16x32_bf16 v[28:31], v[48:51], v[60:63], v[28:31]
    v_mfma_f32_16x16x32_bf16 v[72:75], v[52:55], a[32:35], v[72:75]
    ds_read_b64_tr_b16 v[44:45], v9 offset:40960
    v_mfma_f32_16x16x32_bf16 v[76:79], v[52:55], a[96:99], v[76:79]
    ds_read_b64_tr_b16 v[46:47], v9 offset:41472
    s_waitcnt lgkmcnt(7)
    v_mfma_f32_16x16x32_bf16 v[64:67], v[32:35], a[36:39], v[64:67]
    ds_read_b64_tr_b16 v[48:49], v8 offset:45056
    v_mfma_f32_16x16x32_bf16 v[68:71], v[32:35], a[100:103], v[68:71]
    ds_read_b64_tr_b16 v[50:51], v8 offset:45568
    v_add_u32 v1, 65536, v13
    ds_read_b128 a[44:47], v1 offset:16384
    v_add_u32 v2, 65536, v15
    ds_read_b128 a[108:111], v2 offset:16384
    ds_read_b128 v[60:63], v19 offset:10240
    v_mfma_f32_16x16x32_bf16 v[28:31], v[32:35], v[24:27], v[28:31]
    v_mfma_f32_16x16x32_bf16 v[72:75], v[36:39], a[36:39], v[72:75]
    ds_read_b64_tr_b16 v[52:53], v9 offset:45056
    v_mfma_f32_16x16x32_bf16 v[76:79], v[36:39], a[100:103], v[76:79]
    ds_read_b64_tr_b16 v[54:55], v9 offset:45568
    s_waitcnt lgkmcnt(7)
    v_mfma_f32_16x16x32_bf16 v[64:67], v[40:43], a[40:43], v[64:67]
    ds_read_b64_tr_b16 v[32:33], v10 offset:32768
    v_mfma_f32_16x16x32_bf16 v[68:71], v[40:43], a[104:107], v[68:71]
    ds_read_b64_tr_b16 v[34:35], v10 offset:33280
    v_mfma_f32_16x16x32_bf16 v[28:31], v[40:43], v[56:59], v[28:31]
    v_mfma_f32_16x16x32_bf16 v[72:75], v[44:47], a[40:43], v[72:75]
    ds_read_b64_tr_b16 v[36:37], v11 offset:32768
    v_mfma_f32_16x16x32_bf16 v[76:79], v[44:47], a[104:107], v[76:79]
    ds_read_b64_tr_b16 v[38:39], v11 offset:33280
    s_waitcnt lgkmcnt(4)
    v_mfma_f32_16x16x32_bf16 v[64:67], v[48:51], a[44:47], v[64:67]
    ds_read_b64_tr_b16 v[40:41], v10 offset:36864
    v_mfma_f32_16x16x32_bf16 v[68:71], v[48:51], a[108:111], v[68:71]
    ds_read_b64_tr_b16 v[42:43], v10 offset:37376
    v_mfma_f32_16x16x32_bf16 v[28:31], v[48:51], v[60:63], v[28:31]
    v_mfma_f32_16x16x32_bf16 v[72:75], v[52:55], a[44:47], v[72:75]
    ds_read_b64_tr_b16 v[44:45], v11 offset:36864
    v_mfma_f32_16x16x32_bf16 v[76:79], v[52:55], a[108:111], v[76:79]
    ds_read_b64_tr_b16 v[46:47], v11 offset:37376
    s_waitcnt lgkmcnt(4)
    v_mfma_f32_16x16x32_bf16 v[80:83], v[32:35], a[32:35], v[80:83]
    ds_read_b64_tr_b16 v[48:49], v10 offset:40960
    v_mfma_f32_16x16x32_bf16 v[84:87], v[32:35], a[96:99], v[84:87]
    ds_read_b64_tr_b16 v[50:51], v10 offset:41472
    v_mfma_f32_16x16x32_bf16 v[88:91], v[36:39], a[32:35], v[88:91]
    ds_read_b64_tr_b16 v[52:53], v11 offset:40960
    v_mfma_f32_16x16x32_bf16 v[92:95], v[36:39], a[96:99], v[92:95]
    ds_read_b64_tr_b16 v[54:55], v11 offset:41472
    s_waitcnt lgkmcnt(4)
    v_mfma_f32_16x16x32_bf16 v[80:83], v[40:43], a[36:39], v[80:83]
    ds_read_b64_tr_b16 v[32:33], v10 offset:45056
    v_mfma_f32_16x16x32_bf16 v[84:87], v[40:43], a[100:103], v[84:87]
    ds_read_b64_tr_b16 v[34:35], v10 offset:45568
    v_mfma_f32_16x16x32_bf16 v[88:91], v[44:47], a[36:39], v[88:91]
    ds_read_b64_tr_b16 v[36:37], v11 offset:45056
    v_mfma_f32_16x16x32_bf16 v[92:95], v[44:47], a[100:103], v[92:95]
    ds_read_b64_tr_b16 v[38:39], v11 offset:45568
    s_waitcnt lgkmcnt(4)
    v_mfma_f32_16x16x32_bf16 v[80:83], v[48:51], a[40:43], v[80:83]
    s_barrier
    ds_read_b64_tr_b16 v[40:41], v4 offset:0
    v_mfma_f32_16x16x32_bf16 v[84:87], v[48:51], a[104:107], v[84:87]
    ds_read_b64_tr_b16 v[42:43], v4 offset:512
    v_mfma_f32_16x16x32_bf16 v[88:91], v[52:55], a[40:43], v[88:91]
    ds_read_b64_tr_b16 v[44:45], v5 offset:0
    v_mfma_f32_16x16x32_bf16 v[92:95], v[52:55], a[104:107], v[92:95]
    ds_read_b64_tr_b16 v[46:47], v5 offset:512
    s_waitcnt lgkmcnt(4)
    v_mfma_f32_16x16x32_bf16 v[80:83], v[32:35], a[44:47], v[80:83]
    ds_read_b64_tr_b16 v[48:49], v4 offset:4096
    v_mfma_f32_16x16x32_bf16 v[84:87], v[32:35], a[108:111], v[84:87]
    ds_read_b64_tr_b16 v[50:51], v4 offset:4608
    v_mfma_f32_16x16x32_bf16 v[88:91], v[36:39], a[44:47], v[88:91]
    ds_read_b64_tr_b16 v[52:53], v5 offset:4096
    v_mfma_f32_16x16x32_bf16 v[92:95], v[36:39], a[108:111], v[92:95]
    ds_read_b64_tr_b16 v[54:55], v5 offset:4608
    s_waitcnt lgkmcnt(4)
    v_mfma_f32_16x16x32_bf16 v[96:99], v[40:43], a[32:35], v[96:99]
    ds_read_b64_tr_b16 v[32:33], v4 offset:8192
    v_mfma_f32_16x16x32_bf16 v[100:103], v[40:43], a[96:99], v[100:103]
    ds_read_b64_tr_b16 v[34:35], v4 offset:8704
    v_mfma_f32_16x16x32_bf16 v[104:107], v[44:47], a[32:35], v[104:107]
    ds_read_b64_tr_b16 v[36:37], v5 offset:8192
    v_mfma_f32_16x16x32_bf16 v[108:111], v[44:47], a[96:99], v[108:111]
    ds_read_b64_tr_b16 v[38:39], v5 offset:8704
    s_waitcnt lgkmcnt(4)
    v_mfma_f32_16x16x32_bf16 v[96:99], v[48:51], a[36:39], v[96:99]
    ds_read_b64_tr_b16 v[40:41], v4 offset:12288
    v_mfma_f32_16x16x32_bf16 v[100:103], v[48:51], a[100:103], v[100:103]
    ds_read_b64_tr_b16 v[42:43], v4 offset:12800
    v_mfma_f32_16x16x32_bf16 v[104:107], v[52:55], a[36:39], v[104:107]
    ds_read_b64_tr_b16 v[44:45], v5 offset:12288
    v_mfma_f32_16x16x32_bf16 v[108:111], v[52:55], a[100:103], v[108:111]
    ds_read_b64_tr_b16 v[46:47], v5 offset:12800
    s_waitcnt lgkmcnt(4)
    v_mfma_f32_16x16x32_bf16 v[96:99], v[32:35], a[40:43], v[96:99]
    ds_read_b64_tr_b16 v[48:49], v6 offset:0
    v_mfma_f32_16x16x32_bf16 v[100:103], v[32:35], a[104:107], v[100:103]
    ds_read_b64_tr_b16 v[50:51], v6 offset:512
    v_mfma_f32_16x16x32_bf16 v[104:107], v[36:39], a[40:43], v[104:107]
    ds_read_b64_tr_b16 v[52:53], v7 offset:0
    v_mfma_f32_16x16x32_bf16 v[108:111], v[36:39], a[104:107], v[108:111]
    ds_read_b64_tr_b16 v[54:55], v7 offset:512
    s_waitcnt lgkmcnt(4)
    v_mfma_f32_16x16x32_bf16 v[96:99], v[40:43], a[44:47], v[96:99]
    ds_read_b64_tr_b16 v[32:33], v6 offset:4096
    v_mfma_f32_16x16x32_bf16 v[100:103], v[40:43], a[108:111], v[100:103]
    ds_read_b64_tr_b16 v[34:35], v6 offset:4608
    v_mfma_f32_16x16x32_bf16 v[104:107], v[44:47], a[44:47], v[104:107]
    ds_read_b64_tr_b16 v[36:37], v7 offset:4096
    v_mfma_f32_16x16x32_bf16 v[108:111], v[44:47], a[108:111], v[108:111]
    ds_read_b64_tr_b16 v[38:39], v7 offset:4608
    s_waitcnt lgkmcnt(4)
    v_mfma_f32_16x16x32_bf16 v[112:115], v[48:51], a[32:35], v[112:115]
    ds_read_b64_tr_b16 v[40:41], v6 offset:8192
    v_mfma_f32_16x16x32_bf16 v[116:119], v[48:51], a[96:99], v[116:119]
    ds_read_b64_tr_b16 v[42:43], v6 offset:8704
    v_mfma_f32_16x16x32_bf16 v[120:123], v[52:55], a[32:35], v[120:123]
    ds_read_b64_tr_b16 v[44:45], v7 offset:8192
    v_mfma_f32_16x16x32_bf16 v[124:127], v[52:55], a[96:99], v[124:127]
    ds_read_b64_tr_b16 v[46:47], v7 offset:8704
    s_waitcnt lgkmcnt(4)
    v_mfma_f32_16x16x32_bf16 v[112:115], v[32:35], a[36:39], v[112:115]
    ds_read_b64_tr_b16 v[48:49], v6 offset:12288
    v_mfma_f32_16x16x32_bf16 v[116:119], v[32:35], a[100:103], v[116:119]
    ds_read_b64_tr_b16 v[50:51], v6 offset:12800
    v_mfma_f32_16x16x32_bf16 v[120:123], v[36:39], a[36:39], v[120:123]
    ds_read_b64_tr_b16 v[52:53], v7 offset:12288
    v_mfma_f32_16x16x32_bf16 v[124:127], v[36:39], a[100:103], v[124:127]
    ds_read_b64_tr_b16 v[54:55], v7 offset:12800
    s_waitcnt lgkmcnt(4)
    v_mfma_f32_16x16x32_bf16 v[112:115], v[40:43], a[40:43], v[112:115]
    s_barrier
    ds_read_b64_tr_b16 v[32:33], v4 offset:16384
    v_mfma_f32_16x16x32_bf16 v[116:119], v[40:43], a[104:107], v[116:119]
    ds_read_b64_tr_b16 v[34:35], v4 offset:16896
    v_add_u32 v1, 131072, v12
    ds_read_b128 a[48:51], v1 offset:0
    v_add_u32 v2, 131072, v14
    ds_read_b128 a[112:115], v2 offset:0
    ds_read_b128 v[24:27], v18 offset:12288
    v_mfma_f32_16x16x32_bf16 v[120:123], v[44:47], a[40:43], v[120:123]
    ds_read_b64_tr_b16 v[36:37], v5 offset:16384
    v_mfma_f32_16x16x32_bf16 v[124:127], v[44:47], a[104:107], v[124:127]
    ds_read_b64_tr_b16 v[38:39], v5 offset:16896
    s_waitcnt lgkmcnt(7)
    v_mfma_f32_16x16x32_bf16 v[112:115], v[48:51], a[44:47], v[112:115]
    ds_read_b64_tr_b16 v[40:41], v4 offset:20480
    v_mfma_f32_16x16x32_bf16 v[116:119], v[48:51], a[108:111], v[116:119]
    ds_read_b64_tr_b16 v[42:43], v4 offset:20992
    v_add_u32 v1, 131072, v13
    ds_read_b128 a[52:55], v1 offset:0
    v_add_u32 v2, 131072, v15
    ds_read_b128 a[116:119], v2 offset:0
    ds_read_b128 v[56:59], v19 offset:12288
    v_mfma_f32_16x16x32_bf16 v[120:123], v[52:55], a[44:47], v[120:123]
    ds_read_b64_tr_b16 v[44:45], v5 offset:20480
    v_mfma_f32_16x16x32_bf16 v[124:127], v[52:55], a[108:111], v[124:127]
    ds_read_b64_tr_b16 v[46:47], v5 offset:20992
    s_waitcnt lgkmcnt(7)
    v_mfma_f32_16x16x32_bf16 v[64:67], v[32:35], a[48:51], v[64:67]
    ds_read_b64_tr_b16 v[48:49], v4 offset:24576
    v_mfma_f32_16x16x32_bf16 v[68:71], v[32:35], a[112:115], v[68:71]
    ds_read_b64_tr_b16 v[50:51], v4 offset:25088
    v_add_u32 v1, 131072, v12
    ds_read_b128 a[56:59], v1 offset:16384
    v_add_u32 v2, 131072, v14
    ds_read_b128 a[120:123], v2 offset:16384
    ds_read_b128 v[60:63], v18 offset:14336
    v_mfma_f32_16x16x32_bf16 v[28:31], v[32:35], v[24:27], v[28:31]
    v_mfma_f32_16x16x32_bf16 v[72:75], v[36:39], a[48:51], v[72:75]
    ds_read_b64_tr_b16 v[52:53], v5 offset:24576
    v_mfma_f32_16x16x32_bf16 v[76:79], v[36:39], a[112:115], v[76:79]
    ds_read_b64_tr_b16 v[54:55], v5 offset:25088
    s_waitcnt lgkmcnt(7)
    v_mfma_f32_16x16x32_bf16 v[64:67], v[40:43], a[52:55], v[64:67]
    ds_read_b64_tr_b16 v[32:33], v4 offset:28672
    v_mfma_f32_16x16x32_bf16 v[68:71], v[40:43], a[116:119], v[68:71]
    ds_read_b64_tr_b16 v[34:35], v4 offset:29184
    v_add_u32 v1, 131072, v13
    ds_read_b128 a[60:63], v1 offset:16384
    v_add_u32 v2, 131072, v15
    ds_read_b128 a[124:127], v2 offset:16384
    ds_read_b128 v[24:27], v19 offset:14336
    v_mfma_f32_16x16x32_bf16 v[28:31], v[40:43], v[56:59], v[28:31]
    v_mfma_f32_16x16x32_bf16 v[72:75], v[44:47], a[52:55], v[72:75]
    ds_read_b64_tr_b16 v[36:37], v5 offset:28672
    v_mfma_f32_16x16x32_bf16 v[76:79], v[44:47], a[116:119], v[76:79]
    ds_read_b64_tr_b16 v[38:39], v5 offset:29184
    s_waitcnt lgkmcnt(7)
    v_mfma_f32_16x16x32_bf16 v[64:67], v[48:51], a[56:59], v[64:67]
    ds_read_b64_tr_b16 v[40:41], v6 offset:16384
    v_mfma_f32_16x16x32_bf16 v[68:71], v[48:51], a[120:123], v[68:71]
    ds_read_b64_tr_b16 v[42:43], v6 offset:16896
    v_mfma_f32_16x16x32_bf16 v[28:31], v[48:51], v[60:63], v[28:31]
    v_mfma_f32_16x16x32_bf16 v[72:75], v[52:55], a[56:59], v[72:75]
    ds_read_b64_tr_b16 v[44:45], v7 offset:16384
    v_mfma_f32_16x16x32_bf16 v[76:79], v[52:55], a[120:123], v[76:79]
    ds_read_b64_tr_b16 v[46:47], v7 offset:16896
    s_waitcnt lgkmcnt(4)
    v_mfma_f32_16x16x32_bf16 v[64:67], v[32:35], a[60:63], v[64:67]
    ds_read_b64_tr_b16 v[48:49], v6 offset:20480
    v_mfma_f32_16x16x32_bf16 v[68:71], v[32:35], a[124:127], v[68:71]
    ds_read_b64_tr_b16 v[50:51], v6 offset:20992
    v_mfma_f32_16x16x32_bf16 v[28:31], v[32:35], v[24:27], v[28:31]
    v_mfma_f32_16x16x32_bf16 v[72:75], v[36:39], a[60:63], v[72:75]
    ds_read_b64_tr_b16 v[52:53], v7 offset:20480
    v_mfma_f32_16x16x32_bf16 v[76:79], v[36:39], a[124:127], v[76:79]
    ds_read_b64_tr_b16 v[54:55], v7 offset:20992
    s_waitcnt lgkmcnt(4)
    v_mfma_f32_16x16x32_bf16 v[80:83], v[40:43], a[48:51], v[80:83]
    ds_read_b64_tr_b16 v[32:33], v6 offset:24576
    v_mfma_f32_16x16x32_bf16 v[84:87], v[40:43], a[112:115], v[84:87]
    ds_read_b64_tr_b16 v[34:35], v6 offset:25088
    v_mfma_f32_16x16x32_bf16 v[88:91], v[44:47], a[48:51], v[88:91]
    ds_read_b64_tr_b16 v[36:37], v7 offset:24576
    v_mfma_f32_16x16x32_bf16 v[92:95], v[44:47], a[112:115], v[92:95]
    ds_read_b64_tr_b16 v[38:39], v7 offset:25088
    s_waitcnt lgkmcnt(4)
    v_mfma_f32_16x16x32_bf16 v[80:83], v[48:51], a[52:55], v[80:83]
    ds_read_b64_tr_b16 v[40:41], v6 offset:28672
    v_mfma_f32_16x16x32_bf16 v[84:87], v[48:51], a[116:119], v[84:87]
    ds_read_b64_tr_b16 v[42:43], v6 offset:29184
    v_mfma_f32_16x16x32_bf16 v[88:91], v[52:55], a[52:55], v[88:91]
    ds_read_b64_tr_b16 v[44:45], v7 offset:28672
    v_mfma_f32_16x16x32_bf16 v[92:95], v[52:55], a[116:119], v[92:95]
    ds_read_b64_tr_b16 v[46:47], v7 offset:29184
    s_waitcnt lgkmcnt(4)
    v_mfma_f32_16x16x32_bf16 v[80:83], v[32:35], a[56:59], v[80:83]
    s_barrier
    ds_read_b64_tr_b16 v[48:49], v4 offset:32768
    v_mfma_f32_16x16x32_bf16 v[84:87], v[32:35], a[120:123], v[84:87]
    ds_read_b64_tr_b16 v[50:51], v4 offset:33280
    v_mfma_f32_16x16x32_bf16 v[88:91], v[36:39], a[56:59], v[88:91]
    ds_read_b64_tr_b16 v[52:53], v5 offset:32768
    v_cvt_pk_bf16_f32 v64, v64, v65
    v_mfma_f32_16x16x32_bf16 v[92:95], v[36:39], a[120:123], v[92:95]
    ds_read_b64_tr_b16 v[54:55], v5 offset:33280
    v_cvt_pk_bf16_f32 v65, v66, v67
    s_waitcnt lgkmcnt(4)
    v_mfma_f32_16x16x32_bf16 v[80:83], v[40:43], a[60:63], v[80:83]
    ds_read_b64_tr_b16 v[32:33], v4 offset:36864
    v_cvt_pk_bf16_f32 v66, v68, v69
    v_mfma_f32_16x16x32_bf16 v[84:87], v[40:43], a[124:127], v[84:87]
    ds_read_b64_tr_b16 v[34:35], v4 offset:37376
    v_cvt_pk_bf16_f32 v67, v70, v71
    v_mfma_f32_16x16x32_bf16 v[88:91], v[44:47], a[60:63], v[88:91]
    ds_read_b64_tr_b16 v[36:37], v5 offset:36864
    v_xor_b32 v1, 0, v3
    ds_write_b128 v1, v[64:67]
    v_mfma_f32_16x16x32_bf16 v[92:95], v[44:47], a[124:127], v[92:95]
    ds_read_b64_tr_b16 v[38:39], v5 offset:37376
    v_cvt_pk_bf16_f32 v72, v72, v73
    s_waitcnt lgkmcnt(5)
    v_mfma_f32_16x16x32_bf16 v[96:99], v[48:51], a[48:51], v[96:99]
    ds_read_b64_tr_b16 v[40:41], v4 offset:40960
    v_cvt_pk_bf16_f32 v73, v74, v75
    v_mfma_f32_16x16x32_bf16 v[100:103], v[48:51], a[112:115], v[100:103]
    ds_read_b64_tr_b16 v[42:43], v4 offset:41472
    v_cvt_pk_bf16_f32 v74, v76, v77
    v_mfma_f32_16x16x32_bf16 v[104:107], v[52:55], a[48:51], v[104:107]
    ds_read_b64_tr_b16 v[44:45], v5 offset:40960
    v_cvt_pk_bf16_f32 v75, v78, v79
    v_mfma_f32_16x16x32_bf16 v[108:111], v[52:55], a[112:115], v[108:111]
    ds_read_b64_tr_b16 v[46:47], v5 offset:41472
    v_xor_b32 v1, 1024, v3
    ds_write_b128 v1, v[72:75]
    s_waitcnt lgkmcnt(5)
    v_mfma_f32_16x16x32_bf16 v[96:99], v[32:35], a[52:55], v[96:99]
    ds_read_b64_tr_b16 v[48:49], v4 offset:45056
    v_cvt_pk_bf16_f32 v28, v28, v29
    v_cvt_pk_bf16_f32 v29, v30, v31
    s_add_u32 s3, s65, 4096
    v_subrev_u32 v1, s3, v3
    ds_write2_b64 v1, v[28:29], v[28:29] offset0:0 offset1:1
    v_mfma_f32_16x16x32_bf16 v[100:103], v[32:35], a[116:119], v[100:103]
    ds_read_b64_tr_b16 v[50:51], v4 offset:45568
    v_lshlrev_b32 v2, 2, v0
    v_add_u32 v2, 151552, v2
    v_mov_b32 v1, 1
    ds_write_b32 v2, v1
    v_mfma_f32_16x16x32_bf16 v[104:107], v[36:39], a[52:55], v[104:107]
    ds_read_b64_tr_b16 v[52:53], v5 offset:45056
    v_cvt_pk_bf16_f32 v80, v80, v81
    v_mfma_f32_16x16x32_bf16 v[108:111], v[36:39], a[116:119], v[108:111]
    ds_read_b64_tr_b16 v[54:55], v5 offset:45568
    v_cvt_pk_bf16_f32 v81, v82, v83
    s_waitcnt lgkmcnt(7)
    v_mfma_f32_16x16x32_bf16 v[96:99], v[40:43], a[56:59], v[96:99]
    ds_read_b64_tr_b16 v[32:33], v6 offset:32768
    v_cvt_pk_bf16_f32 v82, v84, v85
    v_mfma_f32_16x16x32_bf16 v[100:103], v[40:43], a[120:123], v[100:103]
    ds_read_b64_tr_b16 v[34:35], v6 offset:33280
    v_cvt_pk_bf16_f32 v83, v86, v87
    v_mfma_f32_16x16x32_bf16 v[104:107], v[44:47], a[56:59], v[104:107]
    ds_read_b64_tr_b16 v[36:37], v7 offset:32768
    v_xor_b32 v1, 2048, v3
    ds_write_b128 v1, v[80:83]
    v_mfma_f32_16x16x32_bf16 v[108:111], v[44:47], a[120:123], v[108:111]
    ds_read_b64_tr_b16 v[38:39], v7 offset:33280
    v_cvt_pk_bf16_f32 v88, v88, v89
    s_waitcnt lgkmcnt(5)
    v_mfma_f32_16x16x32_bf16 v[96:99], v[48:51], a[60:63], v[96:99]
    ds_read_b64_tr_b16 v[40:41], v6 offset:36864
    v_cvt_pk_bf16_f32 v89, v90, v91
    v_mfma_f32_16x16x32_bf16 v[100:103], v[48:51], a[124:127], v[100:103]
    ds_read_b64_tr_b16 v[42:43], v6 offset:37376
    v_cvt_pk_bf16_f32 v90, v92, v93
    v_mfma_f32_16x16x32_bf16 v[104:107], v[52:55], a[60:63], v[104:107]
    ds_read_b64_tr_b16 v[44:45], v7 offset:36864
    v_cvt_pk_bf16_f32 v91, v94, v95
    v_mfma_f32_16x16x32_bf16 v[108:111], v[52:55], a[124:127], v[108:111]
    ds_read_b64_tr_b16 v[46:47], v7 offset:37376
    v_xor_b32 v1, 3072, v3
    ds_write_b128 v1, v[88:91]
    s_waitcnt lgkmcnt(5)
    v_mfma_f32_16x16x32_bf16 v[112:115], v[32:35], a[48:51], v[112:115]
    ds_read_b64_tr_b16 v[48:49], v6 offset:40960
    v_mfma_f32_16x16x32_bf16 v[116:119], v[32:35], a[112:115], v[116:119]
    ds_read_b64_tr_b16 v[50:51], v6 offset:41472
    v_mfma_f32_16x16x32_bf16 v[120:123], v[36:39], a[48:51], v[120:123]
    ds_read_b64_tr_b16 v[52:53], v7 offset:40960
    v_cvt_pk_bf16_f32 v96, v96, v97
    v_mfma_f32_16x16x32_bf16 v[124:127], v[36:39], a[112:115], v[124:127]
    ds_read_b64_tr_b16 v[54:55], v7 offset:41472
    v_cvt_pk_bf16_f32 v97, v98, v99
    s_waitcnt lgkmcnt(5)
    v_mfma_f32_16x16x32_bf16 v[112:115], v[40:43], a[52:55], v[112:115]
    ds_read_b64_tr_b16 v[32:33], v6 offset:45056
    v_cvt_pk_bf16_f32 v98, v100, v101
    v_mfma_f32_16x16x32_bf16 v[116:119], v[40:43], a[116:119], v[116:119]
    ds_read_b64_tr_b16 v[34:35], v6 offset:45568
    v_cvt_pk_bf16_f32 v99, v102, v103
    v_mfma_f32_16x16x32_bf16 v[120:123], v[44:47], a[52:55], v[120:123]
    ds_read_b64_tr_b16 v[36:37], v7 offset:45056
    v_xor_b32 v1, 0, v3
    v_add_u32 v1, 4294832128, v1
    ds_write_b128 v1, v[96:99]
    v_mfma_f32_16x16x32_bf16 v[124:127], v[44:47], a[116:119], v[124:127]
    ds_read_b64_tr_b16 v[38:39], v7 offset:45568
    v_cvt_pk_bf16_f32 v104, v104, v105
    s_waitcnt lgkmcnt(5)
    v_mfma_f32_16x16x32_bf16 v[112:115], v[48:51], a[56:59], v[112:115]
    s_barrier
    ds_read_b64_tr_b16 v[40:41], v4 offset:49152
    v_cvt_pk_bf16_f32 v105, v106, v107
    v_mfma_f32_16x16x32_bf16 v[116:119], v[48:51], a[120:123], v[116:119]
    ds_read_b64_tr_b16 v[42:43], v4 offset:49664
    ds_read_b128 v[56:59], v18 offset:0
    v_cvt_pk_bf16_f32 v106, v108, v109
    v_mfma_f32_16x16x32_bf16 v[120:123], v[52:55], a[56:59], v[120:123]
    ds_read_b64_tr_b16 v[44:45], v5 offset:49152
    v_cvt_pk_bf16_f32 v107, v110, v111
    v_mfma_f32_16x16x32_bf16 v[124:127], v[52:55], a[120:123], v[124:127]
    ds_read_b64_tr_b16 v[46:47], v5 offset:49664
    v_xor_b32 v1, 1024, v3
    v_add_u32 v1, 4294832128, v1
    ds_write_b128 v1, v[104:107]
    s_waitcnt lgkmcnt(6)
    v_mfma_f32_16x16x32_bf16 v[112:115], v[32:35], a[60:63], v[112:115]
    ds_read_b64_tr_b16 v[48:49], v4 offset:53248
    v_mfma_f32_16x16x32_bf16 v[116:119], v[32:35], a[124:127], v[116:119]
    ds_read_b64_tr_b16 v[50:51], v4 offset:53760
    ds_read_b128 v[60:63], v19 offset:0
    v_mfma_f32_16x16x32_bf16 v[120:123], v[36:39], a[60:63], v[120:123]
    ds_read_b64_tr_b16 v[52:53], v5 offset:53248
    v_mfma_f32_16x16x32_bf16 v[124:127], v[36:39], a[124:127], v[124:127]
    ds_read_b64_tr_b16 v[54:55], v5 offset:53760
    s_waitcnt lgkmcnt(6)
    v_mfma_f32_16x16x32_bf16 v[64:67], a[0:3], v[40:43], 0
    ds_read_b64_tr_b16 v[32:33], v4 offset:57344
    v_mfma_f32_16x16x32_bf16 v[68:71], a[64:67], v[40:43], 0
    ds_read_b64_tr_b16 v[34:35], v4 offset:57856
    ds_read_b128 v[24:27], v18 offset:2048
    v_mfma_f32_16x16x32_bf16 v[28:31], v[56:59], v[40:43], 0
    v_mfma_f32_16x16x32_bf16 v[72:75], a[0:3], v[44:47], 0
    ds_read_b64_tr_b16 v[36:37], v5 offset:57344
    v_cvt_pk_bf16_f32 v112, v112, v113
    v_mfma_f32_16x16x32_bf16 v[76:79], a[64:67], v[44:47], 0
    ds_read_b64_tr_b16 v[38:39], v5 offset:57856
    v_cvt_pk_bf16_f32 v113, v114, v115
    s_waitcnt lgkmcnt(5)
    v_mfma_f32_16x16x32_bf16 v[64:67], a[4:7], v[48:51], v[64:67]
    ds_read_b64_tr_b16 v[40:41], v4 offset:61440
    v_cvt_pk_bf16_f32 v114, v116, v117
    v_mfma_f32_16x16x32_bf16 v[68:71], a[68:71], v[48:51], v[68:71]
    ds_read_b64_tr_b16 v[42:43], v4 offset:61952
    ds_read_b128 v[56:59], v19 offset:2048
    v_mfma_f32_16x16x32_bf16 v[28:31], v[60:63], v[48:51], v[28:31]
    v_cvt_pk_bf16_f32 v115, v118, v119
    v_mfma_f32_16x16x32_bf16 v[72:75], a[4:7], v[52:55], v[72:75]
    ds_read_b64_tr_b16 v[44:45], v5 offset:61440
    v_xor_b32 v1, 2048, v3
    v_add_u32 v1, 4294832128, v1
    ds_write_b128 v1, v[112:115]
    v_mfma_f32_16x16x32_bf16 v[76:79], a[68:71], v[52:55], v[76:79]
    ds_read_b64_tr_b16 v[46:47], v5 offset:61952
    v_cvt_pk_bf16_f32 v120, v120, v121
    s_waitcnt lgkmcnt(6)
    v_mfma_f32_16x16x32_bf16 v[64:67], a[8:11], v[32:35], v[64:67]
    ds_read_b64_tr_b16 v[48:49], v6 offset:49152
    v_cvt_pk_bf16_f32 v121, v122, v123
    v_mfma_f32_16x16x32_bf16 v[68:71], a[72:75], v[32:35], v[68:71]
    ds_read_b64_tr_b16 v[50:51], v6 offset:49664
    v_mfma_f32_16x16x32_bf16 v[28:31], v[24:27], v[32:35], v[28:31]
    v_cvt_pk_bf16_f32 v122, v124, v125
    v_mfma_f32_16x16x32_bf16 v[72:75], a[8:11], v[36:39], v[72:75]
    ds_read_b64_tr_b16 v[52:53], v7 offset:49152
    v_cvt_pk_bf16_f32 v123, v126, v127
    v_mfma_f32_16x16x32_bf16 v[76:79], a[72:75], v[36:39], v[76:79]
    ds_read_b64_tr_b16 v[54:55], v7 offset:49664
    v_xor_b32 v1, 3072, v3
    v_add_u32 v1, 4294832128, v1
    ds_write_b128 v1, v[120:123]
    s_waitcnt lgkmcnt(5)
    v_mfma_f32_16x16x32_bf16 v[64:67], a[12:15], v[40:43], v[64:67]
    ds_read_b64_tr_b16 v[32:33], v6 offset:53248
    v_mfma_f32_16x16x32_bf16 v[68:71], a[76:79], v[40:43], v[68:71]
    ds_read_b64_tr_b16 v[34:35], v6 offset:53760
    v_mfma_f32_16x16x32_bf16 v[28:31], v[56:59], v[40:43], v[28:31]
    v_mfma_f32_16x16x32_bf16 v[72:75], a[12:15], v[44:47], v[72:75]
    ds_read_b64_tr_b16 v[36:37], v7 offset:53248
    v_mfma_f32_16x16x32_bf16 v[76:79], a[76:79], v[44:47], v[76:79]
    ds_read_b64_tr_b16 v[38:39], v7 offset:53760
    s_waitcnt lgkmcnt(4)
    s_barrier
    v_mfma_f32_16x16x32_bf16 v[80:83], a[0:3], v[48:51], 0
    ds_read_b64_tr_b16 v[40:41], v6 offset:57344
    v_mfma_f32_16x16x32_bf16 v[84:87], a[64:67], v[48:51], 0
    ds_read_b64_tr_b16 v[42:43], v6 offset:57856
    v_mfma_f32_16x16x32_bf16 v[88:91], a[0:3], v[52:55], 0
    ds_read_b64_tr_b16 v[44:45], v7 offset:57344
    v_mfma_f32_16x16x32_bf16 v[92:95], a[64:67], v[52:55], 0
    ds_read_b64_tr_b16 v[46:47], v7 offset:57856
    s_waitcnt lgkmcnt(4)
    v_mfma_f32_16x16x32_bf16 v[80:83], a[4:7], v[32:35], v[80:83]
    ds_read_b64_tr_b16 v[48:49], v6 offset:61440
    v_mfma_f32_16x16x32_bf16 v[84:87], a[68:71], v[32:35], v[84:87]
    ds_read_b64_tr_b16 v[50:51], v6 offset:61952
    v_mfma_f32_16x16x32_bf16 v[88:91], a[4:7], v[36:39], v[88:91]
    ds_read_b64_tr_b16 v[52:53], v7 offset:61440
    v_mfma_f32_16x16x32_bf16 v[92:95], a[68:71], v[36:39], v[92:95]
    ds_read_b64_tr_b16 v[54:55], v7 offset:61952
    s_waitcnt lgkmcnt(4)
    v_mfma_f32_16x16x32_bf16 v[80:83], a[8:11], v[40:43], v[80:83]
    ds_read_b64_tr_b16 v[32:33], v8 offset:0
    v_mfma_f32_16x16x32_bf16 v[84:87], a[72:75], v[40:43], v[84:87]
    ds_read_b64_tr_b16 v[34:35], v8 offset:512
    ds_read_b128 v[60:63], v18 offset:4096
    v_mfma_f32_16x16x32_bf16 v[88:91], a[8:11], v[44:47], v[88:91]
    ds_read_b64_tr_b16 v[36:37], v9 offset:0
    v_mfma_f32_16x16x32_bf16 v[92:95], a[72:75], v[44:47], v[92:95]
    ds_read_b64_tr_b16 v[38:39], v9 offset:512
    s_waitcnt lgkmcnt(5)
    v_mfma_f32_16x16x32_bf16 v[80:83], a[12:15], v[48:51], v[80:83]
    ds_read_b64_tr_b16 v[40:41], v8 offset:4096
    v_mfma_f32_16x16x32_bf16 v[84:87], a[76:79], v[48:51], v[84:87]
    ds_read_b64_tr_b16 v[42:43], v8 offset:4608
    ds_read_b128 v[24:27], v19 offset:4096
    v_mfma_f32_16x16x32_bf16 v[88:91], a[12:15], v[52:55], v[88:91]
    ds_read_b64_tr_b16 v[44:45], v9 offset:4096
    v_mfma_f32_16x16x32_bf16 v[92:95], a[76:79], v[52:55], v[92:95]
    ds_read_b64_tr_b16 v[46:47], v9 offset:4608
    s_waitcnt lgkmcnt(5)
    v_mfma_f32_16x16x32_bf16 v[64:67], a[16:19], v[32:35], v[64:67]
    ds_read_b64_tr_b16 v[48:49], v8 offset:8192
    v_mfma_f32_16x16x32_bf16 v[68:71], a[80:83], v[32:35], v[68:71]
    ds_read_b64_tr_b16 v[50:51], v8 offset:8704
    ds_read_b128 v[56:59], v18 offset:6144
    v_mfma_f32_16x16x32_bf16 v[28:31], v[60:63], v[32:35], v[28:31]
    v_mfma_f32_16x16x32_bf16 v[72:75], a[16:19], v[36:39], v[72:75]
    ds_read_b64_tr_b16 v[52:53], v9 offset:8192
    v_mfma_f32_16x16x32_bf16 v[76:79], a[80:83], v[36:39], v[76:79]
    ds_read_b64_tr_b16 v[54:55], v9 offset:8704
    s_waitcnt lgkmcnt(5)
    v_mfma_f32_16x16x32_bf16 v[64:67], a[20:23], v[40:43], v[64:67]
    ds_read_b64_tr_b16 v[32:33], v8 offset:12288
    v_mfma_f32_16x16x32_bf16 v[68:71], a[84:87], v[40:43], v[68:71]
    ds_read_b64_tr_b16 v[34:35], v8 offset:12800
    ds_read_b128 v[60:63], v19 offset:6144
    v_mfma_f32_16x16x32_bf16 v[28:31], v[24:27], v[40:43], v[28:31]
    v_mfma_f32_16x16x32_bf16 v[72:75], a[20:23], v[44:47], v[72:75]
    ds_read_b64_tr_b16 v[36:37], v9 offset:12288
    v_mfma_f32_16x16x32_bf16 v[76:79], a[84:87], v[44:47], v[76:79]
    ds_read_b64_tr_b16 v[38:39], v9 offset:12800
    s_waitcnt lgkmcnt(5)
    v_mfma_f32_16x16x32_bf16 v[64:67], a[24:27], v[48:51], v[64:67]
    ds_read_b64_tr_b16 v[40:41], v10 offset:0
    v_mfma_f32_16x16x32_bf16 v[68:71], a[88:91], v[48:51], v[68:71]
    ds_read_b64_tr_b16 v[42:43], v10 offset:512
    v_mfma_f32_16x16x32_bf16 v[28:31], v[56:59], v[48:51], v[28:31]
    v_mfma_f32_16x16x32_bf16 v[72:75], a[24:27], v[52:55], v[72:75]
    ds_read_b64_tr_b16 v[44:45], v11 offset:0
    v_mfma_f32_16x16x32_bf16 v[76:79], a[88:91], v[52:55], v[76:79]
    ds_read_b64_tr_b16 v[46:47], v11 offset:512
    s_waitcnt lgkmcnt(4)
    v_mfma_f32_16x16x32_bf16 v[64:67], a[28:31], v[32:35], v[64:67]
    ds_read_b64_tr_b16 v[48:49], v10 offset:4096
    v_mfma_f32_16x16x32_bf16 v[68:71], a[92:95], v[32:35], v[68:71]
    ds_read_b64_tr_b16 v[50:51], v10 offset:4608
    v_mfma_f32_16x16x32_bf16 v[28:31], v[60:63], v[32:35], v[28:31]
    v_mfma_f32_16x16x32_bf16 v[72:75], a[28:31], v[36:39], v[72:75]
    ds_read_b64_tr_b16 v[52:53], v11 offset:4096
    v_mfma_f32_16x16x32_bf16 v[76:79], a[92:95], v[36:39], v[76:79]
    ds_read_b64_tr_b16 v[54:55], v11 offset:4608
    s_waitcnt lgkmcnt(4)
    v_mfma_f32_16x16x32_bf16 v[80:83], a[16:19], v[40:43], v[80:83]
    ds_read_b64_tr_b16 v[32:33], v10 offset:8192
    v_mfma_f32_16x16x32_bf16 v[84:87], a[80:83], v[40:43], v[84:87]
    ds_read_b64_tr_b16 v[34:35], v10 offset:8704
    v_mfma_f32_16x16x32_bf16 v[88:91], a[16:19], v[44:47], v[88:91]
    ds_read_b64_tr_b16 v[36:37], v11 offset:8192
    v_mfma_f32_16x16x32_bf16 v[92:95], a[80:83], v[44:47], v[92:95]
    ds_read_b64_tr_b16 v[38:39], v11 offset:8704
    s_waitcnt lgkmcnt(4)
    v_mfma_f32_16x16x32_bf16 v[80:83], a[20:23], v[48:51], v[80:83]
    ds_read_b64_tr_b16 v[40:41], v10 offset:12288
    v_mfma_f32_16x16x32_bf16 v[84:87], a[84:87], v[48:51], v[84:87]
    ds_read_b64_tr_b16 v[42:43], v10 offset:12800
    v_mfma_f32_16x16x32_bf16 v[88:91], a[20:23], v[52:55], v[88:91]
    ds_read_b64_tr_b16 v[44:45], v11 offset:12288
    v_mfma_f32_16x16x32_bf16 v[92:95], a[84:87], v[52:55], v[92:95]
    ds_read_b64_tr_b16 v[46:47], v11 offset:12800
    s_waitcnt lgkmcnt(4)
    v_mfma_f32_16x16x32_bf16 v[80:83], a[24:27], v[32:35], v[80:83]
    ds_read_b64_tr_b16 v[48:49], v8 offset:16384
    v_mfma_f32_16x16x32_bf16 v[84:87], a[88:91], v[32:35], v[84:87]
    ds_read_b64_tr_b16 v[50:51], v8 offset:16896
    ds_read_b128 v[24:27], v18 offset:8192
    v_mfma_f32_16x16x32_bf16 v[88:91], a[24:27], v[36:39], v[88:91]
    ds_read_b64_tr_b16 v[52:53], v9 offset:16384
    v_mfma_f32_16x16x32_bf16 v[92:95], a[88:91], v[36:39], v[92:95]
    ds_read_b64_tr_b16 v[54:55], v9 offset:16896
    s_waitcnt lgkmcnt(5)
    v_mfma_f32_16x16x32_bf16 v[80:83], a[28:31], v[40:43], v[80:83]
    ds_read_b64_tr_b16 v[32:33], v8 offset:20480
    v_mfma_f32_16x16x32_bf16 v[84:87], a[92:95], v[40:43], v[84:87]
    ds_read_b64_tr_b16 v[34:35], v8 offset:20992
    ds_read_b128 v[56:59], v19 offset:8192
    v_mfma_f32_16x16x32_bf16 v[88:91], a[28:31], v[44:47], v[88:91]
    ds_read_b64_tr_b16 v[36:37], v9 offset:20480
    v_mfma_f32_16x16x32_bf16 v[92:95], a[92:95], v[44:47], v[92:95]
    ds_read_b64_tr_b16 v[38:39], v9 offset:20992
    s_waitcnt lgkmcnt(5)
    v_mfma_f32_16x16x32_bf16 v[64:67], a[32:35], v[48:51], v[64:67]
    ds_read_b64_tr_b16 v[40:41], v8 offset:24576
    v_mfma_f32_16x16x32_bf16 v[68:71], a[96:99], v[48:51], v[68:71]
    ds_read_b64_tr_b16 v[42:43], v8 offset:25088
    ds_read_b128 v[60:63], v18 offset:10240
    v_mfma_f32_16x16x32_bf16 v[28:31], v[24:27], v[48:51], v[28:31]
    v_mfma_f32_16x16x32_bf16 v[72:75], a[32:35], v[52:55], v[72:75]
    ds_read_b64_tr_b16 v[44:45], v9 offset:24576
    v_mfma_f32_16x16x32_bf16 v[76:79], a[96:99], v[52:55], v[76:79]
    ds_read_b64_tr_b16 v[46:47], v9 offset:25088
    s_waitcnt lgkmcnt(5)
    v_mfma_f32_16x16x32_bf16 v[64:67], a[36:39], v[32:35], v[64:67]
    ds_read_b64_tr_b16 v[48:49], v8 offset:28672
    v_mfma_f32_16x16x32_bf16 v[68:71], a[100:103], v[32:35], v[68:71]
    ds_read_b64_tr_b16 v[50:51], v8 offset:29184
    ds_read_b128 v[24:27], v19 offset:10240
    v_mfma_f32_16x16x32_bf16 v[28:31], v[56:59], v[32:35], v[28:31]
    v_mfma_f32_16x16x32_bf16 v[72:75], a[36:39], v[36:39], v[72:75]
    ds_read_b64_tr_b16 v[52:53], v9 offset:28672
    v_mfma_f32_16x16x32_bf16 v[76:79], a[100:103], v[36:39], v[76:79]
    ds_read_b64_tr_b16 v[54:55], v9 offset:29184
    s_waitcnt lgkmcnt(5)
    v_mfma_f32_16x16x32_bf16 v[64:67], a[40:43], v[40:43], v[64:67]
    ds_read_b64_tr_b16 v[32:33], v10 offset:16384
    v_mfma_f32_16x16x32_bf16 v[68:71], a[104:107], v[40:43], v[68:71]
    ds_read_b64_tr_b16 v[34:35], v10 offset:16896
    v_mfma_f32_16x16x32_bf16 v[28:31], v[60:63], v[40:43], v[28:31]
    v_mfma_f32_16x16x32_bf16 v[72:75], a[40:43], v[44:47], v[72:75]
    ds_read_b64_tr_b16 v[36:37], v11 offset:16384
    v_mfma_f32_16x16x32_bf16 v[76:79], a[104:107], v[44:47], v[76:79]
    ds_read_b64_tr_b16 v[38:39], v11 offset:16896
    s_waitcnt lgkmcnt(4)
    v_mfma_f32_16x16x32_bf16 v[64:67], a[44:47], v[48:51], v[64:67]
    ds_read_b64_tr_b16 v[40:41], v10 offset:20480
    v_mfma_f32_16x16x32_bf16 v[68:71], a[108:111], v[48:51], v[68:71]
    ds_read_b64_tr_b16 v[42:43], v10 offset:20992
    v_mfma_f32_16x16x32_bf16 v[28:31], v[24:27], v[48:51], v[28:31]
    v_mfma_f32_16x16x32_bf16 v[72:75], a[44:47], v[52:55], v[72:75]
    ds_read_b64_tr_b16 v[44:45], v11 offset:20480
    v_mfma_f32_16x16x32_bf16 v[76:79], a[108:111], v[52:55], v[76:79]
    ds_read_b64_tr_b16 v[46:47], v11 offset:20992
    s_waitcnt lgkmcnt(4)
    v_mfma_f32_16x16x32_bf16 v[80:83], a[32:35], v[32:35], v[80:83]
    ds_read_b64_tr_b16 v[48:49], v10 offset:24576
    v_mfma_f32_16x16x32_bf16 v[84:87], a[96:99], v[32:35], v[84:87]
    ds_read_b64_tr_b16 v[50:51], v10 offset:25088
    v_mfma_f32_16x16x32_bf16 v[88:91], a[32:35], v[36:39], v[88:91]
    ds_read_b64_tr_b16 v[52:53], v11 offset:24576
    v_mfma_f32_16x16x32_bf16 v[92:95], a[96:99], v[36:39], v[92:95]
    ds_read_b64_tr_b16 v[54:55], v11 offset:25088
    s_waitcnt lgkmcnt(4)
    v_mfma_f32_16x16x32_bf16 v[80:83], a[36:39], v[40:43], v[80:83]
    ds_read_b64_tr_b16 v[32:33], v10 offset:28672
    v_mfma_f32_16x16x32_bf16 v[84:87], a[100:103], v[40:43], v[84:87]
    ds_read_b64_tr_b16 v[34:35], v10 offset:29184
    v_mfma_f32_16x16x32_bf16 v[88:91], a[36:39], v[44:47], v[88:91]
    ds_read_b64_tr_b16 v[36:37], v11 offset:28672
    v_mfma_f32_16x16x32_bf16 v[92:95], a[100:103], v[44:47], v[92:95]
    ds_read_b64_tr_b16 v[38:39], v11 offset:29184
    s_waitcnt lgkmcnt(4)
    v_mfma_f32_16x16x32_bf16 v[80:83], a[40:43], v[48:51], v[80:83]
    ds_read_b64_tr_b16 v[40:41], v8 offset:32768
    v_mfma_f32_16x16x32_bf16 v[84:87], a[104:107], v[48:51], v[84:87]
    ds_read_b64_tr_b16 v[42:43], v8 offset:33280
    ds_read_b128 v[56:59], v18 offset:12288
    v_mfma_f32_16x16x32_bf16 v[88:91], a[40:43], v[52:55], v[88:91]
    ds_read_b64_tr_b16 v[44:45], v9 offset:32768
    v_mfma_f32_16x16x32_bf16 v[92:95], a[104:107], v[52:55], v[92:95]
    ds_read_b64_tr_b16 v[46:47], v9 offset:33280
    s_waitcnt lgkmcnt(5)
    v_mfma_f32_16x16x32_bf16 v[80:83], a[44:47], v[32:35], v[80:83]
    ds_read_b64_tr_b16 v[48:49], v8 offset:36864
    v_mfma_f32_16x16x32_bf16 v[84:87], a[108:111], v[32:35], v[84:87]
    ds_read_b64_tr_b16 v[50:51], v8 offset:37376
    ds_read_b128 v[60:63], v19 offset:12288
    v_mfma_f32_16x16x32_bf16 v[88:91], a[44:47], v[36:39], v[88:91]
    ds_read_b64_tr_b16 v[52:53], v9 offset:36864
    v_mfma_f32_16x16x32_bf16 v[92:95], a[108:111], v[36:39], v[92:95]
    ds_read_b64_tr_b16 v[54:55], v9 offset:37376
    s_waitcnt lgkmcnt(5)
    v_mfma_f32_16x16x32_bf16 v[64:67], a[48:51], v[40:43], v[64:67]
    ds_read_b64_tr_b16 v[32:33], v8 offset:40960
    v_mfma_f32_16x16x32_bf16 v[68:71], a[112:115], v[40:43], v[68:71]
    ds_read_b64_tr_b16 v[34:35], v8 offset:41472
    ds_read_b128 v[24:27], v18 offset:14336
    v_mfma_f32_16x16x32_bf16 v[28:31], v[56:59], v[40:43], v[28:31]
    v_mfma_f32_16x16x32_bf16 v[72:75], a[48:51], v[44:47], v[72:75]
    ds_read_b64_tr_b16 v[36:37], v9 offset:40960
    v_mfma_f32_16x16x32_bf16 v[76:79], a[112:115], v[44:47], v[76:79]
    ds_read_b64_tr_b16 v[38:39], v9 offset:41472
    s_waitcnt lgkmcnt(5)
    v_mfma_f32_16x16x32_bf16 v[64:67], a[52:55], v[48:51], v[64:67]
    ds_read_b64_tr_b16 v[40:41], v8 offset:45056
    v_mfma_f32_16x16x32_bf16 v[68:71], a[116:119], v[48:51], v[68:71]
    ds_read_b64_tr_b16 v[42:43], v8 offset:45568
    ds_read_b128 v[56:59], v19 offset:14336
    v_mfma_f32_16x16x32_bf16 v[28:31], v[60:63], v[48:51], v[28:31]
    v_mfma_f32_16x16x32_bf16 v[72:75], a[52:55], v[52:55], v[72:75]
    ds_read_b64_tr_b16 v[44:45], v9 offset:45056
    v_mfma_f32_16x16x32_bf16 v[76:79], a[116:119], v[52:55], v[76:79]
    ds_read_b64_tr_b16 v[46:47], v9 offset:45568
    s_waitcnt lgkmcnt(5)
    v_mfma_f32_16x16x32_bf16 v[64:67], a[56:59], v[32:35], v[64:67]
    ds_read_b64_tr_b16 v[48:49], v10 offset:32768
    v_mfma_f32_16x16x32_bf16 v[68:71], a[120:123], v[32:35], v[68:71]
    ds_read_b64_tr_b16 v[50:51], v10 offset:33280
    v_mfma_f32_16x16x32_bf16 v[28:31], v[24:27], v[32:35], v[28:31]
    v_mfma_f32_16x16x32_bf16 v[72:75], a[56:59], v[36:39], v[72:75]
    ds_read_b64_tr_b16 v[52:53], v11 offset:32768
    v_mfma_f32_16x16x32_bf16 v[76:79], a[120:123], v[36:39], v[76:79]
    ds_read_b64_tr_b16 v[54:55], v11 offset:33280
    s_waitcnt lgkmcnt(4)
    v_mfma_f32_16x16x32_bf16 v[64:67], a[60:63], v[40:43], v[64:67]
    ds_read_b64_tr_b16 v[32:33], v10 offset:36864
    v_mfma_f32_16x16x32_bf16 v[68:71], a[124:127], v[40:43], v[68:71]
    ds_read_b64_tr_b16 v[34:35], v10 offset:37376
    v_mfma_f32_16x16x32_bf16 v[28:31], v[56:59], v[40:43], v[28:31]
    v_mfma_f32_16x16x32_bf16 v[72:75], a[60:63], v[44:47], v[72:75]
    ds_read_b64_tr_b16 v[36:37], v11 offset:36864
    v_mfma_f32_16x16x32_bf16 v[76:79], a[124:127], v[44:47], v[76:79]
    ds_read_b64_tr_b16 v[38:39], v11 offset:37376
    s_waitcnt lgkmcnt(4)
    v_mfma_f32_16x16x32_bf16 v[80:83], a[48:51], v[48:51], v[80:83]
    ds_read_b64_tr_b16 v[40:41], v10 offset:40960
    v_mfma_f32_16x16x32_bf16 v[84:87], a[112:115], v[48:51], v[84:87]
    ds_read_b64_tr_b16 v[42:43], v10 offset:41472
    v_mfma_f32_16x16x32_bf16 v[88:91], a[48:51], v[52:55], v[88:91]
    ds_read_b64_tr_b16 v[44:45], v11 offset:40960
    v_cvt_pk_bf16_f32 v64, v64, v65
    v_mfma_f32_16x16x32_bf16 v[92:95], a[112:115], v[52:55], v[92:95]
    ds_read_b64_tr_b16 v[46:47], v11 offset:41472
    v_cvt_pk_bf16_f32 v65, v66, v67
    s_waitcnt lgkmcnt(4)
    v_mfma_f32_16x16x32_bf16 v[80:83], a[52:55], v[32:35], v[80:83]
    ds_read_b64_tr_b16 v[48:49], v10 offset:45056
    v_cvt_pk_bf16_f32 v66, v68, v69
    v_mfma_f32_16x16x32_bf16 v[84:87], a[116:119], v[32:35], v[84:87]
    ds_read_b64_tr_b16 v[50:51], v10 offset:45568
    v_cvt_pk_bf16_f32 v67, v70, v71
    v_mfma_f32_16x16x32_bf16 v[88:91], a[52:55], v[36:39], v[88:91]
    ds_read_b64_tr_b16 v[52:53], v11 offset:45056
    v_xor_b32 v1, 0, v3
    ds_write_b128 v1, v[64:67]
    v_mfma_f32_16x16x32_bf16 v[92:95], a[116:119], v[36:39], v[92:95]
    ds_read_b64_tr_b16 v[54:55], v11 offset:45568
    v_cvt_pk_bf16_f32 v72, v72, v73
    s_waitcnt lgkmcnt(5)
    v_mfma_f32_16x16x32_bf16 v[80:83], a[56:59], v[40:43], v[80:83]
    v_cvt_pk_bf16_f32 v73, v74, v75
    v_mfma_f32_16x16x32_bf16 v[84:87], a[120:123], v[40:43], v[84:87]
    v_cvt_pk_bf16_f32 v74, v76, v77
    v_mfma_f32_16x16x32_bf16 v[88:91], a[56:59], v[44:47], v[88:91]
    v_cvt_pk_bf16_f32 v75, v78, v79
    v_mfma_f32_16x16x32_bf16 v[92:95], a[120:123], v[44:47], v[92:95]
    v_xor_b32 v1, 1024, v3
    ds_write_b128 v1, v[72:75]
    s_waitcnt lgkmcnt(1)
    v_mfma_f32_16x16x32_bf16 v[80:83], a[60:63], v[48:51], v[80:83]
    v_cvt_pk_bf16_f32 v28, v28, v29
    v_cvt_pk_bf16_f32 v29, v30, v31
    s_add_u32 s3, s65, 4096
    v_subrev_u32 v1, s3, v3
    ds_write2_b64 v1, v[28:29], v[28:29] offset0:0 offset1:1
    v_mfma_f32_16x16x32_bf16 v[84:87], a[124:127], v[48:51], v[84:87]
    v_mfma_f32_16x16x32_bf16 v[88:91], a[60:63], v[52:55], v[88:91]
    v_mfma_f32_16x16x32_bf16 v[92:95], a[124:127], v[52:55], v[92:95]
    v_cvt_pk_bf16_f32 v80, v80, v81
    v_cvt_pk_bf16_f32 v81, v82, v83
    s_nop 3
    v_cvt_pk_bf16_f32 v82, v84, v85
    v_cvt_pk_bf16_f32 v83, v86, v87
    v_xor_b32 v1, 2048, v3
    ds_write_b128 v1, v[80:83]
    v_cvt_pk_bf16_f32 v88, v88, v89
    v_cvt_pk_bf16_f32 v89, v90, v91
    v_cvt_pk_bf16_f32 v90, v92, v93
    v_cvt_pk_bf16_f32 v91, v94, v95
    v_xor_b32 v1, 3072, v3
    ds_write_b128 v1, v[88:91]
    s_waitcnt lgkmcnt(0)
    s_barrier
    v_lshrrev_b32 v1, 3, v0
    v_lshrrev_b32 v2, 4, v0
    v_lshlrev_b32 v2, 1, v2
    v_and_b32 v4, 7, v0
    v_xor_b32 v4, v4, v2
    v_lshlrev_b32 v4, 4, v4
    v_lshl_add_u32 v4, v1, 10, v4
    v_add_u32 v5, 7168, v4
    v_add_u32 v6, 14336, v4
    v_add_u32 v7, 21504, v4
    s_barrier
    s_setprio 0
    s_add_u32 m0, s65, 49152
    s_add_u32 s71, s90, 196608
    buffer_load_dwordx4 v4, s[40:43], s71 offen offset:0 lds
    buffer_load_dwordx4 v5, s[40:43], s71 offen offset:1024 lds
    buffer_load_dwordx4 v6, s[40:43], s71 offen offset:2048 lds
    buffer_load_dwordx4 v7, s[40:43], s71 offen offset:3072 lds
    s_add_u32 m0, s79, 151568
    s_mov_b64 exec, 1
    buffer_load_dword v16, s[44:47], s46 offen lds
    s_mov_b64 exec, -1
    s_add_u32 m0, s65, 65536
    s_add_u32 s71, s90, 262144
    buffer_load_dwordx4 v4, s[40:43], s71 offen offset:0 lds
    buffer_load_dwordx4 v5, s[40:43], s71 offen offset:1024 lds
    buffer_load_dwordx4 v6, s[40:43], s71 offen offset:2048 lds
    buffer_load_dwordx4 v7, s[40:43], s71 offen offset:3072 lds
    s_add_u32 m0, s79, 151584
    s_mov_b64 exec, 1
    buffer_load_dword v16, s[44:47], s46 offen lds
    s_mov_b64 exec, -1
    s_waitcnt vmcnt(5)
    s_add_u32 m0, s65, 81920
    s_add_u32 s71, s90, 327680
    buffer_load_dwordx4 v4, s[40:43], s71 offen offset:0 lds
    buffer_load_dwordx4 v5, s[40:43], s71 offen offset:1024 lds
    buffer_load_dwordx4 v6, s[40:43], s71 offen offset:2048 lds
    buffer_load_dwordx4 v7, s[40:43], s71 offen offset:3072 lds
    s_waitcnt vmcnt(5)
    s_add_u32 m0, s65, 98304
    s_add_u32 s71, s90, 393216
    buffer_load_dwordx4 v4, s[40:43], s71 offen offset:0 lds
    buffer_load_dwordx4 v5, s[40:43], s71 offen offset:1024 lds
    buffer_load_dwordx4 v6, s[40:43], s71 offen offset:2048 lds
    buffer_load_dwordx4 v7, s[40:43], s71 offen offset:3072 lds
    s_add_u32 m0, s79, 151600
    s_mov_b64 exec, 1
    buffer_load_dword v16, s[44:47], s46 offen lds
    s_mov_b64 exec, -1
    s_waitcnt vmcnt(5)
    s_add_u32 m0, s65, 131072
    s_xor_b32 s71, s93, 0
    s_add_u32 s71, s71, s91
    buffer_load_dwordx4 v4, s[44:47], s71 offen offset:0 lds
    buffer_load_dwordx4 v5, s[44:47], s71 offen offset:1024 lds
    buffer_load_dwordx4 v6, s[44:47], s71 offen offset:2048 lds
    buffer_load_dwordx4 v7, s[44:47], s71 offen offset:3072 lds
    s_waitcnt vmcnt(5)
    s_add_u32 m0, s65, 114688
    s_xor_b32 s71, s93, 65536
    s_add_u32 s71, s71, s91
    buffer_load_dwordx4 v4, s[44:47], s71 offen offset:0 lds
    buffer_load_dwordx4 v5, s[44:47], s71 offen offset:1024 lds
    buffer_load_dwordx4 v6, s[44:47], s71 offen offset:2048 lds
    buffer_load_dwordx4 v7, s[44:47], s71 offen offset:3072 lds
    s_add_u32 m0, s79, 151616
    s_mov_b64 exec, 1
    buffer_load_dword v16, s[44:47], s46 offen lds
    s_mov_b64 exec, -1
    s_waitcnt vmcnt(0) lgkmcnt(0)
    s_endpgm
L_end:
    s_endpgm
.section .rodata,"a"
.p2align 6
.amdhsa_kernel gated_mix__sliding_local_dilated__dense_activation_relu__prompt_kernel
  .amdhsa_next_free_vgpr 256
  .amdhsa_next_free_sgpr 102
  .amdhsa_accum_offset 128
  .amdhsa_group_segment_fixed_size 0
  .amdhsa_kernarg_size 80
  .amdhsa_user_sgpr_count 2
  .amdhsa_user_sgpr_kernarg_segment_ptr 1
  .amdhsa_system_sgpr_workgroup_id_x 1
.end_amdhsa_kernel
```
